```python
import torch

def _softmax(x, axis=-1):
    return torch.softmax(x, dim=axis)

def _gelu(x):
    return torch.nn.functional.gelu(x, approximate='tanh')

def _silu(x):
    return torch.nn.functional.silu(x)

def _sigmoid(x):
    return torch.sigmoid(x)

def _layernorm(x, axis=-1, eps=1e-05):
    m = x.mean(dim=axis, keepdim=True)
    v = x.var(dim=axis, keepdim=True, unbiased=False)
    return (x - m) / torch.sqrt(v + eps)

def _scatter_add(tgt, idx, src, axis=0):
    return tgt.clone().index_add_(axis, idx, src)

def _segment_sum(src, seg, n):
    out = torch.zeros((n,) + src.shape[1:], dtype=src.dtype)
    return out.index_add_(0, seg, src)

def _pad(x, pw):
    flat = tuple((v for pair in reversed(pw) for v in pair))
    return torch.nn.functional.pad(x, flat)
kernel_name = 'adaLN_cond__memory_aug_recurrent_mem_tr__glu_gated_bilinear__prompt'

def setup_inputs():

    _w = lambda a: (lambda t: t.to(torch.bfloat16) if t.is_floating_point() else t)(torch.as_tensor(a))

    def _A_setup():
        B, S, Dm = (1, 2048, 512)
        H, Dh = (32, 128)
        M, seg = (8, 32)
        seg = min(seg, S)
        S = S // seg * seg
        return {'x': _w((lambda *s: torch.randn(*s, dtype=torch.bfloat16) * 0.05)(B, S, Dm)), 'mem0': _w((lambda *s: torch.randn(*s, dtype=torch.bfloat16) * 0.8)(B, M, Dm)), 'Wq': _w((lambda *s: torch.randn(*s, dtype=torch.bfloat16) * 1.6)(Dm, H, Dh) * Dm ** (-0.5)), 'Wk': _w((lambda *s: torch.randn(*s, dtype=torch.bfloat16) * 1.6)(Dm, H, Dh) * Dm ** (-0.5)), 'Wv': _w((lambda *s: torch.randn(*s, dtype=torch.bfloat16) * 0.8)(Dm, H, Dh) * Dm ** (-0.5)), 'Wo': _w((lambda *s: torch.randn(*s, dtype=torch.bfloat16) * 0.8)(H, Dh, Dm) * (H * Dh) ** (-0.5)), 'seg_len': seg}
    _A_in = _A_setup()

    def _B_setup():
        B, S, D, F = (1, 2048, 512, 1792)
        return {'x': _w((lambda *s: torch.randn(*s, dtype=torch.bfloat16) * 0.05)(B, S, D)), 'w_gate': _w((lambda *s: torch.randn(*s, dtype=torch.bfloat16) * 0.8)(D, F) * D ** (-0.5)), 'w_up': _w((lambda *s: torch.randn(*s, dtype=torch.bfloat16) * 0.8)(D, F) * D ** (-0.5)), 'w_down': _w((lambda *s: torch.randn(*s, dtype=torch.bfloat16) * 0.8)(F, D) * F ** (-0.5))}
    _B_in = _B_setup()
    return {'A_x': _A_in['x'], 'A_mem0': _A_in['mem0'], 'A_Wq': _A_in['Wq'], 'A_Wk': _A_in['Wk'], 'A_Wv': _A_in['Wv'], 'A_Wo': _A_in['Wo'], 'A_seg_len': _A_in['seg_len'], 'B_x': _B_in['x'], 'B_w_gate': _B_in['w_gate'], 'B_w_up': _B_in['w_up'], 'B_w_down': _B_in['w_down'], 'c': _w((lambda *s: torch.randn(*s, dtype=torch.bfloat16) * 0.1)(1, 512) * 8.0), 'w_mod': _w((lambda *s: torch.randn(*s, dtype=torch.bfloat16) * 0.1)(512, 6 * 512) * 512 ** (-0.5) * 8.0)}

def reference(A_x, A_mem0, A_Wq, A_Wk, A_Wv, A_Wo, A_seg_len, B_x, B_w_gate, B_w_up, B_w_down, c, w_mod):

    def _A_ref(x, mem0, Wq, Wk, Wv, Wo, seg_len):
        B, S, Dm = x.shape
        H, Dh = (Wq.shape[1], Wq.shape[2])
        M = mem0.shape[1]
        scale = Dh ** (-0.5)
        n_seg = S // seg_len
        L = M + seg_len
        idx = torch.arange(L)
        mask = (idx[:, None] < M) | (idx[:, None] >= idx[None, :])
        mem = mem0
        outs = []
        for s in range(n_seg):
            xs = x[:, s * seg_len:(s + 1) * seg_len, :].clone()
            h = torch.concatenate([mem, xs], axis=1)
            q = torch.einsum('btd,dhe->bhte', h, Wq)
            k = torch.einsum('btd,dhe->bhte', h, Wk)
            v = torch.einsum('btd,dhe->bhte', h, Wv)
            scores = torch.einsum('bhqe,bhke->bhqk', q, k) * scale
            scores = torch.where(mask[None, None], scores, -1000000000.0)
            p = _softmax(scores, axis=-1)
            o = torch.einsum('bhqk,bhke->bhqe', p, v)
            o = torch.einsum('bhte,hed->btd', o, Wo)
            mem = o[:, :M, :].clone()
            outs.append(o[:, M:, :])
        return torch.concatenate(outs, axis=1)

    def _B_ref(x, w_gate, w_up, w_down):
        g = torch.einsum('bsd,df->bsf', x, w_gate)
        u = torch.einsum('bsd,df->bsf', x, w_up)
        h = g * u
        return torch.einsum('bsf,fd->bsd', h, w_down)
    x = A_x
    mod = (_silu(c) @ w_mod).reshape(c.shape[0], 6, 1, -1)
    sa, ca, ga, sb, cb, gb = (mod[:, 0].clone(), mod[:, 1].clone(), mod[:, 2].clone(), mod[:, 3].clone(), mod[:, 4].clone(), mod[:, 5].clone())
    h = _layernorm(x, axis=-1) * (1 + ca) + sa
    x = x + ga * _A_ref(h, A_mem0, A_Wq, A_Wk, A_Wv, A_Wo, A_seg_len)
    h = _layernorm(x, axis=-1) * (1 + cb) + sb
    x = x + gb * _B_ref(h, B_w_gate, B_w_up, B_w_down)
    return x
```

```asm
; @launch grid=(256,1,1) block=(256,1,1) lds=163840
.amdgcn_target "amdgcn-amd-amdhsa--gfx950"
.text
.p2align 8
.globl adaLN_cond__memory_aug_recurrent_mem_tr__glu_gated_bilinear__prompt_kernel
.type adaLN_cond__memory_aug_recurrent_mem_tr__glu_gated_bilinear__prompt_kernel,@function
adaLN_cond__memory_aug_recurrent_mem_tr__glu_gated_bilinear__prompt_kernel:
    s_cmp_ge_u32 s2, 256
    s_cbranch_scc1 main_done
    s_load_dwordx8 s[8:15], s[0:1], 8
    s_load_dwordx2 s[16:17], s[0:1], 40
    s_load_dwordx4 s[20:23], s[0:1], 112
    s_getreg_b32 s57, hwreg(HW_REG_XCC_ID)
    s_and_b32 s57, s57, 7
    s_lshl_b32 s57, s57, 2
    s_lshr_b32 s57, 0x24130765, s57
    s_and_b32 s57, s57, 7
    v_lshrrev_b32_e64 v1, 6, v0
    s_nop 0
    v_readfirstlane_b32 s54, v1
    s_getpc_b64 s[4:5]
ipf_base:
    s_lshr_b32 s6, s2, 3
    s_lshl_b32 s6, s6, 12
    v_lshl_add_u32 v2, v0, 4, s6
    v_min_u32 v2, code_end-ipf_base-16, v2
    v_mov_b32 v3, s5
    v_add_co_u32 v2, vcc, s4, v2
    s_nop 1
    v_addc_co_u32 v3, vcc, 0, v3, vcc
    global_load_dwordx4 v[252:255], v[2:3], off
    v_and_b32_e64 v0, 63, v0
    s_waitcnt lgkmcnt(0)
    s_mov_b32 s24, s22
    s_and_b32 s25, s23, 0xffff
    s_mov_b32 s26, 268435456
    s_mov_b32 s27, 0x00020000
    s_mov_b32 s28, s20
    s_and_b32 s29, s21, 0xffff
    s_mov_b32 s30, 256
    s_mov_b32 s31, 0x00020000
    s_mov_b32 s32, s10
    s_and_b32 s33, s11, 0xffff
    s_mov_b32 s34, 4194304
    s_mov_b32 s35, 0x00020000
    s_mov_b32 s36, s12
    s_and_b32 s37, s13, 0xffff
    s_mov_b32 s38, 4194304
    s_mov_b32 s39, 0x00020000
    s_mov_b32 s40, s14
    s_and_b32 s41, s15, 0xffff
    s_mov_b32 s42, 4194304
    s_mov_b32 s43, 0x00020000
    s_mov_b32 s44, s16
    s_and_b32 s45, s17, 0xffff
    s_mov_b32 s46, 4194304
    s_mov_b32 s47, 0x00020000
    s_mov_b32 s48, s8
    s_and_b32 s49, s9, 0xffff
    s_mov_b32 s50, 8192
    s_mov_b32 s51, 0x00020000
    s_lshl_b32 s3, s2, 7
    s_add_u32 s3, s3, 98304
    s_cmp_lg_u32 s54, 0
    s_cbranch_scc1 role_wait
    s_mov_b32 s59, s57
    s_mov_b32 s61, 0
    s_mov_b64 exec, 1
role_loop:
    s_cmp_eq_u32 s59, 0
    s_cbranch_scc1 role_tk
    v_mov_b64 v[4:5], 0
    v_mov_b64 v[6:7], 0
    buffer_store_dwordx4 v[4:7], off, s[24:27], s3 sc1
    s_waitcnt vmcnt(0)
role_tk:
    s_cmp_eq_u32 s59, s57
    s_cselect_b32 s60, 1, 0x10001
    v_mov_b32 v1, s60
    s_lshl_b32 s60, s59, 2
    s_add_u32 s60, s60, 144
    s_cmp_eq_u32 s59, 0
    s_cselect_b32 s60, 0, s60
    buffer_atomic_add v1, off, s[28:31], s60 sc0
    s_waitcnt vmcnt(0)
    v_readfirstlane_b32 s60, v1
    s_nop 0
    s_and_b32 s60, s60, 0xffff
    s_cmp_lt_u32 s60, 32
    s_cbranch_scc1 role_got
    s_add_u32 s59, s59, 1
    s_and_b32 s59, s59, 7
    s_add_u32 s61, s61, 1
    s_cmp_lt_u32 s61, 8
    s_cbranch_scc1 role_loop
    s_mov_b32 s59, 8
    s_mov_b32 s60, 0
role_got:
    s_lshl_b32 s59, s59, 5
    s_add_u32 s59, s59, s60
    v_mov_b32 v1, s59
    v_mov_b32 v2, 0
    ds_write_b32 v2, v1
    s_mov_b64 exec, -1
    s_waitcnt lgkmcnt(0)
role_wait:
    s_barrier
    v_mov_b32 v2, 0
    ds_read_b32 v1, v2
    s_waitcnt lgkmcnt(0)
    v_readfirstlane_b32 s53, v1
    s_barrier
    s_cmp_ge_u32 s53, 256
    s_cbranch_scc1 main_done
    s_lshl_b32 s58, s54, 15
    s_add_u32 s58, s58, 32768
    s_cmp_lt_u32 s53, 32
    s_cbranch_scc1 rec_start
    s_branch work_start
rec_start:
    s_mov_b32 s55, s53
    s_lshl_b32 s58, s54, 12
    s_add_u32 s58, s58, 32768
    s_lshl_b32 s13, s55, 8
    s_lshl_b32 s12, s55, 17
    v_lshrrev_b32 v16, 4, v0
    v_and_b32 v17, 15, v0
    v_and_b32 v18, 1, v16
    v_lshlrev_b32 v18, 1, v18
    v_xor_b32 v17, v17, v18
    s_lshl_b32 s59, s54, 4
    v_add_u32_e64 v16, s59, v16
    s_mov_b32 s59, 8192
    v_mul_lo_u32 v18, v16, s59
    v_add_u32 v18, s13, v18
    v_xor_b32 v19, 0, v17
    v_lshl_add_u32 v96, v19, 4, v18
    v_xor_b32_e64 v19, 4, v17
    v_lshl_add_u32 v97, v19, 4, v18
    v_add_u32 v97, 32768, v97
    v_xor_b32_e64 v19, 8, v17
    v_lshl_add_u32 v98, v19, 4, v18
    v_add_u32 v98, 65536, v98
    v_xor_b32_e64 v19, 12, v17
    v_lshl_add_u32 v99, v19, 4, v18
    v_add_u32 v99, 98304, v99
    s_mov_b32 s59, 1024
    v_mul_lo_u32 v18, v16, s59
    v_xor_b32_e64 v19, 0, v17
    v_lshl_add_u32 v100, v19, 4, v18
    v_xor_b32_e64 v19, 4, v17
    v_lshl_add_u32 v101, v19, 4, v18
    v_add_u32 v101, 4096, v101
    v_xor_b32_e64 v19, 8, v17
    v_lshl_add_u32 v102, v19, 4, v18
    v_add_u32 v102, 8192, v102
    v_xor_b32_e64 v19, 12, v17
    v_lshl_add_u32 v103, v19, 4, v18
    v_add_u32 v103, 12288, v103
    v_lshrrev_b32 v2, 3, v0
    v_lshlrev_b32 v104, 13, v2
    v_and_b32_e64 v2, 7, v0
    v_lshl_add_u32 v104, v2, 4, v104
    s_and_b32 s59, s55, 28
    s_lshl_b32 s59, s59, 8
    s_add_u32 s59, s59, 384
    s_bfe_u32 s60, s55, 0x10001
    s_lshl_b32 s60, s60, 2
    s_add_u32 s60, s60, s54
    s_lshl_b32 s60, s60, 16
    s_add_u32 s59, s59, s60
    s_bitcmp1_b32 s55, 0
    s_cselect_b32 s59, 0x1000000, s59
    v_add_u32_e64 v104, s59, v104
    s_mov_b32 s59, 0
    s_add_u32 m0, s58, 0
    s_nop 0
    buffer_load_dwordx4 v96, s[32:35], s59 offen lds
    s_add_u32 m0, s58, 1024
    s_nop 0
    buffer_load_dwordx4 v97, s[32:35], s59 offen lds
    s_add_u32 m0, s58, 2048
    s_nop 0
    buffer_load_dwordx4 v98, s[32:35], s59 offen lds
    s_add_u32 m0, s58, 3072
    s_nop 0
    buffer_load_dwordx4 v99, s[32:35], s59 offen lds
    s_lshl_b32 m0, s54, 10
    s_mov_b32 s59, 2097152
    buffer_load_dwordx4 v104, s[32:35], s59 offen lds
    s_mov_b32 s59, 524288
    s_add_u32 m0, s58, 16384
    s_nop 0
    buffer_load_dwordx4 v96, s[32:35], s59 offen lds
    s_add_u32 m0, s58, 17408
    s_nop 0
    buffer_load_dwordx4 v97, s[32:35], s59 offen lds
    s_add_u32 m0, s58, 18432
    s_nop 0
    buffer_load_dwordx4 v98, s[32:35], s59 offen lds
    s_add_u32 m0, s58, 19456
    s_nop 0
    buffer_load_dwordx4 v99, s[32:35], s59 offen lds
    s_lshl_b32 m0, s54, 10
    s_mov_b32 s59, 2621440
    buffer_load_dwordx4 v104, s[32:35], s59 offen lds
    s_mov_b32 s59, 1048576
    s_add_u32 m0, s58, 32768
    s_nop 0
    buffer_load_dwordx4 v96, s[32:35], s59 offen lds
    s_add_u32 m0, s58, 33792
    s_nop 0
    buffer_load_dwordx4 v97, s[32:35], s59 offen lds
    s_add_u32 m0, s58, 34816
    s_nop 0
    buffer_load_dwordx4 v98, s[32:35], s59 offen lds
    s_add_u32 m0, s58, 35840
    s_nop 0
    buffer_load_dwordx4 v99, s[32:35], s59 offen lds
    s_lshl_b32 m0, s54, 10
    s_mov_b32 s59, 3145728
    buffer_load_dwordx4 v104, s[32:35], s59 offen lds
    s_mov_b32 s59, 1572864
    s_add_u32 m0, s58, 49152
    s_nop 0
    buffer_load_dwordx4 v96, s[32:35], s59 offen lds
    s_add_u32 m0, s58, 50176
    s_nop 0
    buffer_load_dwordx4 v97, s[32:35], s59 offen lds
    s_add_u32 m0, s58, 51200
    s_nop 0
    buffer_load_dwordx4 v98, s[32:35], s59 offen lds
    s_add_u32 m0, s58, 52224
    s_nop 0
    buffer_load_dwordx4 v99, s[32:35], s59 offen lds
    s_lshl_b32 m0, s54, 10
    s_mov_b32 s59, 3670016
    buffer_load_dwordx4 v104, s[32:35], s59 offen lds
    s_mov_b32 s59, 2097152
    s_add_u32 m0, s58, 65536
    s_nop 0
    buffer_load_dwordx4 v96, s[32:35], s59 offen lds
    s_add_u32 m0, s58, 66560
    s_nop 0
    buffer_load_dwordx4 v97, s[32:35], s59 offen lds
    s_add_u32 m0, s58, 67584
    s_nop 0
    buffer_load_dwordx4 v98, s[32:35], s59 offen lds
    s_add_u32 m0, s58, 68608
    s_nop 0
    buffer_load_dwordx4 v99, s[32:35], s59 offen lds
    s_lshl_b32 m0, s54, 10
    s_mov_b32 s59, 0
    buffer_load_dwordx4 v104, s[36:39], s59 offen lds
    s_mov_b32 s59, 2621440
    s_add_u32 m0, s58, 81920
    s_nop 0
    buffer_load_dwordx4 v96, s[32:35], s59 offen lds
    s_add_u32 m0, s58, 82944
    s_nop 0
    buffer_load_dwordx4 v97, s[32:35], s59 offen lds
    s_add_u32 m0, s58, 83968
    s_nop 0
    buffer_load_dwordx4 v98, s[32:35], s59 offen lds
    s_add_u32 m0, s58, 84992
    s_nop 0
    buffer_load_dwordx4 v99, s[32:35], s59 offen lds
    s_lshl_b32 m0, s54, 10
    s_mov_b32 s59, 524288
    buffer_load_dwordx4 v104, s[36:39], s59 offen lds
    s_mov_b32 s59, 3145728
    s_add_u32 m0, s58, 98304
    s_nop 0
    buffer_load_dwordx4 v96, s[32:35], s59 offen lds
    s_add_u32 m0, s58, 99328
    s_nop 0
    buffer_load_dwordx4 v97, s[32:35], s59 offen lds
    s_add_u32 m0, s58, 100352
    s_nop 0
    buffer_load_dwordx4 v98, s[32:35], s59 offen lds
    s_add_u32 m0, s58, 101376
    s_nop 0
    buffer_load_dwordx4 v99, s[32:35], s59 offen lds
    s_lshl_b32 m0, s54, 10
    s_mov_b32 s59, 1048576
    buffer_load_dwordx4 v104, s[36:39], s59 offen lds
    s_mov_b32 s59, 3670016
    s_add_u32 m0, s58, 114688
    s_nop 0
    buffer_load_dwordx4 v96, s[32:35], s59 offen lds
    s_add_u32 m0, s58, 115712
    s_nop 0
    buffer_load_dwordx4 v97, s[32:35], s59 offen lds
    s_add_u32 m0, s58, 116736
    s_nop 0
    buffer_load_dwordx4 v98, s[32:35], s59 offen lds
    s_add_u32 m0, s58, 117760
    s_nop 0
    buffer_load_dwordx4 v99, s[32:35], s59 offen lds
    s_lshl_b32 m0, s54, 10
    s_mov_b32 s59, 1572864
    buffer_load_dwordx4 v104, s[36:39], s59 offen lds
    v_lshrrev_b32 v16, 4, v0
    v_and_b32 v17, 15, v0
    v_and_b32 v18, 1, v16
    v_lshlrev_b32 v18, 1, v18
    v_xor_b32 v17, v17, v18
    s_lshl_b32 s59, s54, 4
    v_add_u32_e64 v16, s59, v16
    v_bfe_u32 v2, v0, 3, 1
    v_lshlrev_b32_e64 v112, 12, v2
    v_bfe_u32 v2, v0, 5, 1
    v_lshl_add_u32 v112, v2, 11, v112
    v_lshlrev_b32_e64 v3, 3, v2
    v_bfe_u32 v2, v0, 4, 1
    v_lshl_add_u32 v112, v2, 10, v112
    v_lshl_add_u32 v3, v2, 2, v3
    v_bfe_u32 v2, v0, 2, 1
    v_lshl_add_u32 v112, v2, 8, v112
    v_lshl_add_u32 v3, v2, 1, v3
    v_bfe_u32 v2, v0, 1, 1
    s_lshl_b32 s59, s54, 2
    v_add_u32 v2, s59, v2
    v_xor_b32_e64 v2, v2, v3
    v_lshl_add_u32 v112, v2, 4, v112
    v_and_b32_e64 v2, 1, v0
    v_lshl_add_u32 v112, v2, 3, v112
    v_add_u32 v112, 32768, v112
    v_xor_b32_e64 v113, 32, v112
    v_bfe_u32 v2, v0, 4, 1
    v_lshlrev_b32_e64 v114, 12, v2
    v_bfe_u32 v2, v0, 5, 1
    v_lshl_add_u32 v114, v2, 11, v114
    v_lshlrev_b32_e64 v3, 3, v2
    v_bfe_u32 v2, v0, 3, 1
    v_lshl_add_u32 v114, v2, 10, v114
    v_lshl_add_u32 v3, v2, 2, v3
    v_bfe_u32 v2, v0, 2, 1
    v_lshl_add_u32 v114, v2, 8, v114
    v_lshl_add_u32 v3, v2, 1, v3
    v_bfe_u32 v2, v0, 1, 1
    s_lshl_b32 s59, s54, 2
    v_add_u32 v2, s59, v2
    v_xor_b32_e64 v2, v2, v3
    v_lshl_add_u32 v114, v2, 4, v114
    v_and_b32_e64 v2, 1, v0
    v_lshl_add_u32 v114, v2, 3, v114
    v_add_u32 v114, 32768, v114
    v_xor_b32_e64 v115, 32, v114
    v_add_u32 v116, 0x10000, v112
    v_add_u32 v117, 0x10000, v113
    v_add_u32 v118, 0x10000, v114
    v_add_u32 v119, 0x10000, v115
    v_lshlrev_b32 v2, 4, v0
    v_add_u32 v7, s58, v2
    v_add_u32 v7, 0x10000, v7
    v_mov_b32 v10, -1
    v_mov_b32 v11, -1
    v_mov_b32 v12, -1
    v_mov_b32 v13, -1
    v_and_b32_e64 v19, 1, v0
    v_mov_b32 v1, 0x4444
    v_mov_b32 v16, 0xeeee
    v_cmp_eq_u32 vcc, 1, v19
    s_nop 1
    v_cndmask_b32_e64 v1, v1, v16, vcc
    s_mov_b32 s82, 0xaaaaaaaa
    s_mov_b32 s83, 0xaaaaaaaa
    s_mov_b32 s68, 0x000f000f
    s_mov_b32 s69, 0x000f000f
    v_and_b32 v16, 15, v0
    v_lshrrev_b32 v17, 4, v0
    v_mul_u32_u24 v3, 1088, v17
    v_lshl_add_u32 v3, v16, 2, v3
    s_lshl_b32 s60, s54, 6
    s_add_u32 s60, s60, 24576
    v_add_u32 v3, s60, v3
    v_lshrrev_b32_e64 v18, 1, v16
    v_mul_u32_u24 v4, 544, v18
    v_lshl_add_u32 v4, v17, 4, v4
    v_add_u32 v4, 24576, v4
    v_lshrrev_b32 v18, 1, v16
    v_and_b32 v18, 2, v18
    v_xor_b32 v18, v18, v16
    v_and_b32 v18, 3, v18
    v_lshrrev_b32_e64 v20, 3, v16
    v_lshl_add_u32 v18, v20, 2, v18
    v_mul_u32_u24 v5, 544, v18
    v_lshl_add_u32 v5, v17, 4, v5
    v_add_u32 v5, 24832, v5
    v_lshrrev_b32 v18, 1, v17
    v_lshlrev_b32 v6, 8, v18
    v_lshrrev_b32_e64 v18, 1, v16
    v_lshl_add_u32 v6, v18, 5, v6
    v_and_b32_e64 v18, 1, v17
    v_lshl_add_u32 v6, v18, 4, v6
    v_lshl_add_u32 v6, v19, 3, v6
    s_lshl_b32 s60, s54, 9
    s_add_u32 s60, s60, 29184
    v_add_u32 v6, s60, v6
    v_lshrrev_b32 v18, 3, v0
    v_lshlrev_b32 v8, 11, v18
    v_and_b32_e64 v18, 7, v0
    v_lshl_add_u32 v8, v18, 3, v8
    s_lshl_b32 s60, s54, 14
    s_lshl_b32 s61, s55, 6
    s_add_u32 s60, s60, s61
    v_add_u32 v8, s60, v8
    v_lshrrev_b32 v18, 1, v17
    v_lshlrev_b32 v9, 5, v18
    v_lshlrev_b32 v24, 10, v18
    v_and_b32 v18, 3, v0
    v_lshl_add_u32 v9, v18, 2, v9
    v_lshl_add_u32 v24, v18, 2, v24
    v_and_b32_e64 v18, 1, v17
    v_lshl_add_u32 v9, v18, 4, v9
    v_lshl_add_u32 v24, v18, 5, v24
    s_lshr_b32 s60, s55, 3
    s_lshl_b32 s62, s60, 6
    s_lshl_b32 s60, s60, 9
    s_and_b32 s61, s55, 1
    s_lshl_b32 s61, s61, 4
    s_add_u32 s62, s62, s61
    s_lshl_b32 s61, s61, 4
    s_add_u32 s60, s60, s61
    s_bfe_u32 s61, s55, 0x20001
    s_lshl_b32 s59, s61, 11
    s_lshl_b32 s61, s61, 6
    s_add_u32 s60, s60, s61
    s_add_u32 s62, s62, s59
    s_lshl_b32 s61, s54, 11
    s_add_u32 s60, s60, s61
    s_lshl_b32 s61, s54, 8
    s_add_u32 s62, s62, s61
    v_add_u32_e64 v9, s60, v9
    s_and_b32 s85, s55, 3
    s_mul_i32 s85, s85, 0
    s_lshl_b32 s61, s54, 11
    s_add_u32 s85, s85, s61
    v_mov_b32 v24, 0x3f80
    v_mov_b32_e64 v25, 0x3f800000
    v_mov_b32 v26, 0x3f803f80
    v_and_b32 v18, 3, v16
    v_cmp_eq_u32 vcc, 2, v16
    s_nop 1
    v_cndmask_b32 v80, 0, v24, vcc
    v_cmp_eq_u32 vcc, 10, v16
    s_nop 1
    v_cndmask_b32 v80, v80, v25, vcc
    v_cmp_eq_u32 vcc, 0, v18
    s_nop 1
    v_cndmask_b32 v80, v80, v26, vcc
    v_cmp_eq_u32 vcc, 6, v16
    s_nop 1
    v_cndmask_b32 v81, 0, v24, vcc
    v_cmp_eq_u32 vcc, 14, v16
    s_nop 1
    v_cndmask_b32 v81, v81, v25, vcc
    v_cmp_eq_u32 vcc, 0, v18
    s_nop 1
    v_cndmask_b32 v81, v81, v26, vcc
    v_cmp_eq_u32 vcc, 3, v16
    s_nop 1
    v_cndmask_b32 v82, 0, v24, vcc
    v_cmp_eq_u32 vcc, 11, v16
    s_nop 1
    v_cndmask_b32 v82, v82, v25, vcc
    v_cmp_eq_u32 vcc, 0, v18
    s_nop 1
    v_cndmask_b32 v82, v82, v26, vcc
    v_cmp_eq_u32 vcc, 7, v16
    s_nop 1
    v_cndmask_b32 v83, 0, v24, vcc
    v_cmp_eq_u32 vcc, 15, v16
    s_nop 1
    v_cndmask_b32 v83, v83, v25, vcc
    v_cmp_eq_u32 vcc, 0, v18
    s_nop 1
    v_cndmask_b32 v83, v83, v26, vcc
    v_mov_b32 v84, 0
    v_mov_b32 v85, 0
    v_mov_b32 v86, 0
    v_mov_b32 v87, 0
    v_mov_b32 v15, 0
    s_mov_b32 s86, 0x3e0293ee
    s_mov_b32 s87, 0x3e0293ee
    s_mov_b32 s72, 0
    s_mov_b32 s73, 131072
    s_mov_b32 s74, 139264
    s_mov_b32 s75, 147456
    s_mov_b32 s76, 262144
    s_mov_b32 s77, 524288
    s_mov_b32 s78, 786432
    s_mov_b32 s84, 0
    s_lshl_b32 s101, s55, 13
    s_lshl_b32 s60, s54, 11
    s_add_u32 s94, s101, s60
    s_add_u32 s90, s94, 33554432
    s_add_u32 s91, s94, 50331648
    s_lshl_b32 s95, s54, 16
    s_lshl_b32 s61, s55, 11
    s_add_u32 s95, s95, s61
    s_lshl_b32 s100, s55, 7
    s_add_u32 s100, s100, 7348224
    s_lshl_b32 s61, s54, 2
    s_add_u32 s100, s100, s61
    s_lshr_b32 s96, s94, 1
    s_add_u32 s63, s96, 84934656
    s_add_u32 s96, s96, 84803584
    s_mov_b32 s93, 0
    s_mov_b32 s70, 0x01010101
    s_lshl_b32 s92, s55, 8
    s_add_u32 s92, s92, 7340032
    v_lshrrev_b32 v107, 2, v2
    v_lshlrev_b32 v106, 18, v17
    v_lshl_add_u32 v106, v16, 7, v106
    s_add_u32 s60, s95, 262144
    v_add_u32 v106, s60, v106
    s_lshr_b32 s60, s94, 4
    s_add_u32 s60, s60, 139264
    v_mov_b32 v105, s60
    v_cmp_eq_u32 vcc, 3, v17
    s_nop 1
    v_cndmask_b32_e64 v106, v106, v105, vcc
    s_mov_b32 s89, 0
    s_waitcnt vmcnt(36)
    s_barrier
    ds_read_b64_tr_b16 a[0:1], v112 offset:0
    ds_read_b64_tr_b16 a[2:3], v112 offset:512
    ds_read_b64_tr_b16 a[4:5], v112 offset:8192
    ds_read_b64_tr_b16 a[6:7], v112 offset:8704
    ds_read_b64_tr_b16 a[64:65], v113 offset:0
    ds_read_b64_tr_b16 a[66:67], v113 offset:512
    ds_read_b64_tr_b16 a[68:69], v113 offset:8192
    ds_read_b64_tr_b16 a[70:71], v113 offset:8704
    s_waitcnt lgkmcnt(0)
    s_waitcnt vmcnt(31)
    s_barrier
    s_mov_b32 s59, 0
    s_add_u32 m0, s58, 0
    s_nop 0
    buffer_load_dwordx4 v96, s[36:39], s59 offen lds
    s_add_u32 m0, s58, 1024
    s_nop 0
    buffer_load_dwordx4 v97, s[36:39], s59 offen lds
    s_add_u32 m0, s58, 2048
    s_nop 0
    buffer_load_dwordx4 v98, s[36:39], s59 offen lds
    s_add_u32 m0, s58, 3072
    s_nop 0
    buffer_load_dwordx4 v99, s[36:39], s59 offen lds
    s_lshl_b32 m0, s54, 10
    s_mov_b32 s59, 2097152
    buffer_load_dwordx4 v104, s[36:39], s59 offen lds
    ds_read_b64_tr_b16 a[8:9], v112 offset:16384
    ds_read_b64_tr_b16 a[10:11], v112 offset:16896
    ds_read_b64_tr_b16 a[12:13], v112 offset:24576
    ds_read_b64_tr_b16 a[14:15], v112 offset:25088
    ds_read_b64_tr_b16 a[72:73], v113 offset:16384
    ds_read_b64_tr_b16 a[74:75], v113 offset:16896
    ds_read_b64_tr_b16 a[76:77], v113 offset:24576
    ds_read_b64_tr_b16 a[78:79], v113 offset:25088
    s_waitcnt lgkmcnt(0)
    s_waitcnt vmcnt(31)
    s_barrier
    s_mov_b32 s59, 524288
    s_add_u32 m0, s58, 16384
    s_nop 0
    buffer_load_dwordx4 v96, s[36:39], s59 offen lds
    s_add_u32 m0, s58, 17408
    s_nop 0
    buffer_load_dwordx4 v97, s[36:39], s59 offen lds
    s_add_u32 m0, s58, 18432
    s_nop 0
    buffer_load_dwordx4 v98, s[36:39], s59 offen lds
    s_add_u32 m0, s58, 19456
    s_nop 0
    buffer_load_dwordx4 v99, s[36:39], s59 offen lds
    s_lshl_b32 m0, s54, 10
    s_mov_b32 s59, 2621440
    buffer_load_dwordx4 v104, s[36:39], s59 offen lds
    ds_read_b64_tr_b16 a[16:17], v112 offset:32768
    ds_read_b64_tr_b16 a[18:19], v112 offset:33280
    ds_read_b64_tr_b16 a[20:21], v112 offset:40960
    ds_read_b64_tr_b16 a[22:23], v112 offset:41472
    ds_read_b64_tr_b16 a[80:81], v113 offset:32768
    ds_read_b64_tr_b16 a[82:83], v113 offset:33280
    ds_read_b64_tr_b16 a[84:85], v113 offset:40960
    ds_read_b64_tr_b16 a[86:87], v113 offset:41472
    s_waitcnt lgkmcnt(0)
    s_waitcnt vmcnt(31)
    s_barrier
    s_mov_b32 s59, 1048576
    s_add_u32 m0, s58, 32768
    s_nop 0
    buffer_load_dwordx4 v96, s[36:39], s59 offen lds
    s_add_u32 m0, s58, 33792
    s_nop 0
    buffer_load_dwordx4 v97, s[36:39], s59 offen lds
    s_add_u32 m0, s58, 34816
    s_nop 0
    buffer_load_dwordx4 v98, s[36:39], s59 offen lds
    s_add_u32 m0, s58, 35840
    s_nop 0
    buffer_load_dwordx4 v99, s[36:39], s59 offen lds
    s_lshl_b32 m0, s54, 10
    s_mov_b32 s59, 3145728
    buffer_load_dwordx4 v104, s[36:39], s59 offen lds
    ds_read_b64_tr_b16 a[24:25], v112 offset:49152
    ds_read_b64_tr_b16 a[26:27], v112 offset:49664
    ds_read_b64_tr_b16 a[28:29], v112 offset:57344
    ds_read_b64_tr_b16 a[30:31], v112 offset:57856
    ds_read_b64_tr_b16 a[88:89], v113 offset:49152
    ds_read_b64_tr_b16 a[90:91], v113 offset:49664
    ds_read_b64_tr_b16 a[92:93], v113 offset:57344
    ds_read_b64_tr_b16 a[94:95], v113 offset:57856
    s_waitcnt lgkmcnt(0)
    s_waitcnt vmcnt(31)
    s_barrier
    s_mov_b32 s59, 1572864
    s_add_u32 m0, s58, 49152
    s_nop 0
    buffer_load_dwordx4 v96, s[36:39], s59 offen lds
    s_add_u32 m0, s58, 50176
    s_nop 0
    buffer_load_dwordx4 v97, s[36:39], s59 offen lds
    s_add_u32 m0, s58, 51200
    s_nop 0
    buffer_load_dwordx4 v98, s[36:39], s59 offen lds
    s_add_u32 m0, s58, 52224
    s_nop 0
    buffer_load_dwordx4 v99, s[36:39], s59 offen lds
    s_lshl_b32 m0, s54, 10
    s_mov_b32 s59, 3670016
    buffer_load_dwordx4 v104, s[36:39], s59 offen lds
    ds_read_b64_tr_b16 a[32:33], v116 offset:0
    ds_read_b64_tr_b16 a[34:35], v116 offset:512
    ds_read_b64_tr_b16 a[36:37], v116 offset:8192
    ds_read_b64_tr_b16 a[38:39], v116 offset:8704
    ds_read_b64_tr_b16 a[96:97], v117 offset:0
    ds_read_b64_tr_b16 a[98:99], v117 offset:512
    ds_read_b64_tr_b16 a[100:101], v117 offset:8192
    ds_read_b64_tr_b16 a[102:103], v117 offset:8704
    s_waitcnt lgkmcnt(0)
    s_waitcnt vmcnt(31)
    s_barrier
    s_mov_b32 s59, 2097152
    s_add_u32 m0, s58, 65536
    s_nop 0
    buffer_load_dwordx4 v96, s[36:39], s59 offen lds
    s_add_u32 m0, s58, 66560
    s_nop 0
    buffer_load_dwordx4 v97, s[36:39], s59 offen lds
    s_add_u32 m0, s58, 67584
    s_nop 0
    buffer_load_dwordx4 v98, s[36:39], s59 offen lds
    s_add_u32 m0, s58, 68608
    s_nop 0
    buffer_load_dwordx4 v99, s[36:39], s59 offen lds
    s_lshl_b32 m0, s54, 10
    s_mov_b32 s59, 0
    buffer_load_dwordx4 v104, s[40:43], s59 offen lds
    ds_read_b64_tr_b16 a[40:41], v116 offset:16384
    ds_read_b64_tr_b16 a[42:43], v116 offset:16896
    ds_read_b64_tr_b16 a[44:45], v116 offset:24576
    ds_read_b64_tr_b16 a[46:47], v116 offset:25088
    ds_read_b64_tr_b16 a[104:105], v117 offset:16384
    ds_read_b64_tr_b16 a[106:107], v117 offset:16896
    ds_read_b64_tr_b16 a[108:109], v117 offset:24576
    ds_read_b64_tr_b16 a[110:111], v117 offset:25088
    s_waitcnt lgkmcnt(0)
    s_waitcnt vmcnt(31)
    s_barrier
    s_mov_b32 s59, 2621440
    s_add_u32 m0, s58, 81920
    s_nop 0
    buffer_load_dwordx4 v96, s[36:39], s59 offen lds
    s_add_u32 m0, s58, 82944
    s_nop 0
    buffer_load_dwordx4 v97, s[36:39], s59 offen lds
    s_add_u32 m0, s58, 83968
    s_nop 0
    buffer_load_dwordx4 v98, s[36:39], s59 offen lds
    s_add_u32 m0, s58, 84992
    s_nop 0
    buffer_load_dwordx4 v99, s[36:39], s59 offen lds
    s_lshl_b32 m0, s54, 10
    s_mov_b32 s59, 524288
    buffer_load_dwordx4 v104, s[40:43], s59 offen lds
    ds_read_b64_tr_b16 a[48:49], v116 offset:32768
    ds_read_b64_tr_b16 a[50:51], v116 offset:33280
    ds_read_b64_tr_b16 a[52:53], v116 offset:40960
    ds_read_b64_tr_b16 a[54:55], v116 offset:41472
    ds_read_b64_tr_b16 a[112:113], v117 offset:32768
    ds_read_b64_tr_b16 a[114:115], v117 offset:33280
    ds_read_b64_tr_b16 a[116:117], v117 offset:40960
    ds_read_b64_tr_b16 a[118:119], v117 offset:41472
    s_waitcnt lgkmcnt(0)
    s_waitcnt vmcnt(31)
    s_barrier
    s_mov_b32 s59, 3145728
    s_add_u32 m0, s58, 98304
    s_nop 0
    buffer_load_dwordx4 v96, s[36:39], s59 offen lds
    s_add_u32 m0, s58, 99328
    s_nop 0
    buffer_load_dwordx4 v97, s[36:39], s59 offen lds
    s_add_u32 m0, s58, 100352
    s_nop 0
    buffer_load_dwordx4 v98, s[36:39], s59 offen lds
    s_add_u32 m0, s58, 101376
    s_nop 0
    buffer_load_dwordx4 v99, s[36:39], s59 offen lds
    s_lshl_b32 m0, s54, 10
    s_mov_b32 s59, 1048576
    buffer_load_dwordx4 v104, s[40:43], s59 offen lds
    ds_read_b64_tr_b16 a[56:57], v116 offset:49152
    ds_read_b64_tr_b16 a[58:59], v116 offset:49664
    ds_read_b64_tr_b16 a[60:61], v116 offset:57344
    ds_read_b64_tr_b16 a[62:63], v116 offset:57856
    ds_read_b64_tr_b16 a[120:121], v117 offset:49152
    ds_read_b64_tr_b16 a[122:123], v117 offset:49664
    ds_read_b64_tr_b16 a[124:125], v117 offset:57344
    ds_read_b64_tr_b16 a[126:127], v117 offset:57856
    s_waitcnt lgkmcnt(0)
    s_waitcnt vmcnt(31)
    s_barrier
    s_mov_b32 s59, 3670016
    s_add_u32 m0, s58, 114688
    s_nop 0
    buffer_load_dwordx4 v96, s[36:39], s59 offen lds
    s_add_u32 m0, s58, 115712
    s_nop 0
    buffer_load_dwordx4 v97, s[36:39], s59 offen lds
    s_add_u32 m0, s58, 116736
    s_nop 0
    buffer_load_dwordx4 v98, s[36:39], s59 offen lds
    s_add_u32 m0, s58, 117760
    s_nop 0
    buffer_load_dwordx4 v99, s[36:39], s59 offen lds
    s_lshl_b32 m0, s54, 10
    s_mov_b32 s59, 1572864
    buffer_load_dwordx4 v104, s[40:43], s59 offen lds
    ds_read_b64_tr_b16 a[128:129], v112 offset:0
    ds_read_b64_tr_b16 a[130:131], v112 offset:512
    ds_read_b64_tr_b16 a[132:133], v112 offset:8192
    ds_read_b64_tr_b16 a[134:135], v112 offset:8704
    ds_read_b64_tr_b16 a[192:193], v113 offset:0
    ds_read_b64_tr_b16 a[194:195], v113 offset:512
    ds_read_b64_tr_b16 a[196:197], v113 offset:8192
    ds_read_b64_tr_b16 a[198:199], v113 offset:8704
    s_waitcnt lgkmcnt(0)
    s_waitcnt vmcnt(31)
    s_barrier
    s_mov_b32 s59, 0
    s_add_u32 m0, s58, 0
    s_nop 0
    buffer_load_dwordx4 v96, s[40:43], s59 offen lds
    s_add_u32 m0, s58, 1024
    s_nop 0
    buffer_load_dwordx4 v97, s[40:43], s59 offen lds
    s_add_u32 m0, s58, 2048
    s_nop 0
    buffer_load_dwordx4 v98, s[40:43], s59 offen lds
    s_add_u32 m0, s58, 3072
    s_nop 0
    buffer_load_dwordx4 v99, s[40:43], s59 offen lds
    s_lshl_b32 m0, s54, 10
    s_mov_b32 s59, 2097152
    buffer_load_dwordx4 v104, s[40:43], s59 offen lds
    ds_read_b64_tr_b16 a[136:137], v112 offset:16384
    ds_read_b64_tr_b16 a[138:139], v112 offset:16896
    ds_read_b64_tr_b16 a[140:141], v112 offset:24576
    ds_read_b64_tr_b16 a[142:143], v112 offset:25088
    ds_read_b64_tr_b16 a[200:201], v113 offset:16384
    ds_read_b64_tr_b16 a[202:203], v113 offset:16896
    ds_read_b64_tr_b16 a[204:205], v113 offset:24576
    ds_read_b64_tr_b16 a[206:207], v113 offset:25088
    s_waitcnt lgkmcnt(0)
    s_waitcnt vmcnt(31)
    s_barrier
    s_mov_b32 s59, 524288
    s_add_u32 m0, s58, 16384
    s_nop 0
    buffer_load_dwordx4 v96, s[40:43], s59 offen lds
    s_add_u32 m0, s58, 17408
    s_nop 0
    buffer_load_dwordx4 v97, s[40:43], s59 offen lds
    s_add_u32 m0, s58, 18432
    s_nop 0
    buffer_load_dwordx4 v98, s[40:43], s59 offen lds
    s_add_u32 m0, s58, 19456
    s_nop 0
    buffer_load_dwordx4 v99, s[40:43], s59 offen lds
    s_lshl_b32 m0, s54, 10
    s_mov_b32 s59, 2621440
    buffer_load_dwordx4 v104, s[40:43], s59 offen lds
    ds_read_b64_tr_b16 a[144:145], v112 offset:32768
    ds_read_b64_tr_b16 a[146:147], v112 offset:33280
    ds_read_b64_tr_b16 a[148:149], v112 offset:40960
    ds_read_b64_tr_b16 a[150:151], v112 offset:41472
    ds_read_b64_tr_b16 a[208:209], v113 offset:32768
    ds_read_b64_tr_b16 a[210:211], v113 offset:33280
    ds_read_b64_tr_b16 a[212:213], v113 offset:40960
    ds_read_b64_tr_b16 a[214:215], v113 offset:41472
    s_waitcnt lgkmcnt(0)
    s_waitcnt vmcnt(31)
    s_barrier
    s_mov_b32 s59, 1048576
    s_add_u32 m0, s58, 32768
    s_nop 0
    buffer_load_dwordx4 v96, s[40:43], s59 offen lds
    s_add_u32 m0, s58, 33792
    s_nop 0
    buffer_load_dwordx4 v97, s[40:43], s59 offen lds
    s_add_u32 m0, s58, 34816
    s_nop 0
    buffer_load_dwordx4 v98, s[40:43], s59 offen lds
    s_add_u32 m0, s58, 35840
    s_nop 0
    buffer_load_dwordx4 v99, s[40:43], s59 offen lds
    s_lshl_b32 m0, s54, 10
    s_mov_b32 s59, 3145728
    buffer_load_dwordx4 v104, s[40:43], s59 offen lds
    ds_read_b64_tr_b16 a[152:153], v112 offset:49152
    ds_read_b64_tr_b16 a[154:155], v112 offset:49664
    ds_read_b64_tr_b16 a[156:157], v112 offset:57344
    ds_read_b64_tr_b16 a[158:159], v112 offset:57856
    ds_read_b64_tr_b16 a[216:217], v113 offset:49152
    ds_read_b64_tr_b16 a[218:219], v113 offset:49664
    ds_read_b64_tr_b16 a[220:221], v113 offset:57344
    ds_read_b64_tr_b16 a[222:223], v113 offset:57856
    s_waitcnt lgkmcnt(0)
    s_waitcnt vmcnt(31)
    s_barrier
    s_mov_b32 s59, 1572864
    s_add_u32 m0, s58, 49152
    s_nop 0
    buffer_load_dwordx4 v96, s[40:43], s59 offen lds
    s_add_u32 m0, s58, 50176
    s_nop 0
    buffer_load_dwordx4 v97, s[40:43], s59 offen lds
    s_add_u32 m0, s58, 51200
    s_nop 0
    buffer_load_dwordx4 v98, s[40:43], s59 offen lds
    s_add_u32 m0, s58, 52224
    s_nop 0
    buffer_load_dwordx4 v99, s[40:43], s59 offen lds
    s_lshl_b32 m0, s54, 10
    s_mov_b32 s59, 3670016
    buffer_load_dwordx4 v104, s[40:43], s59 offen lds
    ds_read_b64_tr_b16 a[160:161], v116 offset:0
    ds_read_b64_tr_b16 a[162:163], v116 offset:512
    ds_read_b64_tr_b16 a[164:165], v116 offset:8192
    ds_read_b64_tr_b16 a[166:167], v116 offset:8704
    ds_read_b64_tr_b16 a[224:225], v117 offset:0
    ds_read_b64_tr_b16 a[226:227], v117 offset:512
    ds_read_b64_tr_b16 a[228:229], v117 offset:8192
    ds_read_b64_tr_b16 a[230:231], v117 offset:8704
    s_waitcnt lgkmcnt(0)
    s_waitcnt vmcnt(31)
    s_barrier
    s_mov_b32 s59, 2097152
    s_add_u32 m0, s58, 65536
    s_nop 0
    buffer_load_dwordx4 v96, s[40:43], s59 offen lds
    s_add_u32 m0, s58, 66560
    s_nop 0
    buffer_load_dwordx4 v97, s[40:43], s59 offen lds
    s_add_u32 m0, s58, 67584
    s_nop 0
    buffer_load_dwordx4 v98, s[40:43], s59 offen lds
    s_add_u32 m0, s58, 68608
    s_nop 0
    buffer_load_dwordx4 v99, s[40:43], s59 offen lds
    ds_read_b64_tr_b16 a[168:169], v116 offset:16384
    ds_read_b64_tr_b16 a[170:171], v116 offset:16896
    ds_read_b64_tr_b16 a[172:173], v116 offset:24576
    ds_read_b64_tr_b16 a[174:175], v116 offset:25088
    ds_read_b64_tr_b16 a[232:233], v117 offset:16384
    ds_read_b64_tr_b16 a[234:235], v117 offset:16896
    ds_read_b64_tr_b16 a[236:237], v117 offset:24576
    ds_read_b64_tr_b16 a[238:239], v117 offset:25088
    s_waitcnt lgkmcnt(0)
    s_waitcnt vmcnt(30)
    s_barrier
    s_mov_b32 s59, 2621440
    s_add_u32 m0, s58, 81920
    s_nop 0
    buffer_load_dwordx4 v96, s[40:43], s59 offen lds
    s_add_u32 m0, s58, 82944
    s_nop 0
    buffer_load_dwordx4 v97, s[40:43], s59 offen lds
    s_add_u32 m0, s58, 83968
    s_nop 0
    buffer_load_dwordx4 v98, s[40:43], s59 offen lds
    s_add_u32 m0, s58, 84992
    s_nop 0
    buffer_load_dwordx4 v99, s[40:43], s59 offen lds
    ds_read_b64_tr_b16 a[176:177], v116 offset:32768
    ds_read_b64_tr_b16 a[178:179], v116 offset:33280
    ds_read_b64_tr_b16 a[180:181], v116 offset:40960
    ds_read_b64_tr_b16 a[182:183], v116 offset:41472
    ds_read_b64_tr_b16 a[240:241], v117 offset:32768
    ds_read_b64_tr_b16 a[242:243], v117 offset:33280
    ds_read_b64_tr_b16 a[244:245], v117 offset:40960
    ds_read_b64_tr_b16 a[246:247], v117 offset:41472
    s_waitcnt lgkmcnt(0)
    s_waitcnt vmcnt(29)
    s_barrier
    s_mov_b32 s59, 3145728
    s_add_u32 m0, s58, 98304
    s_nop 0
    buffer_load_dwordx4 v96, s[40:43], s59 offen lds
    s_add_u32 m0, s58, 99328
    s_nop 0
    buffer_load_dwordx4 v97, s[40:43], s59 offen lds
    s_add_u32 m0, s58, 100352
    s_nop 0
    buffer_load_dwordx4 v98, s[40:43], s59 offen lds
    s_add_u32 m0, s58, 101376
    s_nop 0
    buffer_load_dwordx4 v99, s[40:43], s59 offen lds
    ds_read_b64_tr_b16 a[184:185], v116 offset:49152
    ds_read_b64_tr_b16 a[186:187], v116 offset:49664
    ds_read_b64_tr_b16 a[188:189], v116 offset:57344
    ds_read_b64_tr_b16 a[190:191], v116 offset:57856
    ds_read_b64_tr_b16 a[248:249], v117 offset:49152
    ds_read_b64_tr_b16 a[250:251], v117 offset:49664
    ds_read_b64_tr_b16 a[252:253], v117 offset:57344
    ds_read_b64_tr_b16 a[254:255], v117 offset:57856
    s_waitcnt lgkmcnt(0)
    s_waitcnt vmcnt(28)
    s_barrier
    s_mov_b32 s59, 3670016
    s_add_u32 m0, s58, 114688
    s_nop 0
    buffer_load_dwordx4 v96, s[40:43], s59 offen lds
    s_add_u32 m0, s58, 115712
    s_nop 0
    buffer_load_dwordx4 v97, s[40:43], s59 offen lds
    s_add_u32 m0, s58, 116736
    s_nop 0
    buffer_load_dwordx4 v98, s[40:43], s59 offen lds
    s_add_u32 m0, s58, 117760
    s_nop 0
    buffer_load_dwordx4 v99, s[40:43], s59 offen lds
    s_cmp_lg_u32 s54, 0
    s_cbranch_scc1 wv_2
    ds_read_b64_tr_b16 v[16:17], v112 offset:0
    ds_read_b64_tr_b16 v[18:19], v112 offset:512
    ds_read_b64_tr_b16 v[20:21], v112 offset:8192
    ds_read_b64_tr_b16 v[22:23], v112 offset:8704
    ds_read_b64_tr_b16 v[24:25], v113 offset:0
    ds_read_b64_tr_b16 v[26:27], v113 offset:512
    ds_read_b64_tr_b16 v[28:29], v113 offset:8192
    ds_read_b64_tr_b16 v[30:31], v113 offset:8704
    s_branch wv_1
wv_2:
    s_cmp_lg_u32 s54, 1
    s_cbranch_scc1 wv_3
    ds_read_b64_tr_b16 v[48:49], v112 offset:0
    ds_read_b64_tr_b16 v[50:51], v112 offset:512
    ds_read_b64_tr_b16 v[52:53], v112 offset:8192
    ds_read_b64_tr_b16 v[54:55], v112 offset:8704
    ds_read_b64_tr_b16 v[56:57], v113 offset:0
    ds_read_b64_tr_b16 v[58:59], v113 offset:512
    ds_read_b64_tr_b16 v[60:61], v113 offset:8192
    ds_read_b64_tr_b16 v[62:63], v113 offset:8704
    s_branch wv_1
wv_3:
    s_cmp_lg_u32 s54, 2
    s_cbranch_scc1 wv_4
    ds_read_b64_tr_b16 v[48:49], v112 offset:0
    ds_read_b64_tr_b16 v[50:51], v112 offset:512
    ds_read_b64_tr_b16 v[52:53], v112 offset:8192
    ds_read_b64_tr_b16 v[54:55], v112 offset:8704
    ds_read_b64_tr_b16 v[56:57], v113 offset:0
    ds_read_b64_tr_b16 v[58:59], v113 offset:512
    ds_read_b64_tr_b16 v[60:61], v113 offset:8192
    ds_read_b64_tr_b16 v[62:63], v113 offset:8704
    s_branch wv_1
wv_4:
    ds_read_b64_tr_b16 v[48:49], v112 offset:0
    ds_read_b64_tr_b16 v[50:51], v112 offset:512
    ds_read_b64_tr_b16 v[52:53], v112 offset:8192
    ds_read_b64_tr_b16 v[54:55], v112 offset:8704
    ds_read_b64_tr_b16 v[56:57], v113 offset:0
    ds_read_b64_tr_b16 v[58:59], v113 offset:512
    ds_read_b64_tr_b16 v[60:61], v113 offset:8192
    ds_read_b64_tr_b16 v[62:63], v113 offset:8704
wv_1:
    s_waitcnt lgkmcnt(0)
    s_waitcnt vmcnt(27)
    s_barrier
    s_add_u32 s59, s12, 0
    s_add_u32 m0, s58, 0
    s_nop 0
    buffer_load_dwordx4 v100, s[44:47], s59 offen lds
    s_add_u32 m0, s58, 1024
    s_nop 0
    buffer_load_dwordx4 v101, s[44:47], s59 offen lds
    s_add_u32 m0, s58, 2048
    s_nop 0
    buffer_load_dwordx4 v102, s[44:47], s59 offen lds
    s_add_u32 m0, s58, 3072
    s_nop 0
    buffer_load_dwordx4 v103, s[44:47], s59 offen lds
    s_cmp_lg_u32 s54, 0
    s_cbranch_scc1 wv_7
    ds_read_b64_tr_b16 v[32:33], v112 offset:16384
    ds_read_b64_tr_b16 v[34:35], v112 offset:16896
    ds_read_b64_tr_b16 v[36:37], v112 offset:24576
    ds_read_b64_tr_b16 v[38:39], v112 offset:25088
    ds_read_b64_tr_b16 v[40:41], v113 offset:16384
    ds_read_b64_tr_b16 v[42:43], v113 offset:16896
    ds_read_b64_tr_b16 v[44:45], v113 offset:24576
    ds_read_b64_tr_b16 v[46:47], v113 offset:25088
    s_branch wv_6
wv_7:
    s_cmp_lg_u32 s54, 1
    s_cbranch_scc1 wv_8
    ds_read_b64_tr_b16 v[64:65], v112 offset:16384
    ds_read_b64_tr_b16 v[66:67], v112 offset:16896
    ds_read_b64_tr_b16 v[68:69], v112 offset:24576
    ds_read_b64_tr_b16 v[70:71], v112 offset:25088
    ds_read_b64_tr_b16 v[72:73], v113 offset:16384
    ds_read_b64_tr_b16 v[74:75], v113 offset:16896
    ds_read_b64_tr_b16 v[76:77], v113 offset:24576
    ds_read_b64_tr_b16 v[78:79], v113 offset:25088
    s_branch wv_6
wv_8:
    s_cmp_lg_u32 s54, 2
    s_cbranch_scc1 wv_9
    ds_read_b64_tr_b16 v[64:65], v112 offset:16384
    ds_read_b64_tr_b16 v[66:67], v112 offset:16896
    ds_read_b64_tr_b16 v[68:69], v112 offset:24576
    ds_read_b64_tr_b16 v[70:71], v112 offset:25088
    ds_read_b64_tr_b16 v[72:73], v113 offset:16384
    ds_read_b64_tr_b16 v[74:75], v113 offset:16896
    ds_read_b64_tr_b16 v[76:77], v113 offset:24576
    ds_read_b64_tr_b16 v[78:79], v113 offset:25088
    s_branch wv_6
wv_9:
    ds_read_b64_tr_b16 v[64:65], v112 offset:16384
    ds_read_b64_tr_b16 v[66:67], v112 offset:16896
    ds_read_b64_tr_b16 v[68:69], v112 offset:24576
    ds_read_b64_tr_b16 v[70:71], v112 offset:25088
    ds_read_b64_tr_b16 v[72:73], v113 offset:16384
    ds_read_b64_tr_b16 v[74:75], v113 offset:16896
    ds_read_b64_tr_b16 v[76:77], v113 offset:24576
    ds_read_b64_tr_b16 v[78:79], v113 offset:25088
wv_6:
    s_waitcnt lgkmcnt(0)
    s_waitcnt vmcnt(26)
    s_barrier
    s_add_u32 s59, s12, 65536
    s_add_u32 m0, s58, 16384
    s_nop 0
    buffer_load_dwordx4 v100, s[44:47], s59 offen lds
    s_add_u32 m0, s58, 17408
    s_nop 0
    buffer_load_dwordx4 v101, s[44:47], s59 offen lds
    s_add_u32 m0, s58, 18432
    s_nop 0
    buffer_load_dwordx4 v102, s[44:47], s59 offen lds
    s_add_u32 m0, s58, 19456
    s_nop 0
    buffer_load_dwordx4 v103, s[44:47], s59 offen lds
    s_cmp_lg_u32 s54, 0
    s_cbranch_scc1 wv_12
    ds_read_b64_tr_b16 v[48:49], v112 offset:32768
    ds_read_b64_tr_b16 v[50:51], v112 offset:33280
    ds_read_b64_tr_b16 v[52:53], v112 offset:40960
    ds_read_b64_tr_b16 v[54:55], v112 offset:41472
    ds_read_b64_tr_b16 v[56:57], v113 offset:32768
    ds_read_b64_tr_b16 v[58:59], v113 offset:33280
    ds_read_b64_tr_b16 v[60:61], v113 offset:40960
    ds_read_b64_tr_b16 v[62:63], v113 offset:41472
    s_branch wv_11
wv_12:
    s_cmp_lg_u32 s54, 1
    s_cbranch_scc1 wv_13
    ds_read_b64_tr_b16 v[16:17], v112 offset:32768
    ds_read_b64_tr_b16 v[18:19], v112 offset:33280
    ds_read_b64_tr_b16 v[20:21], v112 offset:40960
    ds_read_b64_tr_b16 v[22:23], v112 offset:41472
    ds_read_b64_tr_b16 v[24:25], v113 offset:32768
    ds_read_b64_tr_b16 v[26:27], v113 offset:33280
    ds_read_b64_tr_b16 v[28:29], v113 offset:40960
    ds_read_b64_tr_b16 v[30:31], v113 offset:41472
    s_branch wv_11
wv_13:
    s_cmp_lg_u32 s54, 2
    s_cbranch_scc1 wv_14
    ds_read_b64_tr_b16 v[160:161], v112 offset:32768
    ds_read_b64_tr_b16 v[162:163], v112 offset:33280
    ds_read_b64_tr_b16 v[164:165], v112 offset:40960
    ds_read_b64_tr_b16 v[166:167], v112 offset:41472
    ds_read_b64_tr_b16 v[224:225], v113 offset:32768
    ds_read_b64_tr_b16 v[226:227], v113 offset:33280
    ds_read_b64_tr_b16 v[228:229], v113 offset:40960
    ds_read_b64_tr_b16 v[230:231], v113 offset:41472
    s_branch wv_11
wv_14:
    ds_read_b64_tr_b16 v[160:161], v112 offset:32768
    ds_read_b64_tr_b16 v[162:163], v112 offset:33280
    ds_read_b64_tr_b16 v[164:165], v112 offset:40960
    ds_read_b64_tr_b16 v[166:167], v112 offset:41472
    ds_read_b64_tr_b16 v[224:225], v113 offset:32768
    ds_read_b64_tr_b16 v[226:227], v113 offset:33280
    ds_read_b64_tr_b16 v[228:229], v113 offset:40960
    ds_read_b64_tr_b16 v[230:231], v113 offset:41472
wv_11:
    s_waitcnt lgkmcnt(0)
    s_waitcnt vmcnt(25)
    s_barrier
    s_add_u32 s59, s12, 256
    s_add_u32 m0, s58, 32768
    s_nop 0
    buffer_load_dwordx4 v100, s[44:47], s59 offen lds
    s_add_u32 m0, s58, 33792
    s_nop 0
    buffer_load_dwordx4 v101, s[44:47], s59 offen lds
    s_add_u32 m0, s58, 34816
    s_nop 0
    buffer_load_dwordx4 v102, s[44:47], s59 offen lds
    s_add_u32 m0, s58, 35840
    s_nop 0
    buffer_load_dwordx4 v103, s[44:47], s59 offen lds
    s_cmp_lg_u32 s54, 0
    s_cbranch_scc1 wv_17
    ds_read_b64_tr_b16 v[64:65], v112 offset:49152
    ds_read_b64_tr_b16 v[66:67], v112 offset:49664
    ds_read_b64_tr_b16 v[68:69], v112 offset:57344
    ds_read_b64_tr_b16 v[70:71], v112 offset:57856
    ds_read_b64_tr_b16 v[72:73], v113 offset:49152
    ds_read_b64_tr_b16 v[74:75], v113 offset:49664
    ds_read_b64_tr_b16 v[76:77], v113 offset:57344
    ds_read_b64_tr_b16 v[78:79], v113 offset:57856
    s_branch wv_16
wv_17:
    s_cmp_lg_u32 s54, 1
    s_cbranch_scc1 wv_18
    ds_read_b64_tr_b16 v[32:33], v112 offset:49152
    ds_read_b64_tr_b16 v[34:35], v112 offset:49664
    ds_read_b64_tr_b16 v[36:37], v112 offset:57344
    ds_read_b64_tr_b16 v[38:39], v112 offset:57856
    ds_read_b64_tr_b16 v[40:41], v113 offset:49152
    ds_read_b64_tr_b16 v[42:43], v113 offset:49664
    ds_read_b64_tr_b16 v[44:45], v113 offset:57344
    ds_read_b64_tr_b16 v[46:47], v113 offset:57856
    s_branch wv_16
wv_18:
    s_cmp_lg_u32 s54, 2
    s_cbranch_scc1 wv_19
    ds_read_b64_tr_b16 v[168:169], v112 offset:49152
    ds_read_b64_tr_b16 v[170:171], v112 offset:49664
    ds_read_b64_tr_b16 v[172:173], v112 offset:57344
    ds_read_b64_tr_b16 v[174:175], v112 offset:57856
    ds_read_b64_tr_b16 v[232:233], v113 offset:49152
    ds_read_b64_tr_b16 v[234:235], v113 offset:49664
    ds_read_b64_tr_b16 v[236:237], v113 offset:57344
    ds_read_b64_tr_b16 v[238:239], v113 offset:57856
    s_branch wv_16
wv_19:
    ds_read_b64_tr_b16 v[168:169], v112 offset:49152
    ds_read_b64_tr_b16 v[170:171], v112 offset:49664
    ds_read_b64_tr_b16 v[172:173], v112 offset:57344
    ds_read_b64_tr_b16 v[174:175], v112 offset:57856
    ds_read_b64_tr_b16 v[232:233], v113 offset:49152
    ds_read_b64_tr_b16 v[234:235], v113 offset:49664
    ds_read_b64_tr_b16 v[236:237], v113 offset:57344
    ds_read_b64_tr_b16 v[238:239], v113 offset:57856
wv_16:
    s_waitcnt lgkmcnt(0)
    s_waitcnt vmcnt(24)
    s_barrier
    s_add_u32 s59, s12, 65792
    s_add_u32 m0, s58, 49152
    s_nop 0
    buffer_load_dwordx4 v100, s[44:47], s59 offen lds
    s_add_u32 m0, s58, 50176
    s_nop 0
    buffer_load_dwordx4 v101, s[44:47], s59 offen lds
    s_add_u32 m0, s58, 51200
    s_nop 0
    buffer_load_dwordx4 v102, s[44:47], s59 offen lds
    s_add_u32 m0, s58, 52224
    s_nop 0
    buffer_load_dwordx4 v103, s[44:47], s59 offen lds
    s_cmp_lg_u32 s54, 0
    s_cbranch_scc1 wv_22
    ds_read_b64_tr_b16 v[160:161], v116 offset:0
    ds_read_b64_tr_b16 v[162:163], v116 offset:512
    ds_read_b64_tr_b16 v[164:165], v116 offset:8192
    ds_read_b64_tr_b16 v[166:167], v116 offset:8704
    ds_read_b64_tr_b16 v[224:225], v117 offset:0
    ds_read_b64_tr_b16 v[226:227], v117 offset:512
    ds_read_b64_tr_b16 v[228:229], v117 offset:8192
    ds_read_b64_tr_b16 v[230:231], v117 offset:8704
    s_branch wv_21
wv_22:
    s_cmp_lg_u32 s54, 1
    s_cbranch_scc1 wv_23
    ds_read_b64_tr_b16 v[160:161], v116 offset:0
    ds_read_b64_tr_b16 v[162:163], v116 offset:512
    ds_read_b64_tr_b16 v[164:165], v116 offset:8192
    ds_read_b64_tr_b16 v[166:167], v116 offset:8704
    ds_read_b64_tr_b16 v[224:225], v117 offset:0
    ds_read_b64_tr_b16 v[226:227], v117 offset:512
    ds_read_b64_tr_b16 v[228:229], v117 offset:8192
    ds_read_b64_tr_b16 v[230:231], v117 offset:8704
    s_branch wv_21
wv_23:
    s_cmp_lg_u32 s54, 2
    s_cbranch_scc1 wv_24
    ds_read_b64_tr_b16 v[16:17], v116 offset:0
    ds_read_b64_tr_b16 v[18:19], v116 offset:512
    ds_read_b64_tr_b16 v[20:21], v116 offset:8192
    ds_read_b64_tr_b16 v[22:23], v116 offset:8704
    ds_read_b64_tr_b16 v[24:25], v117 offset:0
    ds_read_b64_tr_b16 v[26:27], v117 offset:512
    ds_read_b64_tr_b16 v[28:29], v117 offset:8192
    ds_read_b64_tr_b16 v[30:31], v117 offset:8704
    s_branch wv_21
wv_24:
    ds_read_b64_tr_b16 v[176:177], v116 offset:0
    ds_read_b64_tr_b16 v[178:179], v116 offset:512
    ds_read_b64_tr_b16 v[180:181], v116 offset:8192
    ds_read_b64_tr_b16 v[182:183], v116 offset:8704
    ds_read_b64_tr_b16 v[240:241], v117 offset:0
    ds_read_b64_tr_b16 v[242:243], v117 offset:512
    ds_read_b64_tr_b16 v[244:245], v117 offset:8192
    ds_read_b64_tr_b16 v[246:247], v117 offset:8704
wv_21:
    s_waitcnt lgkmcnt(0)
    s_waitcnt vmcnt(24)
    s_barrier
    s_add_u32 s59, s12, 512
    s_add_u32 m0, s58, 65536
    s_nop 0
    buffer_load_dwordx4 v100, s[44:47], s59 offen lds
    s_add_u32 m0, s58, 66560
    s_nop 0
    buffer_load_dwordx4 v101, s[44:47], s59 offen lds
    s_add_u32 m0, s58, 67584
    s_nop 0
    buffer_load_dwordx4 v102, s[44:47], s59 offen lds
    s_add_u32 m0, s58, 68608
    s_nop 0
    buffer_load_dwordx4 v103, s[44:47], s59 offen lds
    s_cmp_lg_u32 s54, 0
    s_cbranch_scc1 wv_27
    ds_read_b64_tr_b16 v[168:169], v116 offset:16384
    ds_read_b64_tr_b16 v[170:171], v116 offset:16896
    ds_read_b64_tr_b16 v[172:173], v116 offset:24576
    ds_read_b64_tr_b16 v[174:175], v116 offset:25088
    ds_read_b64_tr_b16 v[232:233], v117 offset:16384
    ds_read_b64_tr_b16 v[234:235], v117 offset:16896
    ds_read_b64_tr_b16 v[236:237], v117 offset:24576
    ds_read_b64_tr_b16 v[238:239], v117 offset:25088
    s_branch wv_26
wv_27:
    s_cmp_lg_u32 s54, 1
    s_cbranch_scc1 wv_28
    ds_read_b64_tr_b16 v[168:169], v116 offset:16384
    ds_read_b64_tr_b16 v[170:171], v116 offset:16896
    ds_read_b64_tr_b16 v[172:173], v116 offset:24576
    ds_read_b64_tr_b16 v[174:175], v116 offset:25088
    ds_read_b64_tr_b16 v[232:233], v117 offset:16384
    ds_read_b64_tr_b16 v[234:235], v117 offset:16896
    ds_read_b64_tr_b16 v[236:237], v117 offset:24576
    ds_read_b64_tr_b16 v[238:239], v117 offset:25088
    s_branch wv_26
wv_28:
    s_cmp_lg_u32 s54, 2
    s_cbranch_scc1 wv_29
    ds_read_b64_tr_b16 v[32:33], v116 offset:16384
    ds_read_b64_tr_b16 v[34:35], v116 offset:16896
    ds_read_b64_tr_b16 v[36:37], v116 offset:24576
    ds_read_b64_tr_b16 v[38:39], v116 offset:25088
    ds_read_b64_tr_b16 v[40:41], v117 offset:16384
    ds_read_b64_tr_b16 v[42:43], v117 offset:16896
    ds_read_b64_tr_b16 v[44:45], v117 offset:24576
    ds_read_b64_tr_b16 v[46:47], v117 offset:25088
    s_branch wv_26
wv_29:
    ds_read_b64_tr_b16 v[184:185], v116 offset:16384
    ds_read_b64_tr_b16 v[186:187], v116 offset:16896
    ds_read_b64_tr_b16 v[188:189], v116 offset:24576
    ds_read_b64_tr_b16 v[190:191], v116 offset:25088
    ds_read_b64_tr_b16 v[248:249], v117 offset:16384
    ds_read_b64_tr_b16 v[250:251], v117 offset:16896
    ds_read_b64_tr_b16 v[252:253], v117 offset:24576
    ds_read_b64_tr_b16 v[254:255], v117 offset:25088
wv_26:
    s_waitcnt lgkmcnt(0)
    s_waitcnt vmcnt(24)
    s_barrier
    s_add_u32 s59, s12, 66048
    s_add_u32 m0, s58, 81920
    s_nop 0
    buffer_load_dwordx4 v100, s[44:47], s59 offen lds
    s_add_u32 m0, s58, 82944
    s_nop 0
    buffer_load_dwordx4 v101, s[44:47], s59 offen lds
    s_add_u32 m0, s58, 83968
    s_nop 0
    buffer_load_dwordx4 v102, s[44:47], s59 offen lds
    s_add_u32 m0, s58, 84992
    s_nop 0
    buffer_load_dwordx4 v103, s[44:47], s59 offen lds
    s_cmp_lg_u32 s54, 0
    s_cbranch_scc1 wv_32
    ds_read_b64_tr_b16 v[176:177], v116 offset:32768
    ds_read_b64_tr_b16 v[178:179], v116 offset:33280
    ds_read_b64_tr_b16 v[180:181], v116 offset:40960
    ds_read_b64_tr_b16 v[182:183], v116 offset:41472
    ds_read_b64_tr_b16 v[240:241], v117 offset:32768
    ds_read_b64_tr_b16 v[242:243], v117 offset:33280
    ds_read_b64_tr_b16 v[244:245], v117 offset:40960
    ds_read_b64_tr_b16 v[246:247], v117 offset:41472
    s_branch wv_31
wv_32:
    s_cmp_lg_u32 s54, 1
    s_cbranch_scc1 wv_33
    ds_read_b64_tr_b16 v[176:177], v116 offset:32768
    ds_read_b64_tr_b16 v[178:179], v116 offset:33280
    ds_read_b64_tr_b16 v[180:181], v116 offset:40960
    ds_read_b64_tr_b16 v[182:183], v116 offset:41472
    ds_read_b64_tr_b16 v[240:241], v117 offset:32768
    ds_read_b64_tr_b16 v[242:243], v117 offset:33280
    ds_read_b64_tr_b16 v[244:245], v117 offset:40960
    ds_read_b64_tr_b16 v[246:247], v117 offset:41472
    s_branch wv_31
wv_33:
    s_cmp_lg_u32 s54, 2
    s_cbranch_scc1 wv_34
    ds_read_b64_tr_b16 v[176:177], v116 offset:32768
    ds_read_b64_tr_b16 v[178:179], v116 offset:33280
    ds_read_b64_tr_b16 v[180:181], v116 offset:40960
    ds_read_b64_tr_b16 v[182:183], v116 offset:41472
    ds_read_b64_tr_b16 v[240:241], v117 offset:32768
    ds_read_b64_tr_b16 v[242:243], v117 offset:33280
    ds_read_b64_tr_b16 v[244:245], v117 offset:40960
    ds_read_b64_tr_b16 v[246:247], v117 offset:41472
    s_branch wv_31
wv_34:
    ds_read_b64_tr_b16 v[16:17], v116 offset:32768
    ds_read_b64_tr_b16 v[18:19], v116 offset:33280
    ds_read_b64_tr_b16 v[20:21], v116 offset:40960
    ds_read_b64_tr_b16 v[22:23], v116 offset:41472
    ds_read_b64_tr_b16 v[24:25], v117 offset:32768
    ds_read_b64_tr_b16 v[26:27], v117 offset:33280
    ds_read_b64_tr_b16 v[28:29], v117 offset:40960
    ds_read_b64_tr_b16 v[30:31], v117 offset:41472
wv_31:
    s_waitcnt lgkmcnt(0)
    s_waitcnt vmcnt(24)
    s_barrier
    s_add_u32 s59, s12, 768
    s_add_u32 m0, s58, 98304
    s_nop 0
    buffer_load_dwordx4 v100, s[44:47], s59 offen lds
    s_add_u32 m0, s58, 99328
    s_nop 0
    buffer_load_dwordx4 v101, s[44:47], s59 offen lds
    s_add_u32 m0, s58, 100352
    s_nop 0
    buffer_load_dwordx4 v102, s[44:47], s59 offen lds
    s_add_u32 m0, s58, 101376
    s_nop 0
    buffer_load_dwordx4 v103, s[44:47], s59 offen lds
    s_cmp_lg_u32 s54, 0
    s_cbranch_scc1 wv_37
    ds_read_b64_tr_b16 v[184:185], v116 offset:49152
    ds_read_b64_tr_b16 v[186:187], v116 offset:49664
    ds_read_b64_tr_b16 v[188:189], v116 offset:57344
    ds_read_b64_tr_b16 v[190:191], v116 offset:57856
    ds_read_b64_tr_b16 v[248:249], v117 offset:49152
    ds_read_b64_tr_b16 v[250:251], v117 offset:49664
    ds_read_b64_tr_b16 v[252:253], v117 offset:57344
    ds_read_b64_tr_b16 v[254:255], v117 offset:57856
    s_branch wv_36
wv_37:
    s_cmp_lg_u32 s54, 1
    s_cbranch_scc1 wv_38
    ds_read_b64_tr_b16 v[184:185], v116 offset:49152
    ds_read_b64_tr_b16 v[186:187], v116 offset:49664
    ds_read_b64_tr_b16 v[188:189], v116 offset:57344
    ds_read_b64_tr_b16 v[190:191], v116 offset:57856
    ds_read_b64_tr_b16 v[248:249], v117 offset:49152
    ds_read_b64_tr_b16 v[250:251], v117 offset:49664
    ds_read_b64_tr_b16 v[252:253], v117 offset:57344
    ds_read_b64_tr_b16 v[254:255], v117 offset:57856
    s_branch wv_36
wv_38:
    s_cmp_lg_u32 s54, 2
    s_cbranch_scc1 wv_39
    ds_read_b64_tr_b16 v[184:185], v116 offset:49152
    ds_read_b64_tr_b16 v[186:187], v116 offset:49664
    ds_read_b64_tr_b16 v[188:189], v116 offset:57344
    ds_read_b64_tr_b16 v[190:191], v116 offset:57856
    ds_read_b64_tr_b16 v[248:249], v117 offset:49152
    ds_read_b64_tr_b16 v[250:251], v117 offset:49664
    ds_read_b64_tr_b16 v[252:253], v117 offset:57344
    ds_read_b64_tr_b16 v[254:255], v117 offset:57856
    s_branch wv_36
wv_39:
    ds_read_b64_tr_b16 v[32:33], v116 offset:49152
    ds_read_b64_tr_b16 v[34:35], v116 offset:49664
    ds_read_b64_tr_b16 v[36:37], v116 offset:57344
    ds_read_b64_tr_b16 v[38:39], v116 offset:57856
    ds_read_b64_tr_b16 v[40:41], v117 offset:49152
    ds_read_b64_tr_b16 v[42:43], v117 offset:49664
    ds_read_b64_tr_b16 v[44:45], v117 offset:57344
    ds_read_b64_tr_b16 v[46:47], v117 offset:57856
wv_36:
    s_waitcnt lgkmcnt(0)
    s_waitcnt vmcnt(24)
    s_barrier
    s_add_u32 s59, s12, 66304
    s_add_u32 m0, s58, 114688
    s_nop 0
    buffer_load_dwordx4 v100, s[44:47], s59 offen lds
    s_add_u32 m0, s58, 115712
    s_nop 0
    buffer_load_dwordx4 v101, s[44:47], s59 offen lds
    s_add_u32 m0, s58, 116736
    s_nop 0
    buffer_load_dwordx4 v102, s[44:47], s59 offen lds
    s_add_u32 m0, s58, 117760
    s_nop 0
    buffer_load_dwordx4 v103, s[44:47], s59 offen lds
    ds_read_b64_tr_b16 v[128:129], v114 offset:0
    ds_read_b64_tr_b16 v[130:131], v114 offset:512
    ds_read_b64_tr_b16 v[132:133], v114 offset:8192
    ds_read_b64_tr_b16 v[134:135], v114 offset:8704
    ds_read_b64_tr_b16 v[136:137], v115 offset:0
    ds_read_b64_tr_b16 v[138:139], v115 offset:512
    ds_read_b64_tr_b16 v[140:141], v115 offset:8192
    ds_read_b64_tr_b16 v[142:143], v115 offset:8704
    s_waitcnt lgkmcnt(0)
    s_waitcnt vmcnt(24)
    s_barrier
    ds_read_b64_tr_b16 v[192:193], v114 offset:16384
    ds_read_b64_tr_b16 v[194:195], v114 offset:16896
    ds_read_b64_tr_b16 v[196:197], v114 offset:24576
    ds_read_b64_tr_b16 v[198:199], v114 offset:25088
    ds_read_b64_tr_b16 v[200:201], v115 offset:16384
    ds_read_b64_tr_b16 v[202:203], v115 offset:16896
    ds_read_b64_tr_b16 v[204:205], v115 offset:24576
    ds_read_b64_tr_b16 v[206:207], v115 offset:25088
    s_waitcnt lgkmcnt(0)
    s_waitcnt vmcnt(20)
    s_barrier
    ds_read_b64_tr_b16 v[144:145], v114 offset:32768
    ds_read_b64_tr_b16 v[146:147], v114 offset:33280
    ds_read_b64_tr_b16 v[148:149], v114 offset:40960
    ds_read_b64_tr_b16 v[150:151], v114 offset:41472
    ds_read_b64_tr_b16 v[152:153], v115 offset:32768
    ds_read_b64_tr_b16 v[154:155], v115 offset:33280
    ds_read_b64_tr_b16 v[156:157], v115 offset:40960
    ds_read_b64_tr_b16 v[158:159], v115 offset:41472
    s_waitcnt lgkmcnt(0)
    s_waitcnt vmcnt(16)
    s_barrier
    ds_read_b64_tr_b16 v[208:209], v114 offset:49152
    ds_read_b64_tr_b16 v[210:211], v114 offset:49664
    ds_read_b64_tr_b16 v[212:213], v114 offset:57344
    ds_read_b64_tr_b16 v[214:215], v114 offset:57856
    ds_read_b64_tr_b16 v[216:217], v115 offset:49152
    ds_read_b64_tr_b16 v[218:219], v115 offset:49664
    ds_read_b64_tr_b16 v[220:221], v115 offset:57344
    ds_read_b64_tr_b16 v[222:223], v115 offset:57856
    s_waitcnt lgkmcnt(0)
    s_waitcnt vmcnt(12)
    s_barrier
    v_add_u32 v0, 0xffff0000, v7
    ds_write_b128 v0, v[16:19] offset:0
    ds_write_b128 v0, v[20:23] offset:1024
    ds_write_b128 v0, v[24:27] offset:2048
    ds_write_b128 v0, v[28:31] offset:3072
    ds_write_b128 v0, v[32:35] offset:16384
    ds_write_b128 v0, v[36:39] offset:17408
    ds_write_b128 v0, v[40:43] offset:18432
    ds_write_b128 v0, v[44:47] offset:19456
    s_waitcnt lgkmcnt(0)
    ds_write_b128 v0, v[48:51] offset:32768
    ds_write_b128 v0, v[52:55] offset:33792
    ds_write_b128 v0, v[56:59] offset:34816
    ds_write_b128 v0, v[60:63] offset:35840
    ds_write_b128 v0, v[64:67] offset:49152
    ds_write_b128 v0, v[68:71] offset:50176
    ds_write_b128 v0, v[72:75] offset:51200
    ds_write_b128 v0, v[76:79] offset:52224
    ds_read_b64_tr_b16 v[88:89], v118 offset:0
    ds_read_b64_tr_b16 v[90:91], v118 offset:512
    ds_read_b64_tr_b16 v[92:93], v118 offset:8192
    ds_read_b64_tr_b16 v[94:95], v118 offset:8704
    ds_read_b64_tr_b16 v[120:121], v119 offset:0
    ds_read_b64_tr_b16 v[122:123], v119 offset:512
    ds_read_b64_tr_b16 v[124:125], v119 offset:8192
    ds_read_b64_tr_b16 v[126:127], v119 offset:8704
    s_waitcnt lgkmcnt(0)
    s_waitcnt vmcnt(8)
    s_barrier
    ds_write_b128 v7, v[88:91] offset:0
    ds_write_b128 v7, v[92:95] offset:1024
    ds_write_b128 v7, v[120:123] offset:2048
    ds_write_b128 v7, v[124:127] offset:3072
    s_waitcnt lgkmcnt(0)
    ds_read_b64_tr_b16 v[88:89], v118 offset:16384
    ds_read_b64_tr_b16 v[90:91], v118 offset:16896
    ds_read_b64_tr_b16 v[92:93], v118 offset:24576
    ds_read_b64_tr_b16 v[94:95], v118 offset:25088
    ds_read_b64_tr_b16 v[120:121], v119 offset:16384
    ds_read_b64_tr_b16 v[122:123], v119 offset:16896
    ds_read_b64_tr_b16 v[124:125], v119 offset:24576
    ds_read_b64_tr_b16 v[126:127], v119 offset:25088
    s_waitcnt lgkmcnt(0)
    s_waitcnt vmcnt(4)
    s_barrier
    ds_write_b128 v7, v[88:91] offset:16384
    ds_write_b128 v7, v[92:95] offset:17408
    ds_write_b128 v7, v[120:123] offset:18432
    ds_write_b128 v7, v[124:127] offset:19456
    s_waitcnt lgkmcnt(0)
    ds_read_b64_tr_b16 v[88:89], v118 offset:32768
    ds_read_b64_tr_b16 v[90:91], v118 offset:33280
    ds_read_b64_tr_b16 v[92:93], v118 offset:40960
    ds_read_b64_tr_b16 v[94:95], v118 offset:41472
    ds_read_b64_tr_b16 v[120:121], v119 offset:32768
    ds_read_b64_tr_b16 v[122:123], v119 offset:33280
    ds_read_b64_tr_b16 v[124:125], v119 offset:40960
    ds_read_b64_tr_b16 v[126:127], v119 offset:41472
    s_waitcnt lgkmcnt(0)
    s_mov_b32 s60, 192
    buffer_load_dword v108, off, s[28:31], s60 sc1
    buffer_load_dword v109, off, s[28:31], 0 sc1
    s_waitcnt vmcnt(2)
    s_barrier
    ds_write_b128 v7, v[88:91] offset:32768
    ds_write_b128 v7, v[92:95] offset:33792
    ds_write_b128 v7, v[120:123] offset:34816
    ds_write_b128 v7, v[124:127] offset:35840
    s_waitcnt lgkmcnt(0)
    ds_read_b64_tr_b16 v[88:89], v118 offset:49152
    ds_read_b64_tr_b16 v[90:91], v118 offset:49664
    ds_read_b64_tr_b16 v[92:93], v118 offset:57344
    ds_read_b64_tr_b16 v[94:95], v118 offset:57856
    ds_read_b64_tr_b16 v[120:121], v119 offset:49152
    ds_read_b64_tr_b16 v[122:123], v119 offset:49664
    ds_read_b64_tr_b16 v[124:125], v119 offset:57344
    ds_read_b64_tr_b16 v[126:127], v119 offset:57856
    s_waitcnt lgkmcnt(0)
    s_barrier
    ds_write_b128 v7, v[88:91] offset:49152
    ds_write_b128 v7, v[92:95] offset:50176
    ds_write_b128 v7, v[120:123] offset:51200
    ds_write_b128 v7, v[124:127] offset:52224
    s_cmp_eq_u32 s89, 1
    s_cbranch_scc1 rec_chk3
rec_chk:
    s_waitcnt vmcnt(0)
    v_readfirstlane_b32 s61, v108
    v_readfirstlane_b32 s59, v109
    s_add_u32 s84, s84, 1
    s_cmp_gt_u32 s84, 4194304
    s_cbranch_scc1 rec_chk2
    s_cmp_lt_u32 s61, 160
    s_cbranch_scc1 rec_again
    s_and_b32 s61, s59, 0xffff
    s_cmp_ge_u32 s61, 32
    s_cbranch_scc1 rec_chk2
rec_again:
    s_sleep 8
    s_mov_b32 s60, 192
    buffer_load_dword v108, off, s[28:31], s60 sc1
    buffer_load_dword v109, off, s[28:31], 0 sc1
    s_branch rec_chk
rec_chk2:
    buffer_load_dword v110, v107, s[24:27], s92 offen sc1
rec_chk3:
    s_add_u32 s84, s84, 1
    s_waitcnt vmcnt(0)
    v_cmp_eq_u32 s[80:81], s70, v110
    s_cmp_gt_u32 s84, 4194304
    s_cbranch_scc1 rec_go
    s_bitcmp1_b64 s[80:81], 0
    s_cbranch_scc0 rec_chk2
rec_go:
    ds_write_b32 v107, v110 offset:0x7A00
    s_lshl_b32 s60, s54, 11
    s_add_u32 m0, s60, 0
    s_nop 0
    buffer_load_dwordx4 v2, s[24:27], s90 offen sc1 lds
    buffer_load_dwordx4 v2, s[24:27], s90 offen offset:1024 sc1 lds
    s_add_u32 m0, s60, 8192
    s_nop 0
    buffer_load_dwordx4 v2, s[24:27], s91 offen sc1 lds
    buffer_load_dwordx4 v2, s[24:27], s91 offen offset:1024 sc1 lds
    buffer_load_dword v127, v106, s[24:27], 0 offen sc1
    s_waitcnt lgkmcnt(0)
    s_add_u32 s79, s73, s85
    s_add_u32 s89, s72, 1
    s_min_u32 s89, s89, 63
    s_and_b32 s88, s89, 63
    s_lshl_b32 s88, s88, 18
    s_add_u32 s88, s88, s94
    s_add_u32 s90, s88, 33554432
    s_add_u32 s91, s88, 50331648
    s_add_u32 s97, s78, s95
    s_add_u32 s98, s76, s95
    s_add_u32 s65, s76, 65536
    s_add_u32 s66, s76, 131072
    s_add_u32 s67, s76, 196608
    s_cmp_lt_u32 s59, 0x10000
    s_cbranch_scc0 rec_slow
    s_cmp_eq_u32 s54, 0
    s_cbranch_scc1 rec_redo_f0
    s_cmp_eq_u32 s54, 1
    s_cbranch_scc1 rec_redo_f1
    s_cmp_eq_u32 s54, 2
    s_cbranch_scc1 rec_redo_f2
    s_cmp_eq_u32 s54, 3
    s_cbranch_scc1 rec_redo_f3
rec_slow:
    s_cmp_eq_u32 s54, 0
    s_cbranch_scc1 rec_redo_s0
    s_cmp_eq_u32 s54, 1
    s_cbranch_scc1 rec_redo_s1
    s_cmp_eq_u32 s54, 2
    s_cbranch_scc1 rec_redo_s2
    s_branch rec_redo_s3
rec_redo_f0:
    buffer_load_dwordx4 v[16:19], v2, s[24:27], s79 offen offset:0 sc1
    buffer_load_dwordx4 v[20:23], v2, s[24:27], s79 offen offset:1024 sc1
    v_add_u32 v0, 0xffff0000, v7
    ds_read_b128 v[88:91], v0 offset:0
    ds_read_b128 v[92:95], v0 offset:1024
    ds_read_b128 v[96:99], v0 offset:2048
    ds_read_b128 v[100:103], v0 offset:3072
    ds_read_b128 v[104:107], v0 offset:16384
    ds_read_b128 v[108:111], v0 offset:17408
    ds_read_b128 v[112:115], v0 offset:18432
    ds_read_b128 v[116:119], v0 offset:19456
    v_mov_b64 v[70:71], 0
    v_mov_b64 v[68:69], 0
    v_mov_b64 v[66:67], 0
    v_mov_b64 v[64:65], 0
    v_mov_b64 v[62:63], 0
    v_mov_b64 v[60:61], 0
    v_mov_b64 v[58:59], 0
    v_mov_b64 v[56:57], 0
    v_mov_b64 v[54:55], 0
    v_mov_b64 v[52:53], 0
    v_mov_b64 v[50:51], 0
    v_mov_b64_e64 v[48:49], 0
    s_waitcnt vmcnt(0)
    ds_read_b128 v[72:75], v2 offset:8192
    ds_read_b128 v[76:79], v2 offset:9216
    s_waitcnt lgkmcnt(0)
    s_bitcmp1_b64 s[80:81], s89
    s_cbranch_scc0 rec_kvw_f0
    s_branch rec_enter_f0
rec_g0_f0:
    s_mov_b64 exec, vcc
    buffer_load_dwordx4 v[16:19], v2, s[24:27], s79 offen offset:0 sc1
    buffer_load_dwordx4 v[20:23], v2, s[24:27], s79 offen offset:1024 sc1
    s_mov_b64 exec, -1
    s_add_u32 s84, s84, 1
    s_cmp_gt_u32 s84, 4194304
    s_cbranch_scc0 rec_enter_f0
    s_branch rec_ok0_f0
rec_lf_f0:
    v_mov_b32 v14, s72
    s_waitcnt vmcnt(5)
    s_mov_b64 exec, 1
    buffer_store_dword v14, off, s[24:27], s100 sc1
    s_mov_b64 exec, -1
    s_cmp_eq_u32 s72, 63
    s_cbranch_scc1 rec_fin
    s_branch rec_lfx_f0
rec_kvw_f0:
    s_add_u32 s61, s61, 1
    v_lshrrev_b32 v14, 2, v2
    buffer_load_dword v14, v14, s[24:27], s92 offen sc1
    s_waitcnt vmcnt(0)
    v_cmp_eq_u32 s[80:81], s70, v14
    s_cmp_gt_u32 s61, 4194304
    s_cbranch_scc1 rec_kvok_f0
    s_bitcmp1_b64 s[80:81], s89
    s_cbranch_scc0 rec_kvw_f0
    s_branch rec_kvok_f0
.p2align 6
rec_enter_f0:
    v_max3_u32 v0, v16, v17, v18
    v_max3_u32 v14, v19, v20, v21
    v_max3_u32 v0, v0, v22, v23
    v_max_u32 v0, v0, v14
    v_cmp_eq_u32_e64 vcc, -1, v0
    s_cbranch_vccz rec_ok0_f0
    v_max3_u32 v0, v16, v17, v18
    v_max3_u32 v14, v19, v20, v21
    v_max3_u32 v0, v0, v22, v23
    v_max_u32 v0, v0, v14
    v_cmp_eq_u32_e64 vcc, -1, v0
    s_cbranch_vccnz rec_g0_f0
rec_ok0_f0:
    v_smfmac_f32_16x16x64_bf16 v[64:67], v[16:19], v[88:95], v1
    ds_write_b128 v2, v[16:19] offset:16384
    v_smfmac_f32_16x16x64_bf16 v[68:71], v[16:19], v[96:103], v1
    ds_write_b128 v2, v[20:23] offset:17408
    v_smfmac_f32_16x16x64_bf16 v[64:67], v[20:23], v[104:111], v1
    v_smfmac_f32_16x16x64_bf16 v[68:71], v[20:23], v[112:119], v1
    v_smfmac_f32_16x16x64_bf16 v[48:51], v[16:19], a[0:7], v1
    v_smfmac_f32_16x16x64_bf16 v[52:55], v[16:19], a[64:71], v1
    v_smfmac_f32_16x16x64_bf16 v[48:51], v[20:23], a[8:15], v1
    v_smfmac_f32_16x16x64_bf16 v[52:55], v[20:23], a[72:79], v1
    v_smfmac_f32_16x16x64_bf16 v[56:59], v[16:19], a[128:135], v1
    s_waitcnt lgkmcnt(0)
    s_barrier
    ds_read_b128 v[24:27], v2 offset:18432
    v_smfmac_f32_16x16x64_bf16 v[60:63], v[16:19], a[192:199], v1
    ds_read_b128 v[28:31], v2 offset:19456
    ds_read_b128 v[32:35], v2 offset:20480
    buffer_store_dwordx4 v[120:123], v2, s[24:27], s96 offen sc1
    v_smfmac_f32_16x16x64_bf16 v[56:59], v[20:23], a[136:143], v1
    ds_read_b128 v[36:39], v2 offset:21504
    ds_read_b128 v[40:43], v2 offset:22528
    v_smfmac_f32_16x16x64_bf16 v[60:63], v[20:23], a[200:207], v1
    ds_read_b128 v[44:47], v2 offset:23552
    s_waitcnt lgkmcnt(5)
    s_mov_b32 m0, 8192
    v_smfmac_f32_16x16x64_bf16 v[48:51], v[24:27], a[16:23], v1
    buffer_load_dwordx4 v2, s[24:27], s91 offen sc1 lds
    v_smfmac_f32_16x16x64_bf16 v[52:55], v[24:27], a[80:87], v1
    s_waitcnt lgkmcnt(4)
    buffer_load_dwordx4 v2, s[24:27], s91 offen offset:1024 sc1 lds
    v_smfmac_f32_16x16x64_bf16 v[48:51], v[28:31], a[24:31], v1
    v_smfmac_f32_16x16x64_bf16 v[52:55], v[28:31], a[88:95], v1
    s_waitcnt lgkmcnt(0)
    v_smfmac_f32_16x16x64_bf16 v[48:51], v[32:35], a[32:39], v1
    ds_read_b128 v[88:91], v2 offset:0
    v_add_u32 v0, 0xffff0000, v7
    v_smfmac_f32_16x16x64_bf16 v[52:55], v[32:35], a[96:103], v1
    ds_read_b128 v[92:95], v2 offset:1024
    v_mov_b32 v14, s93
    v_smfmac_f32_16x16x64_bf16 v[48:51], v[36:39], a[40:47], v1
    ds_read_b128 v[96:99], v2 offset:2048
    s_add_u32 s60, s97, 131072
    v_smfmac_f32_16x16x64_bf16 v[52:55], v[36:39], a[104:111], v1
    ds_read_b128 v[100:103], v2 offset:3072
    s_waitcnt vmcnt(3)
    v_smfmac_f32_16x16x64_bf16 v[48:51], v[40:43], a[48:55], v1
    ds_read_b128 v[120:123], v0 offset:32768
    buffer_store_dwordx4 v[10:13], v2, s[24:27], s97 offen offset:0
    v_smfmac_f32_16x16x64_bf16 v[52:55], v[40:43], a[112:119], v1
    ds_read_b128 v[124:127], v0 offset:33792
    v_smfmac_f32_16x16x64_bf16 v[48:51], v[44:47], a[56:63], v1
    ds_read_b128 v[16:19], v0 offset:34816
    buffer_store_dwordx4 v[10:13], v2, s[24:27], s97 offen offset:1024
    v_smfmac_f32_16x16x64_bf16 v[52:55], v[44:47], a[120:127], v1
    ds_read_b128 v[20:23], v0 offset:35840
    v_smfmac_f32_16x16x64_bf16 v[56:59], v[24:27], a[144:151], v1
    ds_read_b128 v[104:107], v0 offset:49152
    v_add_f32 v48, v48, v49
    v_smfmac_f32_16x16x64_bf16 v[60:63], v[24:27], a[208:215], v1
    ds_read_b128 v[108:111], v0 offset:50176
    v_add_f32_e64 v50, v50, v51
    v_smfmac_f32_16x16x64_bf16 v[56:59], v[28:31], a[152:159], v1
    ds_read_b128 v[112:115], v0 offset:51200
    v_add_f32_e64 v52, v52, v53
    v_smfmac_f32_16x16x64_bf16 v[60:63], v[28:31], a[216:223], v1
    ds_read_b128 v[116:119], v0 offset:52224
    v_add_f32_e64 v54, v54, v55
    v_smfmac_f32_16x16x64_bf16 v[56:59], v[32:35], a[160:167], v1
    buffer_store_dword v10, v9, s[24:27], s75 offen
    v_cvt_pk_bf16_f32 v48, v48, v52
    v_smfmac_f32_16x16x64_bf16 v[60:63], v[32:35], a[224:231], v1
    v_cvt_pk_bf16_f32 v49, v50, v54
    v_smfmac_f32_16x16x64_bf16 v[56:59], v[36:39], a[168:175], v1
    ds_write2_b32 v3, v48, v49 offset0:0 offset1:136
    v_smfmac_f32_16x16x64_bf16 v[60:63], v[36:39], a[232:239], v1
    buffer_store_dwordx4 v[10:13], v2, s[24:27], s60 offen offset:0
    v_smfmac_f32_16x16x64_bf16 v[56:59], v[40:43], a[176:183], v1
    v_lshrrev_b32_e64 v0, 2, v2
    v_smfmac_f32_16x16x64_bf16 v[60:63], v[40:43], a[240:247], v1
    buffer_store_dwordx4 v[10:13], v2, s[24:27], s60 offen offset:1024
    s_cmp_lt_u32 s72, 60
    v_smfmac_f32_16x16x64_bf16 v[56:59], v[44:47], a[184:191], v1
    s_cselect_b64 exec, 15, 0
    buffer_store_dword v14, v0, s[24:27], s100 offen sc1
    s_mov_b64 exec, -1
    v_smfmac_f32_16x16x64_bf16 v[60:63], v[44:47], a[248:255], v1
    s_waitcnt lgkmcnt(1)
    v_smfmac_f32_16x16x64_bf16 v[64:67], v[24:27], v[120:127], v1
    v_add_f32_e64 v56, v56, v57
    v_smfmac_f32_16x16x64_bf16 v[68:71], v[24:27], v[16:23], v1
    s_waitcnt lgkmcnt(0)
    s_barrier
    v_add_f32_e64 v58, v58, v59
    v_smfmac_f32_16x16x64_bf16 v[64:67], v[28:31], v[104:111], v1
    ds_read_b128 v[16:19], v4 offset:0
    ds_read_b128 v[20:23], v4 offset:64
    v_add_f32_e64 v60, v60, v61
    v_smfmac_f32_16x16x64_bf16 v[68:71], v[28:31], v[112:119], v1
    ds_read_b128 v[120:123], v4 offset:128
    ds_read_b128 v[124:127], v4 offset:192
    v_add_f32_e64 v62, v62, v63
    v_smfmac_f32_16x16x64_bf16 v[64:67], v[32:35], v[160:167], v1
    ds_read_b128 v[104:107], v2 offset:4096
    ds_read_b128 v[108:111], v2 offset:5120
    v_cvt_pk_bf16_f32 v56, v56, v60
    v_smfmac_f32_16x16x64_bf16 v[64:67], v[36:39], v[168:175], v1
    ds_read_b128 v[112:115], v2 offset:6144
    ds_read_b128 v[116:119], v2 offset:7168
    v_cvt_pk_bf16_f32 v57, v58, v62
    v_smfmac_f32_16x16x64_bf16 v[64:67], v[40:43], v[176:183], v1
    ds_write2_b32 v3, v56, v57 offset0:64 offset1:200
    v_smfmac_f32_16x16x64_bf16 v[64:67], v[44:47], v[184:191], v1
    v_smfmac_f32_16x16x64_bf16 v[68:71], v[32:35], v[224:231], v1
    v_mov_b64_e64 v[24:25], 0
    v_smfmac_f32_16x16x64_bf16 v[68:71], v[36:39], v[232:239], v1
    s_waitcnt lgkmcnt(5)
    v_mov_b64 v[26:27], 0
    v_mfma_f32_16x16x32_bf16 v[48:51], v[88:91], v[16:19], 0
    v_mov_b64 v[28:29], 0
    v_mov_b64 v[30:31], 0
    v_mfma_f32_16x16x32_bf16 v[48:51], v[92:95], v[20:23], v[48:51]
    s_mov_b32 m0, 0
    v_mov_b64 v[32:33], 0
    v_mov_b64_e64 v[34:35], 0
    v_mfma_f32_16x16x32_bf16 v[48:51], v[96:99], v[120:123], v[48:51]
    s_waitcnt lgkmcnt(0)
    s_barrier
    ds_read_b128 v[88:91], v5 offset:0
    v_mfma_f32_16x16x32_bf16 v[48:51], v[100:103], v[124:127], v[48:51]
    ds_read_b128 v[92:95], v5 offset:64
    ds_read_b128 v[96:99], v5 offset:128
    ds_read_b128 v[100:103], v5 offset:192
    v_mfma_f32_16x16x32_bf16 v[52:55], v[104:107], v[16:19], 0
    buffer_load_dwordx4 v2, s[24:27], s90 offen sc1 lds
    v_add_f32 v64, v64, v65
    v_add_f32 v66, v66, v67
    v_mfma_f32_16x16x32_bf16 v[52:55], v[108:111], v[20:23], v[52:55]
    buffer_load_dwordx4 v2, s[24:27], s90 offen offset:1024 sc1 lds
    v_mfma_f32_16x16x32_bf16 v[52:55], v[112:115], v[120:123], v[52:55]
    v_cvt_pk_bf16_f32 v84, v64, v66
    v_max3_f32 v0, v48, v49, v50
    v_mfma_f32_16x16x32_bf16 v[52:55], v[116:119], v[124:127], v[52:55]
    v_mov_b64 v[36:37], 0
    v_mov_b64 v[38:39], 0
    v_smfmac_f32_16x16x64_bf16 v[68:71], v[40:43], v[240:247], v1
    ds_read_b128 v[104:107], v7 offset:0
    ds_read_b128 v[108:111], v7 offset:1024
    v_smfmac_f32_16x16x64_bf16 v[68:71], v[44:47], v[248:255], v1
    s_waitcnt lgkmcnt(2)
    ds_read_b128 v[112:115], v7 offset:16384
    ds_read_b128 v[116:119], v7 offset:17408
    v_max3_f32 v58, v51, v52, v53
    v_mfma_f32_16x16x32_bf16 v[60:63], v[88:91], v[16:19], 0
    s_cmp_ge_u32 s72, 59
    v_max3_f32 v0, v0, v54, v55
    v_max_f32_e64 v0, v0, v58
    v_mfma_f32_16x16x32_bf16 v[60:63], v[92:95], v[20:23], v[60:63]
    s_cbranch_scc1 rec_lf_f0
rec_lfx_f0:
    v_mov_b32 v58, v0
    v_mfma_f32_16x16x32_bf16 v[60:63], v[96:99], v[120:123], v[60:63]
    ds_read_b128 v[88:91], v7 offset:2048
    ds_read_b128 v[92:95], v7 offset:3072
    v_add_f32 v68, v68, v69
    v_add_f32 v70, v70, v71
    v_mfma_f32_16x16x32_bf16 v[60:63], v[100:103], v[124:127], v[60:63]
    v_permlane16_swap_b32 v58, v0
    v_cvt_pk_bf16_f32 v86, v68, v70
    v_max_f32 v0, v0, v58
    v_cndmask_b32 v52, v48, v52, s[82:83]
    v_cndmask_b32 v53, v49, v53, s[82:83]
    v_cndmask_b32 v54, v50, v54, s[82:83]
    v_cndmask_b32 v55, v51, v55, s[82:83]
    v_pk_mul_f32 v[52:53], v[52:53], s[86:87]
    v_max3_f32 v0, v0, v60, v61
    v_max3_f32 v0, v0, v62, v63
    v_mov_b32_e64 v58, v0
    v_pk_mul_f32 v[60:61], v[60:61], s[86:87]
    v_pk_mul_f32 v[54:55], v[54:55], s[86:87]
    v_permlane32_swap_b32 v58, v0
    v_max_f32 v0, v58, v0
    v_mul_f32_e64 v58, s86, v0
    v_pk_add_f32 v[60:61], v[60:61], v[58:59] op_sel_hi:[1,0] neg_lo:[0,1] neg_hi:[0,1]
    v_pk_add_f32 v[52:53], v[52:53], v[58:59] op_sel_hi:[1,0] neg_lo:[0,1] neg_hi:[0,1]
    v_pk_add_f32 v[54:55], v[54:55], v[58:59] op_sel_hi:[1,0] neg_lo:[0,1] neg_hi:[0,1]
    v_exp_f32 v60, v60
    v_exp_f32 v61, v61
    v_exp_f32_e64 v52, v52
    v_cvt_pk_bf16_f32 v14, v60, v61
    v_exp_f32 v53, v53
    v_exp_f32 v54, v54
    v_mfma_f32_16x16x16_bf16 v[60:63], v[80:81], v[14:15], 0
    v_exp_f32_e64 v55, v55
    v_cvt_pk_bf16_f32 v52, v52, v53
    v_mfma_f32_16x16x16_bf16 v[64:67], v[84:85], v[14:15], 0
    v_cvt_pk_bf16_f32 v53, v54, v55
    v_mov_b32 v48, v52 quad_perm:[0,0,2,2] row_mask:0xf bank_mask:0xf
    v_mfma_f32_16x16x16_bf16 v[68:71], v[86:87], v[14:15], 0
    v_mov_b32 v50, v52 quad_perm:[1,1,3,3] row_mask:0xf bank_mask:0xf
    v_mov_b32 v49, v53 quad_perm:[0,0,2,2] row_mask:0xf bank_mask:0xf
    v_mov_b32 v51, v53 quad_perm:[1,1,3,3] row_mask:0xf bank_mask:0xf
    s_nop 1
    v_mfma_f32_16x16x32_bf16 v[60:63], v[80:83], v[48:51], v[60:63]
    v_mfma_f32_16x16x32_bf16 v[64:67], v[72:75], v[48:51], v[64:67]
    v_mfma_f32_16x16x32_bf16 v[68:71], v[76:79], v[48:51], v[68:71]
    v_rcp_f32 v60, v60
    v_mov_b64 v[72:73], 0
    v_mov_b64 v[74:75], 0
    v_mov_b64 v[76:77], 0
    v_mov_b64 v[78:79], 0
    v_mov_b64 v[48:49], 0
    v_mov_b64 v[50:51], 0
    v_mov_b64_e64 v[52:53], 0
    v_cndmask_b32 v64, v64, v68, s[82:83]
    v_cndmask_b32 v65, v65, v69, s[82:83]
    v_cndmask_b32 v66, v66, v70, s[82:83]
    v_cndmask_b32 v67, v67, v71, s[82:83]
    v_pk_mul_f32 v[64:65], v[64:65], v[60:61] op_sel_hi:[1,0]
    v_pk_mul_f32 v[66:67], v[66:67], v[60:61] op_sel_hi:[1,0]
    v_cvt_pk_bf16_f32 v68, v64, v65
    v_cvt_pk_bf16_f32 v69, v66, v67
    ds_write_b64 v6, v[68:69]
    v_mov_b64 v[54:55], 0
    s_mov_b32 s88, s73
    s_mov_b32 s73, s74
    s_mov_b32 s74, s75
    s_mov_b32 s75, s88
    s_add_u32 s79, s73, s85
    s_waitcnt lgkmcnt(0)
    s_barrier
    ds_read_b128 v[56:59], v2 offset:29184
    ds_read_b128 v[60:63], v2 offset:30208
    s_mov_b32 s99, s98
    s_waitcnt lgkmcnt(1)
    v_smfmac_f32_16x16x64_bf16 v[24:27], v[56:59], v[128:135], v1
    s_waitcnt lgkmcnt(0)
    v_smfmac_f32_16x16x64_bf16 v[24:27], v[60:63], v[192:199], v1
    v_smfmac_f32_16x16x64_bf16 v[28:31], v[56:59], v[136:143], v1
    ds_read_b128 v[96:99], v7 offset:18432
    ds_read_b128 v[100:103], v7 offset:19456
    v_smfmac_f32_16x16x64_bf16 v[28:31], v[60:63], v[200:207], v1
    ds_read_b128 v[16:19], v7 offset:32768
    ds_read_b128 v[20:23], v7 offset:33792
    v_add_f32 v24, v24, v25
    v_add_f32_e64 v26, v26, v27
    v_smfmac_f32_16x16x64_bf16 v[32:35], v[56:59], v[144:151], v1
    ds_read_b128 v[120:123], v7 offset:49152
    ds_read_b128 v[124:127], v7 offset:50176
    v_cvt_pk_bf16_f32 v24, v24, v26
    v_smfmac_f32_16x16x64_bf16 v[32:35], v[60:63], v[208:215], v1
    ds_read_b128 v[40:43], v7 offset:34816
    ds_read_b128 v[44:47], v7 offset:35840
    v_add_f32 v28, v28, v29
    v_add_f32 v30, v30, v31
    v_smfmac_f32_16x16x64_bf16 v[36:39], v[56:59], v[152:159], v1
    ds_read_b128 v[64:67], v7 offset:51200
    ds_read_b128 v[68:71], v7 offset:52224
    v_cvt_pk_bf16_f32 v25, v28, v30
    v_smfmac_f32_16x16x64_bf16 v[36:39], v[60:63], v[216:223], v1
    buffer_store_dwordx2 v[24:25], v8, s[24:27], s76 offen
    v_add_f32 v32, v32, v33
    v_add_f32 v34, v34, v35
    v_smfmac_f32_16x16x64_bf16 v[72:75], v[56:59], v[104:111], v1
    v_cvt_pk_bf16_f32 v32, v32, v34
    v_smfmac_f32_16x16x64_bf16 v[72:75], v[60:63], v[112:119], v1
    v_add_f32 v36, v36, v37
    v_add_f32 v38, v38, v39
    v_smfmac_f32_16x16x64_bf16 v[76:79], v[56:59], v[88:95], v1
    s_waitcnt lgkmcnt(0)
    v_cvt_pk_bf16_f32 v33, v36, v38
    v_smfmac_f32_16x16x64_bf16 v[76:79], v[60:63], v[96:103], v1
    buffer_store_dwordx2 v[32:33], v8, s[24:27], s65 offen
    v_add_f32 v72, v72, v73
    v_add_f32_e64 v74, v74, v75
    v_smfmac_f32_16x16x64_bf16 v[48:51], v[56:59], v[16:23], v1
    v_cvt_pk_bf16_f32 v72, v72, v74
    v_smfmac_f32_16x16x64_bf16 v[48:51], v[60:63], v[120:127], v1
    v_add_f32 v76, v76, v77
    v_add_f32 v78, v78, v79
    v_smfmac_f32_16x16x64_bf16 v[52:55], v[56:59], v[40:47], v1
    v_cvt_pk_bf16_f32 v73, v76, v78
    v_smfmac_f32_16x16x64_bf16 v[52:55], v[60:63], v[64:71], v1
    buffer_store_dwordx2 v[72:73], v8, s[24:27], s66 offen
    v_add_f32 v48, v48, v49
    v_add_f32 v50, v50, v51
    v_cvt_pk_bf16_f32 v48, v48, v50
    s_nop 3
    v_add_f32 v52, v52, v53
    v_add_f32_e64 v54, v54, v55
    v_cvt_pk_bf16_f32 v49, v52, v54
    buffer_store_dwordx2 v[48:49], v8, s[24:27], s67 offen
    v_mov_b64 v[24:25], -1
    v_mov_b64 v[26:27], -1
    v_mov_b64 v[28:29], -1
    v_mov_b64 v[30:31], -1
    v_mov_b64 v[70:71], 0
    v_mov_b64 v[68:69], 0
    v_mov_b64 v[66:67], 0
    v_mov_b64 v[64:65], 0
    v_mov_b64 v[62:63], 0
    v_mov_b64 v[60:61], 0
    v_mov_b64 v[58:59], 0
    v_mov_b64 v[56:57], 0
    v_mov_b64 v[54:55], 0
    v_mov_b64 v[52:53], 0
    v_mov_b64 v[50:51], 0
    v_mov_b64 v[48:49], 0
    buffer_load_dwordx4 v[24:27], v2, s[24:27], s99 offen offset:0 sc1
    buffer_load_dwordx4 v[28:31], v2, s[24:27], s99 offen offset:1024 sc1
    v_mov_b64 v[16:17], -1
    v_mov_b64 v[18:19], -1
    v_mov_b64 v[20:21], -1
    v_mov_b64 v[22:23], -1
    v_add_u32 v0, 0xffff0000, v7
    ds_read_b128 v[88:91], v0 offset:0
    ds_read_b128 v[92:95], v0 offset:1024
    ds_read_b128 v[96:99], v0 offset:2048
    ds_read_b128 v[100:103], v0 offset:3072
    ds_read_b128 v[104:107], v0 offset:16384
    ds_read_b128 v[108:111], v0 offset:17408
    ds_read_b128 v[112:115], v0 offset:18432
    ds_read_b128 v[116:119], v0 offset:19456
    ds_read2_b32 v[120:121], v3 offset0:64 offset1:200
    v_mov_b32 v122, v84
    v_mov_b32 v123, v86
    s_mov_b32 s88, s76
    s_mov_b32 s76, s77
    s_mov_b32 s77, s78
    s_mov_b32 s78, s88
    s_and_b32 s88, s72, 63
    s_lshl_b32 s88, s88, 17
    s_waitcnt vmcnt(6)
rec_rs_f0:
    s_add_u32 s84, s84, 1
    s_cmp_gt_u32 s84, 4194304
    v_max3_u32 v0, v24, v25, v26
    v_max3_u32 v14, v27, v28, v29
    v_max3_u32 v0, v0, v30, v31
    v_mfma_f32_16x16x32_bf16 v[124:127], v[80:83], v[24:27], 0
    v_max_u32 v0, v0, v14
    v_cmp_eq_u32 vcc, -1, v0
    v_mfma_f32_16x16x32_bf16 v[124:127], v[80:83], v[28:31], v[124:127]
    s_cbranch_vccz rec_go_f0
    s_mov_b64 exec, vcc
    buffer_load_dwordx4 v[24:27], v2, s[24:27], s99 offen offset:0 sc1
    buffer_load_dwordx4 v[28:31], v2, s[24:27], s99 offen offset:1024 sc1
    s_mov_b64 exec, -1
    v_max3_u32 v0, v24, v25, v26
    v_max3_u32 v14, v27, v28, v29
    v_max3_u32 v0, v0, v30, v31
    v_mfma_f32_16x16x32_bf16 v[124:127], v[80:83], v[24:27], 0
    v_max_u32 v0, v0, v14
    v_cmp_eq_u32_e64 vcc, -1, v0
    v_mfma_f32_16x16x32_bf16 v[124:127], v[80:83], v[28:31], v[124:127]
    s_cselect_b64 vcc, 0, vcc
    s_cbranch_vccnz rec_rs_f0
rec_go_f0:
    v_lshrrev_b32_e64 v0, 2, v2
    ds_read_b32 v14, v0 offset:31232
    ds_read_b128 v[72:75], v2 offset:8192
    ds_read_b128 v[76:79], v2 offset:9216
    s_nop 2
    v_add_f32 v126, v126, v126 row_ror:4 row_mask:0xf bank_mask:0xf
    v_add_f32 v127, v127, v127 row_ror:4 row_mask:0xf bank_mask:0xf
    s_nop 0
    v_add_f32 v126, v126, v126 row_ror:8 row_mask:0xf bank_mask:0xf
    v_add_f32 v127, v127, v127 row_ror:8 row_mask:0xf bank_mask:0xf
    v_cvt_pk_bf16_f32 v124, v126, v127
    buffer_store_dword v124, v9, s[24:27], s73 offen
    s_add_u32 s96, s63, s88
    s_mov_b32 s93, s72
    s_add_u32 s72, s72, 1
    s_add_u32 s89, s72, 1
    s_min_u32 s89, s89, 63
    s_and_b32 s88, s89, 63
    s_lshl_b32 s88, s88, 18
    s_add_u32 s88, s88, s94
    s_add_u32 s90, s88, 33554432
    s_add_u32 s91, s88, 50331648
    s_add_u32 s97, s78, s95
    s_add_u32 s98, s76, s95
    s_add_u32 s65, s76, 65536
    s_add_u32 s66, s76, 131072
    s_add_u32 s67, s76, 196608
    s_waitcnt lgkmcnt(0)
    v_cmp_eq_u32 s[80:81], s70, v14
    buffer_load_dwordx4 v[16:19], v2, s[24:27], s79 offen offset:0 sc1
    buffer_load_dwordx4 v[20:23], v2, s[24:27], s79 offen offset:1024 sc1
    s_bitcmp1_b64 s[80:81], s89
    s_cbranch_scc0 rec_kvw_f0
rec_kvok_f0:
    s_branch rec_enter_f0
rec_f0_f0:
    s_mov_b64 exec, vcc
    buffer_load_dwordx4 v[24:27], v2, s[24:27], s99 offen offset:0 sc1
    buffer_load_dwordx4 v[28:31], v2, s[24:27], s99 offen offset:1024 sc1
    s_mov_b64 exec, -1
    s_add_u32 s84, s84, 1
    s_cmp_gt_u32 s84, 4194304
    s_cbranch_scc0 rec_rs_f0
    s_branch rec_go_f0
rec_redo_f1:
    buffer_load_dwordx4 v[16:19], v2, s[24:27], s79 offen offset:0 sc1
    buffer_load_dwordx4 v[20:23], v2, s[24:27], s79 offen offset:1024 sc1
    v_add_u32 v0, 0xffff0000, v7
    ds_read_b128 v[88:91], v0 offset:0
    ds_read_b128 v[92:95], v0 offset:1024
    ds_read_b128 v[96:99], v0 offset:2048
    ds_read_b128 v[100:103], v0 offset:3072
    ds_read_b128 v[104:107], v0 offset:16384
    ds_read_b128 v[108:111], v0 offset:17408
    ds_read_b128 v[112:115], v0 offset:18432
    ds_read_b128 v[116:119], v0 offset:19456
    v_mov_b64 v[70:71], 0
    v_mov_b64 v[68:69], 0
    v_mov_b64 v[66:67], 0
    v_mov_b64 v[64:65], 0
    v_mov_b64 v[62:63], 0
    v_mov_b64 v[60:61], 0
    v_mov_b64 v[58:59], 0
    v_mov_b64 v[56:57], 0
    v_mov_b64 v[54:55], 0
    v_mov_b64 v[52:53], 0
    v_mov_b64 v[50:51], 0
    v_mov_b64 v[48:49], 0
    s_waitcnt vmcnt(0)
    ds_read_b128 v[72:75], v2 offset:10240
    ds_read_b128 v[76:79], v2 offset:11264
    s_waitcnt lgkmcnt(0)
    s_bitcmp1_b64 s[80:81], s89
    s_cbranch_scc0 rec_kvw_f1
    s_branch rec_enter_f1
rec_g0_f1:
    s_mov_b64 exec, vcc
    buffer_load_dwordx4 v[16:19], v2, s[24:27], s79 offen offset:0 sc1
    buffer_load_dwordx4 v[20:23], v2, s[24:27], s79 offen offset:1024 sc1
    s_mov_b64 exec, -1
    s_add_u32 s84, s84, 1
    s_cmp_gt_u32 s84, 4194304
    s_cbranch_scc0 rec_enter_f1
    s_branch rec_ok0_f1
rec_lf_f1:
    v_mov_b32 v14, s72
    s_waitcnt vmcnt(5)
    s_mov_b64 exec, 1
    buffer_store_dword v14, off, s[24:27], s100 sc1
    s_mov_b64 exec, -1
    s_cmp_eq_u32 s72, 63
    s_cbranch_scc1 rec_fin
    s_branch rec_lfx_f1
rec_kvw_f1:
    s_add_u32 s61, s61, 1
    v_lshrrev_b32 v14, 2, v2
    buffer_load_dword v14, v14, s[24:27], s92 offen sc1
    s_waitcnt vmcnt(0)
    v_cmp_eq_u32 s[80:81], s70, v14
    s_cmp_gt_u32 s61, 4194304
    s_cbranch_scc1 rec_kvok_f1
    s_bitcmp1_b64 s[80:81], s89
    s_cbranch_scc0 rec_kvw_f1
    s_branch rec_kvok_f1
.p2align 6
rec_enter_f1:
    v_max3_u32 v0, v16, v17, v18
    v_max3_u32 v14, v19, v20, v21
    v_max3_u32 v0, v0, v22, v23
    v_max_u32 v0, v0, v14
    v_cmp_eq_u32_e64 vcc, -1, v0
    s_cbranch_vccz rec_ok0_f1
    v_max3_u32 v0, v16, v17, v18
    v_max3_u32 v14, v19, v20, v21
    v_max3_u32 v0, v0, v22, v23
    v_max_u32 v0, v0, v14
    v_cmp_eq_u32_e64 vcc, -1, v0
    s_cbranch_vccnz rec_g0_f1
rec_ok0_f1:
    v_smfmac_f32_16x16x64_bf16 v[64:67], v[16:19], v[88:95], v1
    ds_write_b128 v2, v[16:19] offset:18432
    v_smfmac_f32_16x16x64_bf16 v[68:71], v[16:19], v[96:103], v1
    ds_write_b128 v2, v[20:23] offset:19456
    v_smfmac_f32_16x16x64_bf16 v[64:67], v[20:23], v[104:111], v1
    v_smfmac_f32_16x16x64_bf16 v[68:71], v[20:23], v[112:119], v1
    v_lshrrev_b32_e64 v0, 2, v2
    v_smfmac_f32_16x16x64_bf16 v[48:51], v[16:19], a[16:23], v1
    v_smfmac_f32_16x16x64_bf16 v[52:55], v[16:19], a[80:87], v1
    v_smfmac_f32_16x16x64_bf16 v[48:51], v[20:23], a[24:31], v1
    v_smfmac_f32_16x16x64_bf16 v[52:55], v[20:23], a[88:95], v1
    v_smfmac_f32_16x16x64_bf16 v[56:59], v[16:19], a[144:151], v1
    s_waitcnt lgkmcnt(0)
    s_barrier
    ds_read_b128 v[24:27], v2 offset:16384
    v_smfmac_f32_16x16x64_bf16 v[60:63], v[16:19], a[208:215], v1
    ds_read_b128 v[28:31], v2 offset:17408
    ds_read_b128 v[32:35], v2 offset:20480
    buffer_store_dwordx4 v[120:123], v2, s[24:27], s96 offen sc1
    v_smfmac_f32_16x16x64_bf16 v[56:59], v[20:23], a[152:159], v1
    ds_read_b128 v[36:39], v2 offset:21504
    ds_read_b128 v[40:43], v2 offset:22528
    v_smfmac_f32_16x16x64_bf16 v[60:63], v[20:23], a[216:223], v1
    ds_read_b128 v[44:47], v2 offset:23552
    s_waitcnt lgkmcnt(5)
    s_mov_b32 m0, 10240
    v_smfmac_f32_16x16x64_bf16 v[48:51], v[24:27], a[0:7], v1
    buffer_load_dwordx4 v2, s[24:27], s91 offen sc1 lds
    v_smfmac_f32_16x16x64_bf16 v[52:55], v[24:27], a[64:71], v1
    s_waitcnt lgkmcnt(4)
    buffer_load_dwordx4 v2, s[24:27], s91 offen offset:1024 sc1 lds
    v_smfmac_f32_16x16x64_bf16 v[48:51], v[28:31], a[8:15], v1
    s_mov_b32 m0, 31232
    v_smfmac_f32_16x16x64_bf16 v[52:55], v[28:31], a[72:79], v1
    s_waitcnt lgkmcnt(0)
    buffer_load_dword v0, s[24:27], s92 offen sc1 lds
    v_smfmac_f32_16x16x64_bf16 v[48:51], v[32:35], a[32:39], v1
    ds_read_b128 v[88:91], v2 offset:0
    v_add_u32 v0, 0xffff0000, v7
    v_smfmac_f32_16x16x64_bf16 v[52:55], v[32:35], a[96:103], v1
    ds_read_b128 v[92:95], v2 offset:1024
    v_smfmac_f32_16x16x64_bf16 v[48:51], v[36:39], a[40:47], v1
    ds_read_b128 v[96:99], v2 offset:2048
    s_add_u32 s60, s97, 131072
    v_smfmac_f32_16x16x64_bf16 v[52:55], v[36:39], a[104:111], v1
    ds_read_b128 v[100:103], v2 offset:3072
    s_waitcnt vmcnt(4)
    v_smfmac_f32_16x16x64_bf16 v[48:51], v[40:43], a[48:55], v1
    ds_read_b128 v[120:123], v0 offset:32768
    v_smfmac_f32_16x16x64_bf16 v[52:55], v[40:43], a[112:119], v1
    ds_read_b128 v[124:127], v0 offset:33792
    buffer_store_dwordx4 v[10:13], v2, s[24:27], s97 offen offset:0
    v_smfmac_f32_16x16x64_bf16 v[48:51], v[44:47], a[56:63], v1
    ds_read_b128 v[16:19], v0 offset:34816
    v_smfmac_f32_16x16x64_bf16 v[52:55], v[44:47], a[120:127], v1
    ds_read_b128 v[20:23], v0 offset:35840
    buffer_store_dwordx4 v[10:13], v2, s[24:27], s97 offen offset:1024
    v_smfmac_f32_16x16x64_bf16 v[56:59], v[24:27], a[128:135], v1
    ds_read_b128 v[104:107], v0 offset:49152
    v_add_f32_e64 v48, v48, v49
    v_smfmac_f32_16x16x64_bf16 v[60:63], v[24:27], a[192:199], v1
    ds_read_b128 v[108:111], v0 offset:50176
    v_add_f32_e64 v50, v50, v51
    v_smfmac_f32_16x16x64_bf16 v[56:59], v[28:31], a[136:143], v1
    ds_read_b128 v[112:115], v0 offset:51200
    v_add_f32_e64 v52, v52, v53
    v_smfmac_f32_16x16x64_bf16 v[60:63], v[28:31], a[200:207], v1
    ds_read_b128 v[116:119], v0 offset:52224
    v_add_f32_e64 v54, v54, v55
    v_smfmac_f32_16x16x64_bf16 v[56:59], v[32:35], a[160:167], v1
    buffer_store_dword v10, v9, s[24:27], s75 offen
    v_cvt_pk_bf16_f32 v48, v48, v52
    v_smfmac_f32_16x16x64_bf16 v[60:63], v[32:35], a[224:231], v1
    v_cvt_pk_bf16_f32 v49, v50, v54
    v_smfmac_f32_16x16x64_bf16 v[56:59], v[36:39], a[168:175], v1
    ds_write2_b32 v3, v48, v49 offset0:0 offset1:136
    v_smfmac_f32_16x16x64_bf16 v[60:63], v[36:39], a[232:239], v1
    v_smfmac_f32_16x16x64_bf16 v[56:59], v[40:43], a[176:183], v1
    buffer_store_dwordx4 v[10:13], v2, s[24:27], s60 offen offset:0
    v_smfmac_f32_16x16x64_bf16 v[60:63], v[40:43], a[240:247], v1
    v_smfmac_f32_16x16x64_bf16 v[56:59], v[44:47], a[184:191], v1
    buffer_store_dwordx4 v[10:13], v2, s[24:27], s60 offen offset:1024
    v_smfmac_f32_16x16x64_bf16 v[60:63], v[44:47], a[248:255], v1
    s_waitcnt lgkmcnt(1)
    v_smfmac_f32_16x16x64_bf16 v[64:67], v[24:27], v[120:127], v1
    v_add_f32 v56, v56, v57
    v_smfmac_f32_16x16x64_bf16 v[68:71], v[24:27], v[16:23], v1
    s_waitcnt lgkmcnt(0)
    s_barrier
    v_add_f32_e64 v58, v58, v59
    v_smfmac_f32_16x16x64_bf16 v[64:67], v[28:31], v[104:111], v1
    ds_read_b128 v[16:19], v4 offset:0
    ds_read_b128 v[20:23], v4 offset:64
    v_add_f32_e64 v60, v60, v61
    v_smfmac_f32_16x16x64_bf16 v[68:71], v[28:31], v[112:119], v1
    ds_read_b128 v[120:123], v4 offset:128
    ds_read_b128 v[124:127], v4 offset:192
    v_add_f32_e64 v62, v62, v63
    v_smfmac_f32_16x16x64_bf16 v[64:67], v[32:35], v[160:167], v1
    ds_read_b128 v[104:107], v2 offset:4096
    ds_read_b128 v[108:111], v2 offset:5120
    v_cvt_pk_bf16_f32 v56, v56, v60
    v_smfmac_f32_16x16x64_bf16 v[64:67], v[36:39], v[168:175], v1
    ds_read_b128 v[112:115], v2 offset:6144
    ds_read_b128 v[116:119], v2 offset:7168
    v_cvt_pk_bf16_f32 v57, v58, v62
    v_smfmac_f32_16x16x64_bf16 v[64:67], v[40:43], v[176:183], v1
    ds_write2_b32 v3, v56, v57 offset0:64 offset1:200
    v_smfmac_f32_16x16x64_bf16 v[64:67], v[44:47], v[184:191], v1
    v_smfmac_f32_16x16x64_bf16 v[68:71], v[32:35], v[224:231], v1
    v_mov_b64_e64 v[24:25], 0
    v_smfmac_f32_16x16x64_bf16 v[68:71], v[36:39], v[232:239], v1
    s_waitcnt lgkmcnt(5)
    v_mov_b64 v[26:27], 0
    v_mfma_f32_16x16x32_bf16 v[48:51], v[88:91], v[16:19], 0
    v_mov_b64 v[28:29], 0
    v_mov_b64 v[30:31], 0
    v_mfma_f32_16x16x32_bf16 v[48:51], v[92:95], v[20:23], v[48:51]
    s_mov_b32 m0, 2048
    v_mov_b64 v[32:33], 0
    v_mov_b64 v[34:35], 0
    v_mfma_f32_16x16x32_bf16 v[48:51], v[96:99], v[120:123], v[48:51]
    s_waitcnt lgkmcnt(0)
    s_barrier
    ds_read_b128 v[88:91], v5 offset:0
    v_mfma_f32_16x16x32_bf16 v[48:51], v[100:103], v[124:127], v[48:51]
    ds_read_b128 v[92:95], v5 offset:64
    ds_read_b128 v[96:99], v5 offset:128
    ds_read_b128 v[100:103], v5 offset:192
    v_mfma_f32_16x16x32_bf16 v[52:55], v[104:107], v[16:19], 0
    buffer_load_dwordx4 v2, s[24:27], s90 offen sc1 lds
    v_add_f32 v64, v64, v65
    v_add_f32 v66, v66, v67
    v_mfma_f32_16x16x32_bf16 v[52:55], v[108:111], v[20:23], v[52:55]
    buffer_load_dwordx4 v2, s[24:27], s90 offen offset:1024 sc1 lds
    v_mfma_f32_16x16x32_bf16 v[52:55], v[112:115], v[120:123], v[52:55]
    v_cvt_pk_bf16_f32 v84, v64, v66
    v_max3_f32 v0, v48, v49, v50
    v_mfma_f32_16x16x32_bf16 v[52:55], v[116:119], v[124:127], v[52:55]
    v_mov_b64 v[36:37], 0
    v_mov_b64 v[38:39], 0
    v_smfmac_f32_16x16x64_bf16 v[68:71], v[40:43], v[240:247], v1
    ds_read_b128 v[104:107], v7 offset:0
    ds_read_b128 v[108:111], v7 offset:1024
    v_smfmac_f32_16x16x64_bf16 v[68:71], v[44:47], v[248:255], v1
    s_waitcnt lgkmcnt(2)
    ds_read_b128 v[112:115], v7 offset:16384
    ds_read_b128 v[116:119], v7 offset:17408
    v_max3_f32 v58, v51, v52, v53
    v_mfma_f32_16x16x32_bf16 v[60:63], v[88:91], v[16:19], 0
    s_cmp_ge_u32 s72, 59
    v_max3_f32 v0, v0, v54, v55
    v_max_f32_e64 v0, v0, v58
    v_mfma_f32_16x16x32_bf16 v[60:63], v[92:95], v[20:23], v[60:63]
    s_cbranch_scc1 rec_lf_f1
rec_lfx_f1:
    v_mov_b32 v58, v0
    v_mfma_f32_16x16x32_bf16 v[60:63], v[96:99], v[120:123], v[60:63]
    ds_read_b128 v[88:91], v7 offset:2048
    ds_read_b128 v[92:95], v7 offset:3072
    v_add_f32 v68, v68, v69
    v_add_f32 v70, v70, v71
    v_mfma_f32_16x16x32_bf16 v[60:63], v[100:103], v[124:127], v[60:63]
    v_permlane16_swap_b32 v58, v0
    v_cvt_pk_bf16_f32 v86, v68, v70
    v_max_f32 v0, v0, v58
    v_cndmask_b32 v52, v48, v52, s[82:83]
    v_cndmask_b32 v53, v49, v53, s[82:83]
    v_cndmask_b32 v54, v50, v54, s[82:83]
    v_cndmask_b32 v55, v51, v55, s[82:83]
    v_pk_mul_f32 v[52:53], v[52:53], s[86:87]
    v_max3_f32 v0, v0, v60, v61
    v_max3_f32 v0, v0, v62, v63
    v_mov_b32_e64 v58, v0
    v_pk_mul_f32 v[60:61], v[60:61], s[86:87]
    v_pk_mul_f32 v[54:55], v[54:55], s[86:87]
    v_permlane32_swap_b32 v58, v0
    v_max_f32 v0, v58, v0
    v_mul_f32_e64 v58, s86, v0
    v_pk_add_f32 v[60:61], v[60:61], v[58:59] op_sel_hi:[1,0] neg_lo:[0,1] neg_hi:[0,1]
    v_pk_add_f32 v[52:53], v[52:53], v[58:59] op_sel_hi:[1,0] neg_lo:[0,1] neg_hi:[0,1]
    v_pk_add_f32 v[54:55], v[54:55], v[58:59] op_sel_hi:[1,0] neg_lo:[0,1] neg_hi:[0,1]
    v_exp_f32 v60, v60
    v_exp_f32 v61, v61
    v_exp_f32_e64 v52, v52
    v_cvt_pk_bf16_f32 v14, v60, v61
    v_exp_f32 v53, v53
    v_exp_f32 v54, v54
    v_mfma_f32_16x16x16_bf16 v[60:63], v[80:81], v[14:15], 0
    v_exp_f32_e64 v55, v55
    v_cvt_pk_bf16_f32 v52, v52, v53
    v_mfma_f32_16x16x16_bf16 v[64:67], v[84:85], v[14:15], 0
    v_cvt_pk_bf16_f32 v53, v54, v55
    v_mov_b32 v48, v52 quad_perm:[0,0,2,2] row_mask:0xf bank_mask:0xf
    v_mfma_f32_16x16x16_bf16 v[68:71], v[86:87], v[14:15], 0
    v_mov_b32 v50, v52 quad_perm:[1,1,3,3] row_mask:0xf bank_mask:0xf
    v_mov_b32 v49, v53 quad_perm:[0,0,2,2] row_mask:0xf bank_mask:0xf
    v_mov_b32 v51, v53 quad_perm:[1,1,3,3] row_mask:0xf bank_mask:0xf
    s_nop 1
    v_mfma_f32_16x16x32_bf16 v[60:63], v[80:83], v[48:51], v[60:63]
    v_mfma_f32_16x16x32_bf16 v[64:67], v[72:75], v[48:51], v[64:67]
    v_mfma_f32_16x16x32_bf16 v[68:71], v[76:79], v[48:51], v[68:71]
    v_rcp_f32 v60, v60
    v_mov_b64 v[72:73], 0
    v_mov_b64 v[74:75], 0
    v_mov_b64 v[76:77], 0
    v_mov_b64 v[78:79], 0
    v_mov_b64 v[48:49], 0
    v_mov_b64 v[50:51], 0
    v_mov_b64_e64 v[52:53], 0
    v_cndmask_b32 v64, v64, v68, s[82:83]
    v_cndmask_b32 v65, v65, v69, s[82:83]
    v_cndmask_b32 v66, v66, v70, s[82:83]
    v_cndmask_b32 v67, v67, v71, s[82:83]
    v_pk_mul_f32 v[64:65], v[64:65], v[60:61] op_sel_hi:[1,0]
    v_pk_mul_f32 v[66:67], v[66:67], v[60:61] op_sel_hi:[1,0]
    v_cvt_pk_bf16_f32 v68, v64, v65
    v_cvt_pk_bf16_f32 v69, v66, v67
    ds_write_b64 v6, v[68:69]
    v_mov_b64 v[54:55], 0
    s_mov_b32 s88, s73
    s_mov_b32 s73, s74
    s_mov_b32 s74, s75
    s_mov_b32 s75, s88
    s_add_u32 s79, s73, s85
    s_waitcnt lgkmcnt(0)
    s_barrier
    ds_read_b128 v[56:59], v2 offset:29184
    ds_read_b128 v[60:63], v2 offset:30208
    s_mov_b32 s99, s98
    s_waitcnt lgkmcnt(1)
    v_smfmac_f32_16x16x64_bf16 v[24:27], v[56:59], v[128:135], v1
    s_waitcnt lgkmcnt(0)
    v_smfmac_f32_16x16x64_bf16 v[24:27], v[60:63], v[192:199], v1
    v_smfmac_f32_16x16x64_bf16 v[28:31], v[56:59], v[136:143], v1
    ds_read_b128 v[96:99], v7 offset:18432
    ds_read_b128 v[100:103], v7 offset:19456
    v_smfmac_f32_16x16x64_bf16 v[28:31], v[60:63], v[200:207], v1
    ds_read_b128 v[16:19], v7 offset:32768
    ds_read_b128 v[20:23], v7 offset:33792
    v_add_f32 v24, v24, v25
    v_add_f32_e64 v26, v26, v27
    v_smfmac_f32_16x16x64_bf16 v[32:35], v[56:59], v[144:151], v1
    ds_read_b128 v[120:123], v7 offset:49152
    ds_read_b128 v[124:127], v7 offset:50176
    v_cvt_pk_bf16_f32 v24, v24, v26
    v_smfmac_f32_16x16x64_bf16 v[32:35], v[60:63], v[208:215], v1
    ds_read_b128 v[40:43], v7 offset:34816
    ds_read_b128 v[44:47], v7 offset:35840
    v_add_f32 v28, v28, v29
    v_add_f32 v30, v30, v31
    v_smfmac_f32_16x16x64_bf16 v[36:39], v[56:59], v[152:159], v1
    ds_read_b128 v[64:67], v7 offset:51200
    ds_read_b128 v[68:71], v7 offset:52224
    v_cvt_pk_bf16_f32 v25, v28, v30
    v_smfmac_f32_16x16x64_bf16 v[36:39], v[60:63], v[216:223], v1
    buffer_store_dwordx2 v[24:25], v8, s[24:27], s76 offen
    v_add_f32 v32, v32, v33
    v_add_f32 v34, v34, v35
    v_smfmac_f32_16x16x64_bf16 v[72:75], v[56:59], v[104:111], v1
    v_cvt_pk_bf16_f32 v32, v32, v34
    v_smfmac_f32_16x16x64_bf16 v[72:75], v[60:63], v[112:119], v1
    v_add_f32 v36, v36, v37
    v_add_f32 v38, v38, v39
    v_smfmac_f32_16x16x64_bf16 v[76:79], v[56:59], v[88:95], v1
    s_waitcnt lgkmcnt(0)
    v_cvt_pk_bf16_f32 v33, v36, v38
    v_smfmac_f32_16x16x64_bf16 v[76:79], v[60:63], v[96:103], v1
    buffer_store_dwordx2 v[32:33], v8, s[24:27], s65 offen
    v_add_f32 v72, v72, v73
    v_add_f32_e64 v74, v74, v75
    v_smfmac_f32_16x16x64_bf16 v[48:51], v[56:59], v[16:23], v1
    v_cvt_pk_bf16_f32 v72, v72, v74
    v_smfmac_f32_16x16x64_bf16 v[48:51], v[60:63], v[120:127], v1
    v_add_f32 v76, v76, v77
    v_add_f32 v78, v78, v79
    v_smfmac_f32_16x16x64_bf16 v[52:55], v[56:59], v[40:47], v1
    v_cvt_pk_bf16_f32 v73, v76, v78
    v_smfmac_f32_16x16x64_bf16 v[52:55], v[60:63], v[64:71], v1
    buffer_store_dwordx2 v[72:73], v8, s[24:27], s66 offen
    v_add_f32 v48, v48, v49
    v_add_f32 v50, v50, v51
    v_cvt_pk_bf16_f32 v48, v48, v50
    s_nop 3
    v_add_f32 v52, v52, v53
    v_add_f32_e64 v54, v54, v55
    v_cvt_pk_bf16_f32 v49, v52, v54
    buffer_store_dwordx2 v[48:49], v8, s[24:27], s67 offen
    v_mov_b64 v[24:25], -1
    v_mov_b64 v[26:27], -1
    v_mov_b64 v[28:29], -1
    v_mov_b64 v[30:31], -1
    v_mov_b64 v[70:71], 0
    v_mov_b64 v[68:69], 0
    v_mov_b64 v[66:67], 0
    v_mov_b64 v[64:65], 0
    v_mov_b64 v[62:63], 0
    v_mov_b64 v[60:61], 0
    v_mov_b64 v[58:59], 0
    v_mov_b64 v[56:57], 0
    v_mov_b64 v[54:55], 0
    v_mov_b64 v[52:53], 0
    v_mov_b64 v[50:51], 0
    v_mov_b64 v[48:49], 0
    v_mov_b64 v[16:17], -1
    v_mov_b64 v[18:19], -1
    v_mov_b64 v[20:21], -1
    v_mov_b64 v[22:23], -1
    buffer_load_dwordx4 v[24:27], v2, s[24:27], s99 offen offset:0 sc1
    buffer_load_dwordx4 v[28:31], v2, s[24:27], s99 offen offset:1024 sc1
    v_add_u32 v0, 0xffff0000, v7
    ds_read_b128 v[88:91], v0 offset:0
    ds_read_b128 v[92:95], v0 offset:1024
    ds_read_b128 v[96:99], v0 offset:2048
    ds_read_b128 v[100:103], v0 offset:3072
    ds_read_b128 v[104:107], v0 offset:16384
    ds_read_b128 v[108:111], v0 offset:17408
    ds_read_b128 v[112:115], v0 offset:18432
    ds_read_b128 v[116:119], v0 offset:19456
    ds_read2_b32 v[120:121], v3 offset0:64 offset1:200
    v_mov_b32 v122, v84
    v_mov_b32 v123, v86
    s_mov_b32 s88, s76
    s_mov_b32 s76, s77
    s_mov_b32 s77, s78
    s_mov_b32 s78, s88
    s_and_b32 s88, s72, 63
    s_lshl_b32 s88, s88, 17
    s_waitcnt vmcnt(6)
rec_rs_f1:
    s_add_u32 s84, s84, 1
    s_cmp_gt_u32 s84, 4194304
    v_max3_u32 v0, v24, v25, v26
    v_max3_u32 v14, v27, v28, v29
    v_max3_u32 v0, v0, v30, v31
    v_mfma_f32_16x16x32_bf16 v[124:127], v[80:83], v[24:27], 0
    v_max_u32 v0, v0, v14
    v_cmp_eq_u32 vcc, -1, v0
    v_mfma_f32_16x16x32_bf16 v[124:127], v[80:83], v[28:31], v[124:127]
    s_cbranch_vccz rec_go_f1
    s_mov_b64 exec, vcc
    buffer_load_dwordx4 v[24:27], v2, s[24:27], s99 offen offset:0 sc1
    buffer_load_dwordx4 v[28:31], v2, s[24:27], s99 offen offset:1024 sc1
    s_mov_b64 exec, -1
    v_max3_u32 v0, v24, v25, v26
    v_max3_u32 v14, v27, v28, v29
    v_max3_u32 v0, v0, v30, v31
    v_mfma_f32_16x16x32_bf16 v[124:127], v[80:83], v[24:27], 0
    v_max_u32 v0, v0, v14
    v_cmp_eq_u32_e64 vcc, -1, v0
    v_mfma_f32_16x16x32_bf16 v[124:127], v[80:83], v[28:31], v[124:127]
    s_cselect_b64 vcc, 0, vcc
    s_cbranch_vccnz rec_rs_f1
rec_go_f1:
    v_lshrrev_b32_e64 v0, 2, v2
    ds_read_b32 v14, v0 offset:31232
    ds_read_b128 v[72:75], v2 offset:10240
    ds_read_b128 v[76:79], v2 offset:11264
    s_nop 2
    v_add_f32 v126, v126, v126 row_ror:4 row_mask:0xf bank_mask:0xf
    v_add_f32 v127, v127, v127 row_ror:4 row_mask:0xf bank_mask:0xf
    s_nop 0
    v_add_f32 v126, v126, v126 row_ror:8 row_mask:0xf bank_mask:0xf
    v_add_f32 v127, v127, v127 row_ror:8 row_mask:0xf bank_mask:0xf
    v_cvt_pk_bf16_f32 v124, v126, v127
    buffer_store_dword v124, v9, s[24:27], s73 offen
    s_add_u32 s96, s63, s88
    s_mov_b32 s93, s72
    s_add_u32 s72, s72, 1
    s_add_u32 s89, s72, 1
    s_min_u32 s89, s89, 63
    s_and_b32 s88, s89, 63
    s_lshl_b32 s88, s88, 18
    s_add_u32 s88, s88, s94
    s_add_u32 s90, s88, 33554432
    s_add_u32 s91, s88, 50331648
    s_add_u32 s97, s78, s95
    s_add_u32 s98, s76, s95
    s_add_u32 s65, s76, 65536
    s_add_u32 s66, s76, 131072
    s_add_u32 s67, s76, 196608
    s_waitcnt lgkmcnt(0)
    v_cmp_eq_u32 s[80:81], s70, v14
    buffer_load_dwordx4 v[16:19], v2, s[24:27], s79 offen offset:0 sc1
    buffer_load_dwordx4 v[20:23], v2, s[24:27], s79 offen offset:1024 sc1
    s_bitcmp1_b64 s[80:81], s89
    s_cbranch_scc0 rec_kvw_f1
rec_kvok_f1:
    s_branch rec_enter_f1
rec_f0_f1:
    s_mov_b64 exec, vcc
    buffer_load_dwordx4 v[24:27], v2, s[24:27], s99 offen offset:0 sc1
    buffer_load_dwordx4 v[28:31], v2, s[24:27], s99 offen offset:1024 sc1
    s_mov_b64 exec, -1
    s_add_u32 s84, s84, 1
    s_cmp_gt_u32 s84, 4194304
    s_cbranch_scc0 rec_rs_f1
    s_branch rec_go_f1
rec_redo_f2:
    buffer_load_dwordx4 v[16:19], v2, s[24:27], s79 offen offset:0 sc1
    buffer_load_dwordx4 v[20:23], v2, s[24:27], s79 offen offset:1024 sc1
    v_add_u32 v0, 0xffff0000, v7
    ds_read_b128 v[88:91], v0 offset:0
    ds_read_b128 v[92:95], v0 offset:1024
    ds_read_b128 v[96:99], v0 offset:2048
    ds_read_b128 v[100:103], v0 offset:3072
    ds_read_b128 v[104:107], v0 offset:16384
    ds_read_b128 v[108:111], v0 offset:17408
    ds_read_b128 v[112:115], v0 offset:18432
    ds_read_b128 v[116:119], v0 offset:19456
    v_mov_b64 v[70:71], 0
    v_mov_b64 v[68:69], 0
    v_mov_b64 v[66:67], 0
    v_mov_b64 v[64:65], 0
    v_mov_b64 v[62:63], 0
    v_mov_b64 v[60:61], 0
    v_mov_b64 v[58:59], 0
    v_mov_b64 v[56:57], 0
    v_mov_b64 v[54:55], 0
    v_mov_b64 v[52:53], 0
    v_mov_b64 v[50:51], 0
    v_mov_b64 v[48:49], 0
    s_waitcnt vmcnt(0)
    ds_read_b128 v[72:75], v2 offset:12288
    ds_read_b128 v[76:79], v2 offset:13312
    s_waitcnt lgkmcnt(0)
    s_bitcmp1_b64 s[80:81], s89
    s_cbranch_scc0 rec_kvw_f2
    s_branch rec_enter_f2
rec_g0_f2:
    s_mov_b64 exec, vcc
    buffer_load_dwordx4 v[16:19], v2, s[24:27], s79 offen offset:0 sc1
    buffer_load_dwordx4 v[20:23], v2, s[24:27], s79 offen offset:1024 sc1
    s_mov_b64 exec, -1
    s_add_u32 s84, s84, 1
    s_cmp_gt_u32 s84, 4194304
    s_cbranch_scc0 rec_enter_f2
    s_branch rec_ok0_f2
rec_lf_f2:
    v_mov_b32 v14, s72
    s_waitcnt vmcnt(5)
    s_mov_b64 exec, 1
    buffer_store_dword v14, off, s[24:27], s100 sc1
    s_mov_b64 exec, -1
    s_cmp_eq_u32 s72, 63
    s_cbranch_scc1 rec_fin
    s_branch rec_lfx_f2
rec_kvw_f2:
    s_add_u32 s61, s61, 1
    v_lshrrev_b32 v14, 2, v2
    buffer_load_dword v14, v14, s[24:27], s92 offen sc1
    s_waitcnt vmcnt(0)
    v_cmp_eq_u32 s[80:81], s70, v14
    s_cmp_gt_u32 s61, 4194304
    s_cbranch_scc1 rec_kvok_f2
    s_bitcmp1_b64 s[80:81], s89
    s_cbranch_scc0 rec_kvw_f2
    s_branch rec_kvok_f2
.p2align 6
rec_enter_f2:
    v_max3_u32 v0, v16, v17, v18
    v_max3_u32 v14, v19, v20, v21
    v_max3_u32 v0, v0, v22, v23
    v_max_u32 v0, v0, v14
    v_cmp_eq_u32_e64 vcc, -1, v0
    s_cbranch_vccz rec_ok0_f2
    v_max3_u32 v0, v16, v17, v18
    v_max3_u32 v14, v19, v20, v21
    v_max3_u32 v0, v0, v22, v23
    v_max_u32 v0, v0, v14
    v_cmp_eq_u32_e64 vcc, -1, v0
    s_cbranch_vccnz rec_g0_f2
rec_ok0_f2:
    v_smfmac_f32_16x16x64_bf16 v[64:67], v[16:19], v[88:95], v1
    ds_write_b128 v2, v[16:19] offset:20480
    v_smfmac_f32_16x16x64_bf16 v[68:71], v[16:19], v[96:103], v1
    ds_write_b128 v2, v[20:23] offset:21504
    v_smfmac_f32_16x16x64_bf16 v[64:67], v[20:23], v[104:111], v1
    v_smfmac_f32_16x16x64_bf16 v[68:71], v[20:23], v[112:119], v1
    v_smfmac_f32_16x16x64_bf16 v[48:51], v[16:19], a[32:39], v1
    v_smfmac_f32_16x16x64_bf16 v[52:55], v[16:19], a[96:103], v1
    v_smfmac_f32_16x16x64_bf16 v[48:51], v[20:23], a[40:47], v1
    s_waitcnt lgkmcnt(0)
    s_barrier
    ds_read_b128 v[24:27], v2 offset:16384
    v_smfmac_f32_16x16x64_bf16 v[52:55], v[20:23], a[104:111], v1
    ds_read_b128 v[28:31], v2 offset:17408
    ds_read_b128 v[32:35], v2 offset:18432
    v_smfmac_f32_16x16x64_bf16 v[56:59], v[16:19], a[160:167], v1
    ds_read_b128 v[36:39], v2 offset:19456
    ds_read_b128 v[40:43], v2 offset:22528
    v_smfmac_f32_16x16x64_bf16 v[60:63], v[16:19], a[224:231], v1
    ds_read_b128 v[44:47], v2 offset:23552
    buffer_store_dwordx4 v[120:123], v2, s[24:27], s96 offen sc1
    v_smfmac_f32_16x16x64_bf16 v[56:59], v[20:23], a[168:175], v1
    v_smfmac_f32_16x16x64_bf16 v[60:63], v[20:23], a[232:239], v1
    s_waitcnt lgkmcnt(5)
    s_mov_b32 m0, 12288
    v_smfmac_f32_16x16x64_bf16 v[48:51], v[24:27], a[0:7], v1
    buffer_load_dwordx4 v2, s[24:27], s91 offen sc1 lds
    v_smfmac_f32_16x16x64_bf16 v[52:55], v[24:27], a[64:71], v1
    s_waitcnt lgkmcnt(4)
    buffer_load_dwordx4 v2, s[24:27], s91 offen offset:1024 sc1 lds
    v_smfmac_f32_16x16x64_bf16 v[48:51], v[28:31], a[8:15], v1
    v_smfmac_f32_16x16x64_bf16 v[52:55], v[28:31], a[72:79], v1
    s_waitcnt lgkmcnt(0)
    v_smfmac_f32_16x16x64_bf16 v[48:51], v[32:35], a[16:23], v1
    ds_read_b128 v[88:91], v2 offset:0
    v_add_u32 v0, 0xffff0000, v7
    v_smfmac_f32_16x16x64_bf16 v[52:55], v[32:35], a[80:87], v1
    ds_read_b128 v[92:95], v2 offset:1024
    v_smfmac_f32_16x16x64_bf16 v[48:51], v[36:39], a[24:31], v1
    ds_read_b128 v[96:99], v2 offset:2048
    v_smfmac_f32_16x16x64_bf16 v[52:55], v[36:39], a[88:95], v1
    ds_read_b128 v[100:103], v2 offset:3072
    s_waitcnt vmcnt(3)
    v_smfmac_f32_16x16x64_bf16 v[48:51], v[40:43], a[48:55], v1
    ds_read_b128 v[120:123], v0 offset:32768
    v_smfmac_f32_16x16x64_bf16 v[52:55], v[40:43], a[112:119], v1
    ds_read_b128 v[124:127], v0 offset:33792
    v_smfmac_f32_16x16x64_bf16 v[48:51], v[44:47], a[56:63], v1
    ds_read_b128 v[16:19], v0 offset:34816
    v_smfmac_f32_16x16x64_bf16 v[52:55], v[44:47], a[120:127], v1
    ds_read_b128 v[20:23], v0 offset:35840
    v_smfmac_f32_16x16x64_bf16 v[56:59], v[24:27], a[128:135], v1
    ds_read_b128 v[104:107], v0 offset:49152
    v_add_f32_e64 v48, v48, v49
    v_smfmac_f32_16x16x64_bf16 v[60:63], v[24:27], a[192:199], v1
    ds_read_b128 v[108:111], v0 offset:50176
    v_add_f32_e64 v50, v50, v51
    v_smfmac_f32_16x16x64_bf16 v[56:59], v[28:31], a[136:143], v1
    ds_read_b128 v[112:115], v0 offset:51200
    v_add_f32_e64 v52, v52, v53
    v_smfmac_f32_16x16x64_bf16 v[60:63], v[28:31], a[200:207], v1
    ds_read_b128 v[116:119], v0 offset:52224
    v_add_f32_e64 v54, v54, v55
    v_smfmac_f32_16x16x64_bf16 v[56:59], v[32:35], a[144:151], v1
    buffer_store_dword v10, v9, s[24:27], s75 offen
    v_cvt_pk_bf16_f32 v48, v48, v52
    v_smfmac_f32_16x16x64_bf16 v[60:63], v[32:35], a[208:215], v1
    v_cvt_pk_bf16_f32 v49, v50, v54
    v_smfmac_f32_16x16x64_bf16 v[56:59], v[36:39], a[152:159], v1
    ds_write2_b32 v3, v48, v49 offset0:0 offset1:136
    v_smfmac_f32_16x16x64_bf16 v[60:63], v[36:39], a[216:223], v1
    v_smfmac_f32_16x16x64_bf16 v[56:59], v[40:43], a[176:183], v1
    v_smfmac_f32_16x16x64_bf16 v[60:63], v[40:43], a[240:247], v1
    v_smfmac_f32_16x16x64_bf16 v[56:59], v[44:47], a[184:191], v1
    v_smfmac_f32_16x16x64_bf16 v[60:63], v[44:47], a[248:255], v1
    s_waitcnt lgkmcnt(1)
    v_smfmac_f32_16x16x64_bf16 v[64:67], v[24:27], v[120:127], v1
    v_add_f32 v56, v56, v57
    v_smfmac_f32_16x16x64_bf16 v[68:71], v[24:27], v[16:23], v1
    s_waitcnt lgkmcnt(0)
    s_barrier
    v_add_f32_e64 v58, v58, v59
    v_smfmac_f32_16x16x64_bf16 v[64:67], v[28:31], v[104:111], v1
    ds_read_b128 v[16:19], v4 offset:0
    ds_read_b128 v[20:23], v4 offset:64
    v_add_f32_e64 v60, v60, v61
    v_smfmac_f32_16x16x64_bf16 v[68:71], v[28:31], v[112:119], v1
    ds_read_b128 v[120:123], v4 offset:128
    ds_read_b128 v[124:127], v4 offset:192
    v_add_f32_e64 v62, v62, v63
    v_smfmac_f32_16x16x64_bf16 v[64:67], v[32:35], v[160:167], v1
    ds_read_b128 v[104:107], v2 offset:4096
    ds_read_b128 v[108:111], v2 offset:5120
    v_cvt_pk_bf16_f32 v56, v56, v60
    v_smfmac_f32_16x16x64_bf16 v[64:67], v[36:39], v[168:175], v1
    ds_read_b128 v[112:115], v2 offset:6144
    ds_read_b128 v[116:119], v2 offset:7168
    v_cvt_pk_bf16_f32 v57, v58, v62
    v_smfmac_f32_16x16x64_bf16 v[64:67], v[40:43], v[176:183], v1
    ds_write2_b32 v3, v56, v57 offset0:64 offset1:200
    v_smfmac_f32_16x16x64_bf16 v[64:67], v[44:47], v[184:191], v1
    v_smfmac_f32_16x16x64_bf16 v[68:71], v[32:35], v[224:231], v1
    v_mov_b64_e64 v[24:25], 0
    v_smfmac_f32_16x16x64_bf16 v[68:71], v[36:39], v[232:239], v1
    s_waitcnt lgkmcnt(5)
    v_mov_b64 v[26:27], 0
    v_mfma_f32_16x16x32_bf16 v[48:51], v[88:91], v[16:19], 0
    v_mov_b64 v[28:29], 0
    v_mov_b64 v[30:31], 0
    v_mfma_f32_16x16x32_bf16 v[48:51], v[92:95], v[20:23], v[48:51]
    s_mov_b32 m0, 4096
    v_mov_b64 v[32:33], 0
    v_mov_b64 v[34:35], 0
    v_mfma_f32_16x16x32_bf16 v[48:51], v[96:99], v[120:123], v[48:51]
    s_waitcnt lgkmcnt(0)
    s_barrier
    ds_read_b128 v[88:91], v5 offset:0
    v_mfma_f32_16x16x32_bf16 v[48:51], v[100:103], v[124:127], v[48:51]
    ds_read_b128 v[92:95], v5 offset:64
    ds_read_b128 v[96:99], v5 offset:128
    ds_read_b128 v[100:103], v5 offset:192
    v_mfma_f32_16x16x32_bf16 v[52:55], v[104:107], v[16:19], 0
    buffer_load_dwordx4 v2, s[24:27], s90 offen sc1 lds
    v_add_f32 v64, v64, v65
    v_add_f32 v66, v66, v67
    v_mfma_f32_16x16x32_bf16 v[52:55], v[108:111], v[20:23], v[52:55]
    buffer_load_dwordx4 v2, s[24:27], s90 offen offset:1024 sc1 lds
    v_mfma_f32_16x16x32_bf16 v[52:55], v[112:115], v[120:123], v[52:55]
    v_cvt_pk_bf16_f32 v84, v64, v66
    v_max3_f32 v0, v48, v49, v50
    v_mfma_f32_16x16x32_bf16 v[52:55], v[116:119], v[124:127], v[52:55]
    v_mov_b64 v[36:37], 0
    v_mov_b64 v[38:39], 0
    v_smfmac_f32_16x16x64_bf16 v[68:71], v[40:43], v[240:247], v1
    ds_read_b128 v[104:107], v7 offset:0
    ds_read_b128 v[108:111], v7 offset:1024
    v_smfmac_f32_16x16x64_bf16 v[68:71], v[44:47], v[248:255], v1
    s_waitcnt lgkmcnt(2)
    ds_read_b128 v[112:115], v7 offset:16384
    ds_read_b128 v[116:119], v7 offset:17408
    v_max3_f32 v58, v51, v52, v53
    v_mfma_f32_16x16x32_bf16 v[60:63], v[88:91], v[16:19], 0
    s_cmp_ge_u32 s72, 59
    v_max3_f32 v0, v0, v54, v55
    v_max_f32_e64 v0, v0, v58
    v_mfma_f32_16x16x32_bf16 v[60:63], v[92:95], v[20:23], v[60:63]
    s_cbranch_scc1 rec_lf_f2
rec_lfx_f2:
    v_mov_b32 v58, v0
    v_mfma_f32_16x16x32_bf16 v[60:63], v[96:99], v[120:123], v[60:63]
    ds_read_b128 v[88:91], v7 offset:2048
    ds_read_b128 v[92:95], v7 offset:3072
    v_add_f32 v68, v68, v69
    v_add_f32 v70, v70, v71
    v_mfma_f32_16x16x32_bf16 v[60:63], v[100:103], v[124:127], v[60:63]
    v_permlane16_swap_b32 v58, v0
    v_cvt_pk_bf16_f32 v86, v68, v70
    v_max_f32 v0, v0, v58
    v_cndmask_b32 v52, v48, v52, s[82:83]
    v_cndmask_b32 v53, v49, v53, s[82:83]
    v_cndmask_b32 v54, v50, v54, s[82:83]
    v_cndmask_b32 v55, v51, v55, s[82:83]
    v_pk_mul_f32 v[52:53], v[52:53], s[86:87]
    v_max3_f32 v0, v0, v60, v61
    v_max3_f32 v0, v0, v62, v63
    v_mov_b32_e64 v58, v0
    v_pk_mul_f32 v[60:61], v[60:61], s[86:87]
    v_pk_mul_f32 v[54:55], v[54:55], s[86:87]
    v_permlane32_swap_b32 v58, v0
    v_max_f32 v0, v58, v0
    v_mul_f32_e64 v58, s86, v0
    v_pk_add_f32 v[60:61], v[60:61], v[58:59] op_sel_hi:[1,0] neg_lo:[0,1] neg_hi:[0,1]
    v_pk_add_f32 v[52:53], v[52:53], v[58:59] op_sel_hi:[1,0] neg_lo:[0,1] neg_hi:[0,1]
    v_pk_add_f32 v[54:55], v[54:55], v[58:59] op_sel_hi:[1,0] neg_lo:[0,1] neg_hi:[0,1]
    v_exp_f32 v60, v60
    v_exp_f32 v61, v61
    v_exp_f32_e64 v52, v52
    v_cvt_pk_bf16_f32 v14, v60, v61
    v_exp_f32 v53, v53
    v_exp_f32 v54, v54
    v_mfma_f32_16x16x16_bf16 v[60:63], v[80:81], v[14:15], 0
    v_exp_f32_e64 v55, v55
    v_cvt_pk_bf16_f32 v52, v52, v53
    v_mfma_f32_16x16x16_bf16 v[64:67], v[84:85], v[14:15], 0
    v_cvt_pk_bf16_f32 v53, v54, v55
    v_mov_b32 v48, v52 quad_perm:[0,0,2,2] row_mask:0xf bank_mask:0xf
    v_mfma_f32_16x16x16_bf16 v[68:71], v[86:87], v[14:15], 0
    v_mov_b32 v50, v52 quad_perm:[1,1,3,3] row_mask:0xf bank_mask:0xf
    v_mov_b32 v49, v53 quad_perm:[0,0,2,2] row_mask:0xf bank_mask:0xf
    v_mov_b32 v51, v53 quad_perm:[1,1,3,3] row_mask:0xf bank_mask:0xf
    s_nop 1
    v_mfma_f32_16x16x32_bf16 v[60:63], v[80:83], v[48:51], v[60:63]
    v_mfma_f32_16x16x32_bf16 v[64:67], v[72:75], v[48:51], v[64:67]
    v_mfma_f32_16x16x32_bf16 v[68:71], v[76:79], v[48:51], v[68:71]
    v_rcp_f32 v60, v60
    v_mov_b64 v[72:73], 0
    v_mov_b64 v[74:75], 0
    v_mov_b64 v[76:77], 0
    v_mov_b64 v[78:79], 0
    v_mov_b64 v[48:49], 0
    v_mov_b64 v[50:51], 0
    v_mov_b64_e64 v[52:53], 0
    v_cndmask_b32 v64, v64, v68, s[82:83]
    v_cndmask_b32 v65, v65, v69, s[82:83]
    v_cndmask_b32 v66, v66, v70, s[82:83]
    v_cndmask_b32 v67, v67, v71, s[82:83]
    v_pk_mul_f32 v[64:65], v[64:65], v[60:61] op_sel_hi:[1,0]
    v_pk_mul_f32 v[66:67], v[66:67], v[60:61] op_sel_hi:[1,0]
    v_cvt_pk_bf16_f32 v68, v64, v65
    v_cvt_pk_bf16_f32 v69, v66, v67
    ds_write_b64 v6, v[68:69]
    v_mov_b64 v[54:55], 0
    s_mov_b32 s88, s73
    s_mov_b32 s73, s74
    s_mov_b32 s74, s75
    s_mov_b32 s75, s88
    s_add_u32 s79, s73, s85
    s_waitcnt lgkmcnt(0)
    s_barrier
    ds_read_b128 v[56:59], v2 offset:29184
    ds_read_b128 v[60:63], v2 offset:30208
    s_mov_b32 s99, s98
    s_waitcnt lgkmcnt(1)
    v_smfmac_f32_16x16x64_bf16 v[24:27], v[56:59], v[128:135], v1
    s_waitcnt lgkmcnt(0)
    v_smfmac_f32_16x16x64_bf16 v[24:27], v[60:63], v[192:199], v1
    v_smfmac_f32_16x16x64_bf16 v[28:31], v[56:59], v[136:143], v1
    ds_read_b128 v[96:99], v7 offset:18432
    ds_read_b128 v[100:103], v7 offset:19456
    v_smfmac_f32_16x16x64_bf16 v[28:31], v[60:63], v[200:207], v1
    ds_read_b128 v[16:19], v7 offset:32768
    ds_read_b128 v[20:23], v7 offset:33792
    v_add_f32 v24, v24, v25
    v_add_f32_e64 v26, v26, v27
    v_smfmac_f32_16x16x64_bf16 v[32:35], v[56:59], v[144:151], v1
    ds_read_b128 v[120:123], v7 offset:49152
    ds_read_b128 v[124:127], v7 offset:50176
    v_cvt_pk_bf16_f32 v24, v24, v26
    v_smfmac_f32_16x16x64_bf16 v[32:35], v[60:63], v[208:215], v1
    ds_read_b128 v[40:43], v7 offset:34816
    ds_read_b128 v[44:47], v7 offset:35840
    v_add_f32 v28, v28, v29
    v_add_f32 v30, v30, v31
    v_smfmac_f32_16x16x64_bf16 v[36:39], v[56:59], v[152:159], v1
    ds_read_b128 v[64:67], v7 offset:51200
    ds_read_b128 v[68:71], v7 offset:52224
    v_cvt_pk_bf16_f32 v25, v28, v30
    v_smfmac_f32_16x16x64_bf16 v[36:39], v[60:63], v[216:223], v1
    buffer_store_dwordx2 v[24:25], v8, s[24:27], s76 offen
    v_add_f32 v32, v32, v33
    v_add_f32 v34, v34, v35
    v_smfmac_f32_16x16x64_bf16 v[72:75], v[56:59], v[104:111], v1
    v_cvt_pk_bf16_f32 v32, v32, v34
    v_smfmac_f32_16x16x64_bf16 v[72:75], v[60:63], v[112:119], v1
    v_add_f32 v36, v36, v37
    v_add_f32 v38, v38, v39
    v_smfmac_f32_16x16x64_bf16 v[76:79], v[56:59], v[88:95], v1
    s_waitcnt lgkmcnt(0)
    v_cvt_pk_bf16_f32 v33, v36, v38
    v_smfmac_f32_16x16x64_bf16 v[76:79], v[60:63], v[96:103], v1
    buffer_store_dwordx2 v[32:33], v8, s[24:27], s65 offen
    v_add_f32 v72, v72, v73
    v_add_f32_e64 v74, v74, v75
    v_smfmac_f32_16x16x64_bf16 v[48:51], v[56:59], v[16:23], v1
    v_cvt_pk_bf16_f32 v72, v72, v74
    v_smfmac_f32_16x16x64_bf16 v[48:51], v[60:63], v[120:127], v1
    v_add_f32 v76, v76, v77
    v_add_f32 v78, v78, v79
    v_smfmac_f32_16x16x64_bf16 v[52:55], v[56:59], v[40:47], v1
    v_cvt_pk_bf16_f32 v73, v76, v78
    v_smfmac_f32_16x16x64_bf16 v[52:55], v[60:63], v[64:71], v1
    buffer_store_dwordx2 v[72:73], v8, s[24:27], s66 offen
    v_add_f32 v48, v48, v49
    v_add_f32 v50, v50, v51
    v_cvt_pk_bf16_f32 v48, v48, v50
    s_nop 3
    v_add_f32 v52, v52, v53
    v_add_f32_e64 v54, v54, v55
    v_cvt_pk_bf16_f32 v49, v52, v54
    buffer_store_dwordx2 v[48:49], v8, s[24:27], s67 offen
    v_mov_b64 v[24:25], -1
    v_mov_b64 v[26:27], -1
    v_mov_b64 v[28:29], -1
    v_mov_b64 v[30:31], -1
    v_mov_b64 v[70:71], 0
    v_mov_b64 v[68:69], 0
    v_mov_b64 v[66:67], 0
    v_mov_b64 v[64:65], 0
    v_mov_b64 v[62:63], 0
    v_mov_b64 v[60:61], 0
    v_mov_b64 v[58:59], 0
    v_mov_b64 v[56:57], 0
    v_mov_b64 v[54:55], 0
    v_mov_b64 v[52:53], 0
    v_mov_b64 v[50:51], 0
    v_mov_b64 v[48:49], 0
    v_mov_b64 v[16:17], -1
    v_mov_b64 v[18:19], -1
    v_mov_b64 v[20:21], -1
    v_mov_b64 v[22:23], -1
    v_add_u32 v0, 0xffff0000, v7
    ds_read_b128 v[88:91], v0 offset:0
    ds_read_b128 v[92:95], v0 offset:1024
    ds_read_b128 v[96:99], v0 offset:2048
    ds_read_b128 v[100:103], v0 offset:3072
    ds_read_b128 v[104:107], v0 offset:16384
    ds_read_b128 v[108:111], v0 offset:17408
    ds_read_b128 v[112:115], v0 offset:18432
    buffer_load_dwordx4 v[24:27], v2, s[24:27], s99 offen offset:0 sc1
    buffer_load_dwordx4 v[28:31], v2, s[24:27], s99 offen offset:1024 sc1
    ds_read_b128 v[116:119], v0 offset:19456
    ds_read2_b32 v[120:121], v3 offset0:64 offset1:200
    v_mov_b32 v122, v84
    v_mov_b32 v123, v86
    s_mov_b32 s88, s76
    s_mov_b32 s76, s77
    s_mov_b32 s77, s78
    s_mov_b32 s78, s88
    s_and_b32 s88, s72, 63
    s_lshl_b32 s88, s88, 17
    s_waitcnt vmcnt(6)
rec_rs_f2:
    s_add_u32 s84, s84, 1
    s_cmp_gt_u32 s84, 4194304
    v_max3_u32 v0, v24, v25, v26
    v_max3_u32 v14, v27, v28, v29
    v_max3_u32 v0, v0, v30, v31
    v_mfma_f32_16x16x32_bf16 v[124:127], v[80:83], v[24:27], 0
    v_max_u32 v0, v0, v14
    v_cmp_eq_u32 vcc, -1, v0
    v_mfma_f32_16x16x32_bf16 v[124:127], v[80:83], v[28:31], v[124:127]
    s_cbranch_vccz rec_go_f2
    s_mov_b64 exec, vcc
    buffer_load_dwordx4 v[24:27], v2, s[24:27], s99 offen offset:0 sc1
    buffer_load_dwordx4 v[28:31], v2, s[24:27], s99 offen offset:1024 sc1
    s_mov_b64 exec, -1
    v_max3_u32 v0, v24, v25, v26
    v_max3_u32 v14, v27, v28, v29
    v_max3_u32 v0, v0, v30, v31
    v_mfma_f32_16x16x32_bf16 v[124:127], v[80:83], v[24:27], 0
    v_max_u32 v0, v0, v14
    v_cmp_eq_u32_e64 vcc, -1, v0
    v_mfma_f32_16x16x32_bf16 v[124:127], v[80:83], v[28:31], v[124:127]
    s_cselect_b64 vcc, 0, vcc
    s_cbranch_vccnz rec_rs_f2
rec_go_f2:
    v_lshrrev_b32_e64 v0, 2, v2
    ds_read_b32 v14, v0 offset:31232
    ds_read_b128 v[72:75], v2 offset:12288
    ds_read_b128 v[76:79], v2 offset:13312
    s_nop 2
    v_add_f32 v126, v126, v126 row_ror:4 row_mask:0xf bank_mask:0xf
    v_add_f32 v127, v127, v127 row_ror:4 row_mask:0xf bank_mask:0xf
    s_nop 0
    v_add_f32 v126, v126, v126 row_ror:8 row_mask:0xf bank_mask:0xf
    v_add_f32 v127, v127, v127 row_ror:8 row_mask:0xf bank_mask:0xf
    v_cvt_pk_bf16_f32 v124, v126, v127
    buffer_store_dword v124, v9, s[24:27], s73 offen
    s_add_u32 s96, s63, s88
    s_mov_b32 s93, s72
    s_add_u32 s72, s72, 1
    s_add_u32 s89, s72, 1
    s_min_u32 s89, s89, 63
    s_and_b32 s88, s89, 63
    s_lshl_b32 s88, s88, 18
    s_add_u32 s88, s88, s94
    s_add_u32 s90, s88, 33554432
    s_add_u32 s91, s88, 50331648
    s_add_u32 s97, s78, s95
    s_add_u32 s98, s76, s95
    s_add_u32 s65, s76, 65536
    s_add_u32 s66, s76, 131072
    s_add_u32 s67, s76, 196608
    s_waitcnt lgkmcnt(0)
    v_cmp_eq_u32 s[80:81], s70, v14
    buffer_load_dwordx4 v[16:19], v2, s[24:27], s79 offen offset:0 sc1
    buffer_load_dwordx4 v[20:23], v2, s[24:27], s79 offen offset:1024 sc1
    s_bitcmp1_b64 s[80:81], s89
    s_cbranch_scc0 rec_kvw_f2
rec_kvok_f2:
    s_branch rec_enter_f2
rec_f0_f2:
    s_mov_b64 exec, vcc
    buffer_load_dwordx4 v[24:27], v2, s[24:27], s99 offen offset:0 sc1
    buffer_load_dwordx4 v[28:31], v2, s[24:27], s99 offen offset:1024 sc1
    s_mov_b64 exec, -1
    s_add_u32 s84, s84, 1
    s_cmp_gt_u32 s84, 4194304
    s_cbranch_scc0 rec_rs_f2
    s_branch rec_go_f2
rec_redo_f3:
    buffer_load_dwordx4 v[16:19], v2, s[24:27], s79 offen offset:0 sc1
    buffer_load_dwordx4 v[20:23], v2, s[24:27], s79 offen offset:1024 sc1
    v_add_u32 v0, 0xffff0000, v7
    ds_read_b128 v[88:91], v0 offset:0
    ds_read_b128 v[92:95], v0 offset:1024
    ds_read_b128 v[96:99], v0 offset:2048
    ds_read_b128 v[100:103], v0 offset:3072
    ds_read_b128 v[104:107], v0 offset:16384
    ds_read_b128 v[108:111], v0 offset:17408
    ds_read_b128 v[112:115], v0 offset:18432
    ds_read_b128 v[116:119], v0 offset:19456
    v_mov_b64 v[70:71], 0
    v_mov_b64 v[68:69], 0
    v_mov_b64 v[66:67], 0
    v_mov_b64 v[64:65], 0
    v_mov_b64 v[62:63], 0
    v_mov_b64 v[60:61], 0
    v_mov_b64 v[58:59], 0
    v_mov_b64 v[56:57], 0
    v_mov_b64 v[54:55], 0
    v_mov_b64 v[52:53], 0
    v_mov_b64 v[50:51], 0
    v_mov_b64 v[48:49], 0
    s_waitcnt vmcnt(0)
    ds_read_b128 v[72:75], v2 offset:14336
    ds_read_b128 v[76:79], v2 offset:15360
    s_waitcnt lgkmcnt(0)
    s_bitcmp1_b64 s[80:81], s89
    s_cbranch_scc0 rec_kvw_f3
    s_branch rec_enter_f3
rec_g0_f3:
    s_mov_b64 exec, vcc
    buffer_load_dwordx4 v[16:19], v2, s[24:27], s79 offen offset:0 sc1
    buffer_load_dwordx4 v[20:23], v2, s[24:27], s79 offen offset:1024 sc1
    s_mov_b64 exec, -1
    s_add_u32 s84, s84, 1
    s_cmp_gt_u32 s84, 4194304
    s_cbranch_scc0 rec_enter_f3
    s_branch rec_ok0_f3
rec_lf_f3:
    v_mov_b32 v14, s72
    s_waitcnt vmcnt(5)
    s_mov_b64 exec, 1
    buffer_store_dword v14, off, s[24:27], s100 sc1
    s_mov_b64 exec, -1
    s_cmp_eq_u32 s72, 63
    s_cbranch_scc1 rec_fin
    s_branch rec_lfx_f3
rec_kvw_f3:
    s_add_u32 s61, s61, 1
    v_lshrrev_b32 v14, 2, v2
    buffer_load_dword v14, v14, s[24:27], s92 offen sc1
    s_waitcnt vmcnt(0)
    v_cmp_eq_u32 s[80:81], s70, v14
    s_cmp_gt_u32 s61, 4194304
    s_cbranch_scc1 rec_kvok_f3
    s_bitcmp1_b64 s[80:81], s89
    s_cbranch_scc0 rec_kvw_f3
    s_branch rec_kvok_f3
.p2align 6
rec_enter_f3:
    v_max3_u32 v0, v16, v17, v18
    v_max3_u32 v14, v19, v20, v21
    v_max3_u32 v0, v0, v22, v23
    v_max_u32 v0, v0, v14
    v_cmp_eq_u32_e64 vcc, -1, v0
    s_cbranch_vccz rec_ok0_f3
    v_max3_u32 v0, v16, v17, v18
    v_max3_u32 v14, v19, v20, v21
    v_max3_u32 v0, v0, v22, v23
    v_max_u32 v0, v0, v14
    v_cmp_eq_u32_e64 vcc, -1, v0
    s_cbranch_vccnz rec_g0_f3
rec_ok0_f3:
    v_smfmac_f32_16x16x64_bf16 v[64:67], v[16:19], v[88:95], v1
    ds_write_b128 v2, v[16:19] offset:22528
    v_smfmac_f32_16x16x64_bf16 v[68:71], v[16:19], v[96:103], v1
    ds_write_b128 v2, v[20:23] offset:23552
    v_smfmac_f32_16x16x64_bf16 v[64:67], v[20:23], v[104:111], v1
    v_smfmac_f32_16x16x64_bf16 v[68:71], v[20:23], v[112:119], v1
    v_smfmac_f32_16x16x64_bf16 v[48:51], v[16:19], a[48:55], v1
    v_smfmac_f32_16x16x64_bf16 v[52:55], v[16:19], a[112:119], v1
    s_waitcnt lgkmcnt(0)
    s_barrier
    ds_read_b128 v[24:27], v2 offset:16384
    v_smfmac_f32_16x16x64_bf16 v[48:51], v[20:23], a[56:63], v1
    ds_read_b128 v[28:31], v2 offset:17408
    ds_read_b128 v[32:35], v2 offset:18432
    v_smfmac_f32_16x16x64_bf16 v[52:55], v[20:23], a[120:127], v1
    ds_read_b128 v[36:39], v2 offset:19456
    ds_read_b128 v[40:43], v2 offset:20480
    v_smfmac_f32_16x16x64_bf16 v[56:59], v[16:19], a[176:183], v1
    ds_read_b128 v[44:47], v2 offset:21504
    v_smfmac_f32_16x16x64_bf16 v[60:63], v[16:19], a[240:247], v1
    buffer_store_dwordx4 v[120:123], v2, s[24:27], s96 offen sc1
    v_smfmac_f32_16x16x64_bf16 v[56:59], v[20:23], a[184:191], v1
    v_smfmac_f32_16x16x64_bf16 v[60:63], v[20:23], a[248:255], v1
    s_waitcnt lgkmcnt(5)
    s_mov_b32 m0, 14336
    v_smfmac_f32_16x16x64_bf16 v[48:51], v[24:27], a[0:7], v1
    buffer_load_dwordx4 v2, s[24:27], s91 offen sc1 lds
    v_smfmac_f32_16x16x64_bf16 v[52:55], v[24:27], a[64:71], v1
    s_waitcnt lgkmcnt(4)
    buffer_load_dwordx4 v2, s[24:27], s91 offen offset:1024 sc1 lds
    v_smfmac_f32_16x16x64_bf16 v[48:51], v[28:31], a[8:15], v1
    v_smfmac_f32_16x16x64_bf16 v[52:55], v[28:31], a[72:79], v1
    s_waitcnt lgkmcnt(0)
    v_smfmac_f32_16x16x64_bf16 v[48:51], v[32:35], a[16:23], v1
    ds_read_b128 v[88:91], v2 offset:0
    v_add_u32 v0, 0xffff0000, v7
    v_smfmac_f32_16x16x64_bf16 v[52:55], v[32:35], a[80:87], v1
    ds_read_b128 v[92:95], v2 offset:1024
    v_smfmac_f32_16x16x64_bf16 v[48:51], v[36:39], a[24:31], v1
    ds_read_b128 v[96:99], v2 offset:2048
    v_smfmac_f32_16x16x64_bf16 v[52:55], v[36:39], a[88:95], v1
    ds_read_b128 v[100:103], v2 offset:3072
    s_waitcnt vmcnt(3)
    v_smfmac_f32_16x16x64_bf16 v[48:51], v[40:43], a[32:39], v1
    ds_read_b128 v[120:123], v0 offset:32768
    v_smfmac_f32_16x16x64_bf16 v[52:55], v[40:43], a[96:103], v1
    ds_read_b128 v[124:127], v0 offset:33792
    v_smfmac_f32_16x16x64_bf16 v[48:51], v[44:47], a[40:47], v1
    ds_read_b128 v[16:19], v0 offset:34816
    v_smfmac_f32_16x16x64_bf16 v[52:55], v[44:47], a[104:111], v1
    ds_read_b128 v[20:23], v0 offset:35840
    v_smfmac_f32_16x16x64_bf16 v[56:59], v[24:27], a[128:135], v1
    ds_read_b128 v[104:107], v0 offset:49152
    v_add_f32_e64 v48, v48, v49
    v_smfmac_f32_16x16x64_bf16 v[60:63], v[24:27], a[192:199], v1
    ds_read_b128 v[108:111], v0 offset:50176
    v_add_f32_e64 v50, v50, v51
    v_smfmac_f32_16x16x64_bf16 v[56:59], v[28:31], a[136:143], v1
    ds_read_b128 v[112:115], v0 offset:51200
    v_add_f32_e64 v52, v52, v53
    v_smfmac_f32_16x16x64_bf16 v[60:63], v[28:31], a[200:207], v1
    ds_read_b128 v[116:119], v0 offset:52224
    v_add_f32_e64 v54, v54, v55
    v_smfmac_f32_16x16x64_bf16 v[56:59], v[32:35], a[144:151], v1
    buffer_store_dword v10, v9, s[24:27], s75 offen
    v_cvt_pk_bf16_f32 v48, v48, v52
    v_smfmac_f32_16x16x64_bf16 v[60:63], v[32:35], a[208:215], v1
    v_cvt_pk_bf16_f32 v49, v50, v54
    v_smfmac_f32_16x16x64_bf16 v[56:59], v[36:39], a[152:159], v1
    ds_write2_b32 v3, v48, v49 offset0:0 offset1:136
    v_smfmac_f32_16x16x64_bf16 v[60:63], v[36:39], a[216:223], v1
    v_smfmac_f32_16x16x64_bf16 v[56:59], v[40:43], a[160:167], v1
    v_smfmac_f32_16x16x64_bf16 v[60:63], v[40:43], a[224:231], v1
    v_smfmac_f32_16x16x64_bf16 v[56:59], v[44:47], a[168:175], v1
    v_smfmac_f32_16x16x64_bf16 v[60:63], v[44:47], a[232:239], v1
    s_waitcnt lgkmcnt(1)
    v_smfmac_f32_16x16x64_bf16 v[64:67], v[24:27], v[120:127], v1
    v_add_f32 v56, v56, v57
    v_smfmac_f32_16x16x64_bf16 v[68:71], v[24:27], v[16:23], v1
    s_waitcnt lgkmcnt(0)
    s_barrier
    v_add_f32_e64 v58, v58, v59
    v_smfmac_f32_16x16x64_bf16 v[64:67], v[28:31], v[104:111], v1
    ds_read_b128 v[16:19], v4 offset:0
    ds_read_b128 v[20:23], v4 offset:64
    v_add_f32_e64 v60, v60, v61
    v_smfmac_f32_16x16x64_bf16 v[68:71], v[28:31], v[112:119], v1
    ds_read_b128 v[120:123], v4 offset:128
    ds_read_b128 v[124:127], v4 offset:192
    v_add_f32_e64 v62, v62, v63
    v_smfmac_f32_16x16x64_bf16 v[64:67], v[32:35], v[160:167], v1
    ds_read_b128 v[104:107], v2 offset:4096
    ds_read_b128 v[108:111], v2 offset:5120
    v_cvt_pk_bf16_f32 v56, v56, v60
    v_smfmac_f32_16x16x64_bf16 v[64:67], v[36:39], v[168:175], v1
    ds_read_b128 v[112:115], v2 offset:6144
    ds_read_b128 v[116:119], v2 offset:7168
    v_cvt_pk_bf16_f32 v57, v58, v62
    v_smfmac_f32_16x16x64_bf16 v[64:67], v[40:43], v[176:183], v1
    ds_write2_b32 v3, v56, v57 offset0:64 offset1:200
    v_smfmac_f32_16x16x64_bf16 v[64:67], v[44:47], v[184:191], v1
    v_smfmac_f32_16x16x64_bf16 v[68:71], v[32:35], v[224:231], v1
    v_mov_b64_e64 v[24:25], 0
    v_smfmac_f32_16x16x64_bf16 v[68:71], v[36:39], v[232:239], v1
    s_waitcnt lgkmcnt(5)
    v_mov_b64 v[26:27], 0
    v_mfma_f32_16x16x32_bf16 v[48:51], v[88:91], v[16:19], 0
    v_mov_b64 v[28:29], 0
    v_mov_b64 v[30:31], 0
    v_mfma_f32_16x16x32_bf16 v[48:51], v[92:95], v[20:23], v[48:51]
    s_mov_b32 m0, 6144
    v_mov_b64 v[32:33], 0
    v_mov_b64 v[34:35], 0
    v_mfma_f32_16x16x32_bf16 v[48:51], v[96:99], v[120:123], v[48:51]
    s_waitcnt lgkmcnt(0)
    s_barrier
    ds_read_b128 v[88:91], v5 offset:0
    v_mfma_f32_16x16x32_bf16 v[48:51], v[100:103], v[124:127], v[48:51]
    ds_read_b128 v[92:95], v5 offset:64
    ds_read_b128 v[96:99], v5 offset:128
    ds_read_b128 v[100:103], v5 offset:192
    v_mfma_f32_16x16x32_bf16 v[52:55], v[104:107], v[16:19], 0
    buffer_load_dwordx4 v2, s[24:27], s90 offen sc1 lds
    v_add_f32 v64, v64, v65
    v_add_f32 v66, v66, v67
    v_mfma_f32_16x16x32_bf16 v[52:55], v[108:111], v[20:23], v[52:55]
    buffer_load_dwordx4 v2, s[24:27], s90 offen offset:1024 sc1 lds
    v_mfma_f32_16x16x32_bf16 v[52:55], v[112:115], v[120:123], v[52:55]
    v_cvt_pk_bf16_f32 v84, v64, v66
    v_max3_f32 v0, v48, v49, v50
    v_mfma_f32_16x16x32_bf16 v[52:55], v[116:119], v[124:127], v[52:55]
    v_mov_b64 v[36:37], 0
    v_mov_b64 v[38:39], 0
    v_smfmac_f32_16x16x64_bf16 v[68:71], v[40:43], v[240:247], v1
    ds_read_b128 v[104:107], v7 offset:0
    ds_read_b128 v[108:111], v7 offset:1024
    v_smfmac_f32_16x16x64_bf16 v[68:71], v[44:47], v[248:255], v1
    s_waitcnt lgkmcnt(2)
    ds_read_b128 v[112:115], v7 offset:16384
    ds_read_b128 v[116:119], v7 offset:17408
    v_max3_f32 v58, v51, v52, v53
    v_mfma_f32_16x16x32_bf16 v[60:63], v[88:91], v[16:19], 0
    s_cmp_ge_u32 s72, 59
    v_max3_f32 v0, v0, v54, v55
    v_max_f32_e64 v0, v0, v58
    v_mfma_f32_16x16x32_bf16 v[60:63], v[92:95], v[20:23], v[60:63]
    s_cbranch_scc1 rec_lf_f3
rec_lfx_f3:
    v_mov_b32 v58, v0
    v_mfma_f32_16x16x32_bf16 v[60:63], v[96:99], v[120:123], v[60:63]
    ds_read_b128 v[88:91], v7 offset:2048
    ds_read_b128 v[92:95], v7 offset:3072
    v_add_f32 v68, v68, v69
    v_add_f32 v70, v70, v71
    v_mfma_f32_16x16x32_bf16 v[60:63], v[100:103], v[124:127], v[60:63]
    v_permlane16_swap_b32 v58, v0
    v_cvt_pk_bf16_f32 v86, v68, v70
    v_max_f32 v0, v0, v58
    v_cndmask_b32 v52, v48, v52, s[82:83]
    v_cndmask_b32 v53, v49, v53, s[82:83]
    v_cndmask_b32 v54, v50, v54, s[82:83]
    v_cndmask_b32 v55, v51, v55, s[82:83]
    v_pk_mul_f32 v[52:53], v[52:53], s[86:87]
    v_max3_f32 v0, v0, v60, v61
    v_max3_f32 v0, v0, v62, v63
    v_mov_b32_e64 v58, v0
    v_pk_mul_f32 v[60:61], v[60:61], s[86:87]
    v_pk_mul_f32 v[54:55], v[54:55], s[86:87]
    v_permlane32_swap_b32 v58, v0
    v_max_f32 v0, v58, v0
    v_mul_f32_e64 v58, s86, v0
    v_pk_add_f32 v[60:61], v[60:61], v[58:59] op_sel_hi:[1,0] neg_lo:[0,1] neg_hi:[0,1]
    v_pk_add_f32 v[52:53], v[52:53], v[58:59] op_sel_hi:[1,0] neg_lo:[0,1] neg_hi:[0,1]
    v_pk_add_f32 v[54:55], v[54:55], v[58:59] op_sel_hi:[1,0] neg_lo:[0,1] neg_hi:[0,1]
    v_exp_f32 v60, v60
    v_exp_f32 v61, v61
    v_exp_f32_e64 v52, v52
    v_cvt_pk_bf16_f32 v14, v60, v61
    v_exp_f32 v53, v53
    v_exp_f32 v54, v54
    v_mfma_f32_16x16x16_bf16 v[60:63], v[80:81], v[14:15], 0
    v_exp_f32_e64 v55, v55
    v_cvt_pk_bf16_f32 v52, v52, v53
    v_mfma_f32_16x16x16_bf16 v[64:67], v[84:85], v[14:15], 0
    v_cvt_pk_bf16_f32 v53, v54, v55
    v_mov_b32 v48, v52 quad_perm:[0,0,2,2] row_mask:0xf bank_mask:0xf
    v_mfma_f32_16x16x16_bf16 v[68:71], v[86:87], v[14:15], 0
    v_mov_b32 v50, v52 quad_perm:[1,1,3,3] row_mask:0xf bank_mask:0xf
    v_mov_b32 v49, v53 quad_perm:[0,0,2,2] row_mask:0xf bank_mask:0xf
    v_mov_b32 v51, v53 quad_perm:[1,1,3,3] row_mask:0xf bank_mask:0xf
    s_nop 1
    v_mfma_f32_16x16x32_bf16 v[60:63], v[80:83], v[48:51], v[60:63]
    v_mfma_f32_16x16x32_bf16 v[64:67], v[72:75], v[48:51], v[64:67]
    v_mfma_f32_16x16x32_bf16 v[68:71], v[76:79], v[48:51], v[68:71]
    v_rcp_f32 v60, v60
    v_mov_b64 v[72:73], 0
    v_mov_b64 v[74:75], 0
    v_mov_b64 v[76:77], 0
    v_mov_b64 v[78:79], 0
    v_mov_b64 v[48:49], 0
    v_mov_b64 v[50:51], 0
    v_mov_b64_e64 v[52:53], 0
    v_cndmask_b32 v64, v64, v68, s[82:83]
    v_cndmask_b32 v65, v65, v69, s[82:83]
    v_cndmask_b32 v66, v66, v70, s[82:83]
    v_cndmask_b32 v67, v67, v71, s[82:83]
    v_pk_mul_f32 v[64:65], v[64:65], v[60:61] op_sel_hi:[1,0]
    v_pk_mul_f32 v[66:67], v[66:67], v[60:61] op_sel_hi:[1,0]
    v_cvt_pk_bf16_f32 v68, v64, v65
    v_cvt_pk_bf16_f32 v69, v66, v67
    ds_write_b64 v6, v[68:69]
    v_mov_b64 v[54:55], 0
    s_mov_b32 s88, s73
    s_mov_b32 s73, s74
    s_mov_b32 s74, s75
    s_mov_b32 s75, s88
    s_add_u32 s79, s73, s85
    s_waitcnt lgkmcnt(0)
    s_barrier
    ds_read_b128 v[56:59], v2 offset:29184
    ds_read_b128 v[60:63], v2 offset:30208
    s_mov_b32 s99, s98
    s_waitcnt lgkmcnt(1)
    v_smfmac_f32_16x16x64_bf16 v[24:27], v[56:59], v[128:135], v1
    s_waitcnt lgkmcnt(0)
    v_smfmac_f32_16x16x64_bf16 v[24:27], v[60:63], v[192:199], v1
    v_smfmac_f32_16x16x64_bf16 v[28:31], v[56:59], v[136:143], v1
    ds_read_b128 v[96:99], v7 offset:18432
    ds_read_b128 v[100:103], v7 offset:19456
    v_smfmac_f32_16x16x64_bf16 v[28:31], v[60:63], v[200:207], v1
    ds_read_b128 v[16:19], v7 offset:32768
    ds_read_b128 v[20:23], v7 offset:33792
    v_add_f32 v24, v24, v25
    v_add_f32_e64 v26, v26, v27
    v_smfmac_f32_16x16x64_bf16 v[32:35], v[56:59], v[144:151], v1
    ds_read_b128 v[120:123], v7 offset:49152
    ds_read_b128 v[124:127], v7 offset:50176
    v_cvt_pk_bf16_f32 v24, v24, v26
    v_smfmac_f32_16x16x64_bf16 v[32:35], v[60:63], v[208:215], v1
    ds_read_b128 v[40:43], v7 offset:34816
    ds_read_b128 v[44:47], v7 offset:35840
    v_add_f32 v28, v28, v29
    v_add_f32 v30, v30, v31
    v_smfmac_f32_16x16x64_bf16 v[36:39], v[56:59], v[152:159], v1
    ds_read_b128 v[64:67], v7 offset:51200
    ds_read_b128 v[68:71], v7 offset:52224
    v_cvt_pk_bf16_f32 v25, v28, v30
    v_smfmac_f32_16x16x64_bf16 v[36:39], v[60:63], v[216:223], v1
    buffer_store_dwordx2 v[24:25], v8, s[24:27], s76 offen
    v_add_f32 v32, v32, v33
    v_add_f32 v34, v34, v35
    v_smfmac_f32_16x16x64_bf16 v[72:75], v[56:59], v[104:111], v1
    v_cvt_pk_bf16_f32 v32, v32, v34
    v_smfmac_f32_16x16x64_bf16 v[72:75], v[60:63], v[112:119], v1
    v_add_f32 v36, v36, v37
    v_add_f32 v38, v38, v39
    v_smfmac_f32_16x16x64_bf16 v[76:79], v[56:59], v[88:95], v1
    s_waitcnt lgkmcnt(0)
    v_cvt_pk_bf16_f32 v33, v36, v38
    v_smfmac_f32_16x16x64_bf16 v[76:79], v[60:63], v[96:103], v1
    buffer_store_dwordx2 v[32:33], v8, s[24:27], s65 offen
    v_add_f32 v72, v72, v73
    v_add_f32_e64 v74, v74, v75
    v_smfmac_f32_16x16x64_bf16 v[48:51], v[56:59], v[16:23], v1
    v_cvt_pk_bf16_f32 v72, v72, v74
    v_smfmac_f32_16x16x64_bf16 v[48:51], v[60:63], v[120:127], v1
    v_add_f32 v76, v76, v77
    v_add_f32 v78, v78, v79
    v_smfmac_f32_16x16x64_bf16 v[52:55], v[56:59], v[40:47], v1
    v_cvt_pk_bf16_f32 v73, v76, v78
    v_smfmac_f32_16x16x64_bf16 v[52:55], v[60:63], v[64:71], v1
    buffer_store_dwordx2 v[72:73], v8, s[24:27], s66 offen
    v_add_f32 v48, v48, v49
    v_add_f32 v50, v50, v51
    v_cvt_pk_bf16_f32 v48, v48, v50
    s_nop 3
    v_add_f32 v52, v52, v53
    v_add_f32_e64 v54, v54, v55
    v_cvt_pk_bf16_f32 v49, v52, v54
    buffer_store_dwordx2 v[48:49], v8, s[24:27], s67 offen
    v_mov_b64 v[24:25], -1
    v_mov_b64 v[26:27], -1
    v_mov_b64 v[28:29], -1
    v_mov_b64 v[30:31], -1
    v_mov_b64 v[70:71], 0
    v_mov_b64 v[68:69], 0
    v_mov_b64 v[66:67], 0
    v_mov_b64 v[64:65], 0
    v_mov_b64 v[62:63], 0
    v_mov_b64 v[60:61], 0
    v_mov_b64 v[58:59], 0
    v_mov_b64 v[56:57], 0
    v_mov_b64 v[54:55], 0
    v_mov_b64 v[52:53], 0
    v_mov_b64 v[50:51], 0
    v_mov_b64 v[48:49], 0
    v_mov_b64 v[16:17], -1
    v_mov_b64 v[18:19], -1
    v_mov_b64 v[20:21], -1
    v_mov_b64 v[22:23], -1
    v_add_u32 v0, 0xffff0000, v7
    ds_read_b128 v[88:91], v0 offset:0
    ds_read_b128 v[92:95], v0 offset:1024
    ds_read_b128 v[96:99], v0 offset:2048
    ds_read_b128 v[100:103], v0 offset:3072
    ds_read_b128 v[104:107], v0 offset:16384
    ds_read_b128 v[108:111], v0 offset:17408
    ds_read_b128 v[112:115], v0 offset:18432
    ds_read_b128 v[116:119], v0 offset:19456
    ds_read2_b32 v[120:121], v3 offset0:64 offset1:200
    v_mov_b32 v122, v84
    v_mov_b32 v123, v86
    s_mov_b32 s88, s76
    s_mov_b32 s76, s77
    s_mov_b32 s77, s78
    s_mov_b32 s78, s88
    buffer_load_dwordx4 v[24:27], v2, s[24:27], s99 offen offset:0 sc1
    buffer_load_dwordx4 v[28:31], v2, s[24:27], s99 offen offset:1024 sc1
    s_and_b32 s88, s72, 63
    s_lshl_b32 s88, s88, 17
    s_waitcnt vmcnt(6)
rec_rs_f3:
    s_add_u32 s84, s84, 1
    s_cmp_gt_u32 s84, 4194304
    v_max3_u32 v0, v24, v25, v26
    v_max3_u32 v14, v27, v28, v29
    v_max3_u32 v0, v0, v30, v31
    v_mfma_f32_16x16x32_bf16 v[124:127], v[80:83], v[24:27], 0
    v_max_u32 v0, v0, v14
    v_cmp_eq_u32 vcc, -1, v0
    v_mfma_f32_16x16x32_bf16 v[124:127], v[80:83], v[28:31], v[124:127]
    s_cbranch_vccz rec_go_f3
    s_mov_b64 exec, vcc
    buffer_load_dwordx4 v[24:27], v2, s[24:27], s99 offen offset:0 sc1
    buffer_load_dwordx4 v[28:31], v2, s[24:27], s99 offen offset:1024 sc1
    s_mov_b64 exec, -1
    v_max3_u32 v0, v24, v25, v26
    v_max3_u32 v14, v27, v28, v29
    v_max3_u32 v0, v0, v30, v31
    v_mfma_f32_16x16x32_bf16 v[124:127], v[80:83], v[24:27], 0
    v_max_u32 v0, v0, v14
    v_cmp_eq_u32_e64 vcc, -1, v0
    v_mfma_f32_16x16x32_bf16 v[124:127], v[80:83], v[28:31], v[124:127]
    s_cselect_b64 vcc, 0, vcc
    s_cbranch_vccnz rec_rs_f3
rec_go_f3:
    v_lshrrev_b32_e64 v0, 2, v2
    ds_read_b32 v14, v0 offset:31232
    ds_read_b128 v[72:75], v2 offset:14336
    ds_read_b128 v[76:79], v2 offset:15360
    s_nop 2
    v_add_f32 v126, v126, v126 row_ror:4 row_mask:0xf bank_mask:0xf
    v_add_f32 v127, v127, v127 row_ror:4 row_mask:0xf bank_mask:0xf
    s_nop 0
    v_add_f32 v126, v126, v126 row_ror:8 row_mask:0xf bank_mask:0xf
    v_add_f32 v127, v127, v127 row_ror:8 row_mask:0xf bank_mask:0xf
    v_cvt_pk_bf16_f32 v124, v126, v127
    buffer_store_dword v124, v9, s[24:27], s73 offen
    s_add_u32 s96, s63, s88
    s_mov_b32 s93, s72
    s_add_u32 s72, s72, 1
    s_add_u32 s89, s72, 1
    s_min_u32 s89, s89, 63
    s_and_b32 s88, s89, 63
    s_lshl_b32 s88, s88, 18
    s_add_u32 s88, s88, s94
    s_add_u32 s90, s88, 33554432
    s_add_u32 s91, s88, 50331648
    s_add_u32 s97, s78, s95
    s_add_u32 s98, s76, s95
    s_add_u32 s65, s76, 65536
    s_add_u32 s66, s76, 131072
    s_add_u32 s67, s76, 196608
    s_waitcnt lgkmcnt(0)
    v_cmp_eq_u32 s[80:81], s70, v14
    buffer_load_dwordx4 v[16:19], v2, s[24:27], s79 offen offset:0 sc1
    buffer_load_dwordx4 v[20:23], v2, s[24:27], s79 offen offset:1024 sc1
    s_bitcmp1_b64 s[80:81], s89
    s_cbranch_scc0 rec_kvw_f3
rec_kvok_f3:
    s_branch rec_enter_f3
rec_f0_f3:
    s_mov_b64 exec, vcc
    buffer_load_dwordx4 v[24:27], v2, s[24:27], s99 offen offset:0 sc1
    buffer_load_dwordx4 v[28:31], v2, s[24:27], s99 offen offset:1024 sc1
    s_mov_b64 exec, -1
    s_add_u32 s84, s84, 1
    s_cmp_gt_u32 s84, 4194304
    s_cbranch_scc0 rec_rs_f3
    s_branch rec_go_f3
rec_redo_s0:
    buffer_load_dwordx4 v[16:19], v2, s[24:27], s79 offen offset:0 sc1
    buffer_load_dwordx4 v[20:23], v2, s[24:27], s79 offen offset:1024 sc1
    v_add_u32 v0, 0xffff0000, v7
    ds_read_b128 v[88:91], v0 offset:0
    ds_read_b128 v[92:95], v0 offset:1024
    ds_read_b128 v[96:99], v0 offset:2048
    ds_read_b128 v[100:103], v0 offset:3072
    ds_read_b128 v[104:107], v0 offset:16384
    ds_read_b128 v[108:111], v0 offset:17408
    ds_read_b128 v[112:115], v0 offset:18432
    ds_read_b128 v[116:119], v0 offset:19456
    v_mov_b64 v[70:71], 0
    v_mov_b64 v[68:69], 0
    v_mov_b64 v[66:67], 0
    v_mov_b64 v[64:65], 0
    v_mov_b64 v[62:63], 0
    v_mov_b64 v[60:61], 0
    v_mov_b64 v[58:59], 0
    v_mov_b64 v[56:57], 0
    v_mov_b64 v[54:55], 0
    v_mov_b64 v[52:53], 0
    v_mov_b64 v[50:51], 0
    v_mov_b64 v[48:49], 0
    s_waitcnt vmcnt(0)
    ds_read_b128 v[72:75], v2 offset:8192
    ds_read_b128 v[76:79], v2 offset:9216
    s_waitcnt lgkmcnt(0)
    s_bitcmp1_b64 s[80:81], s89
    s_cbranch_scc0 rec_kvw_s0
    s_branch rec_enter_s0
rec_g0_s0:
    s_mov_b64 exec, vcc
    buffer_load_dwordx4 v[16:19], v2, s[24:27], s79 offen offset:0 sc1
    buffer_load_dwordx4 v[20:23], v2, s[24:27], s79 offen offset:1024 sc1
    s_mov_b64 exec, -1
    s_add_u32 s84, s84, 1
    s_cmp_gt_u32 s84, 4194304
    s_cbranch_scc0 rec_enter_s0
    s_branch rec_ok0_s0
rec_lf_s0:
    v_mov_b32 v14, s72
    s_waitcnt vmcnt(5)
    s_mov_b64 exec, 1
    buffer_store_dword v14, off, s[24:27], s100 sc1
    s_mov_b64 exec, -1
    s_cmp_eq_u32 s72, 63
    s_cbranch_scc1 rec_fin
    s_branch rec_lfx_s0
rec_kvw_s0:
    s_add_u32 s61, s61, 1
    v_lshrrev_b32 v14, 2, v2
    buffer_load_dword v14, v14, s[24:27], s92 offen sc1
    s_waitcnt vmcnt(0)
    v_cmp_eq_u32 s[80:81], s70, v14
    s_cmp_gt_u32 s61, 4194304
    s_cbranch_scc1 rec_kvok_s0
    s_bitcmp1_b64 s[80:81], s89
    s_cbranch_scc0 rec_kvw_s0
    s_branch rec_kvok_s0
.p2align 6
rec_enter_s0:
    v_max3_u32 v0, v16, v17, v18
    v_max3_u32 v14, v19, v20, v21
    v_max3_u32 v0, v0, v22, v23
    v_max_u32 v0, v0, v14
    v_cmp_eq_u32_e64 vcc, -1, v0
    s_cbranch_vccz rec_ok0_s0
    v_max3_u32 v0, v16, v17, v18
    v_max3_u32 v14, v19, v20, v21
    v_max3_u32 v0, v0, v22, v23
    v_max_u32 v0, v0, v14
    v_cmp_eq_u32_e64 vcc, -1, v0
    s_cbranch_vccnz rec_g0_s0
rec_ok0_s0:
    v_smfmac_f32_16x16x64_bf16 v[64:67], v[16:19], v[88:95], v1
    ds_write_b128 v2, v[16:19] offset:16384
    v_smfmac_f32_16x16x64_bf16 v[68:71], v[16:19], v[96:103], v1
    ds_write_b128 v2, v[20:23] offset:17408
    v_smfmac_f32_16x16x64_bf16 v[64:67], v[20:23], v[104:111], v1
    v_smfmac_f32_16x16x64_bf16 v[68:71], v[20:23], v[112:119], v1
    v_smfmac_f32_16x16x64_bf16 v[48:51], v[16:19], a[0:7], v1
    v_smfmac_f32_16x16x64_bf16 v[52:55], v[16:19], a[64:71], v1
    v_smfmac_f32_16x16x64_bf16 v[48:51], v[20:23], a[8:15], v1
    v_smfmac_f32_16x16x64_bf16 v[52:55], v[20:23], a[72:79], v1
    v_smfmac_f32_16x16x64_bf16 v[56:59], v[16:19], a[128:135], v1
    s_waitcnt lgkmcnt(0)
    s_barrier
    ds_read_b128 v[24:27], v2 offset:18432
    v_smfmac_f32_16x16x64_bf16 v[60:63], v[16:19], a[192:199], v1
    ds_read_b128 v[28:31], v2 offset:19456
    ds_read_b128 v[32:35], v2 offset:20480
    buffer_store_dwordx4 v[120:123], v2, s[24:27], s96 offen sc1
    v_smfmac_f32_16x16x64_bf16 v[56:59], v[20:23], a[136:143], v1
    ds_read_b128 v[36:39], v2 offset:21504
    ds_read_b128 v[40:43], v2 offset:22528
    v_smfmac_f32_16x16x64_bf16 v[60:63], v[20:23], a[200:207], v1
    ds_read_b128 v[44:47], v2 offset:23552
    s_waitcnt lgkmcnt(5)
    s_mov_b32 m0, 8192
    v_smfmac_f32_16x16x64_bf16 v[48:51], v[24:27], a[16:23], v1
    buffer_load_dwordx4 v2, s[24:27], s91 offen sc1 lds
    v_smfmac_f32_16x16x64_bf16 v[52:55], v[24:27], a[80:87], v1
    s_waitcnt lgkmcnt(4)
    buffer_load_dwordx4 v2, s[24:27], s91 offen offset:1024 sc1 lds
    v_smfmac_f32_16x16x64_bf16 v[48:51], v[28:31], a[24:31], v1
    v_smfmac_f32_16x16x64_bf16 v[52:55], v[28:31], a[88:95], v1
    s_waitcnt lgkmcnt(0)
    v_smfmac_f32_16x16x64_bf16 v[48:51], v[32:35], a[32:39], v1
    ds_read_b128 v[88:91], v2 offset:0
    v_add_u32 v0, 0xffff0000, v7
    v_smfmac_f32_16x16x64_bf16 v[52:55], v[32:35], a[96:103], v1
    ds_read_b128 v[92:95], v2 offset:1024
    v_mov_b32 v14, s93
    v_smfmac_f32_16x16x64_bf16 v[48:51], v[36:39], a[40:47], v1
    ds_read_b128 v[96:99], v2 offset:2048
    s_add_u32 s60, s97, 131072
    v_smfmac_f32_16x16x64_bf16 v[52:55], v[36:39], a[104:111], v1
    ds_read_b128 v[100:103], v2 offset:3072
    s_waitcnt vmcnt(3)
    v_smfmac_f32_16x16x64_bf16 v[48:51], v[40:43], a[48:55], v1
    ds_read_b128 v[120:123], v0 offset:32768
    buffer_store_dwordx4 v[10:13], v2, s[24:27], s97 offen offset:0 sc1
    v_smfmac_f32_16x16x64_bf16 v[52:55], v[40:43], a[112:119], v1
    ds_read_b128 v[124:127], v0 offset:33792
    v_smfmac_f32_16x16x64_bf16 v[48:51], v[44:47], a[56:63], v1
    ds_read_b128 v[16:19], v0 offset:34816
    buffer_store_dwordx4 v[10:13], v2, s[24:27], s97 offen offset:1024 sc1
    v_smfmac_f32_16x16x64_bf16 v[52:55], v[44:47], a[120:127], v1
    ds_read_b128 v[20:23], v0 offset:35840
    v_smfmac_f32_16x16x64_bf16 v[56:59], v[24:27], a[144:151], v1
    ds_read_b128 v[104:107], v0 offset:49152
    v_add_f32 v48, v48, v49
    v_smfmac_f32_16x16x64_bf16 v[60:63], v[24:27], a[208:215], v1
    ds_read_b128 v[108:111], v0 offset:50176
    v_add_f32_e64 v50, v50, v51
    v_smfmac_f32_16x16x64_bf16 v[56:59], v[28:31], a[152:159], v1
    ds_read_b128 v[112:115], v0 offset:51200
    v_add_f32_e64 v52, v52, v53
    v_smfmac_f32_16x16x64_bf16 v[60:63], v[28:31], a[216:223], v1
    ds_read_b128 v[116:119], v0 offset:52224
    v_add_f32_e64 v54, v54, v55
    v_smfmac_f32_16x16x64_bf16 v[56:59], v[32:35], a[160:167], v1
    buffer_store_dword v10, v9, s[24:27], s75 offen sc1
    v_cvt_pk_bf16_f32 v48, v48, v52
    v_smfmac_f32_16x16x64_bf16 v[60:63], v[32:35], a[224:231], v1
    v_cvt_pk_bf16_f32 v49, v50, v54
    v_smfmac_f32_16x16x64_bf16 v[56:59], v[36:39], a[168:175], v1
    ds_write2_b32 v3, v48, v49 offset0:0 offset1:136
    v_smfmac_f32_16x16x64_bf16 v[60:63], v[36:39], a[232:239], v1
    buffer_store_dwordx4 v[10:13], v2, s[24:27], s60 offen offset:0 sc1
    v_smfmac_f32_16x16x64_bf16 v[56:59], v[40:43], a[176:183], v1
    v_lshrrev_b32_e64 v0, 2, v2
    v_smfmac_f32_16x16x64_bf16 v[60:63], v[40:43], a[240:247], v1
    buffer_store_dwordx4 v[10:13], v2, s[24:27], s60 offen offset:1024 sc1
    s_cmp_lt_u32 s72, 60
    v_smfmac_f32_16x16x64_bf16 v[56:59], v[44:47], a[184:191], v1
    s_cselect_b64 exec, 15, 0
    buffer_store_dword v14, v0, s[24:27], s100 offen sc1
    s_mov_b64 exec, -1
    v_smfmac_f32_16x16x64_bf16 v[60:63], v[44:47], a[248:255], v1
    s_waitcnt lgkmcnt(1)
    v_smfmac_f32_16x16x64_bf16 v[64:67], v[24:27], v[120:127], v1
    v_add_f32_e64 v56, v56, v57
    v_smfmac_f32_16x16x64_bf16 v[68:71], v[24:27], v[16:23], v1
    s_waitcnt lgkmcnt(0)
    s_barrier
    v_add_f32_e64 v58, v58, v59
    v_smfmac_f32_16x16x64_bf16 v[64:67], v[28:31], v[104:111], v1
    ds_read_b128 v[16:19], v4 offset:0
    ds_read_b128 v[20:23], v4 offset:64
    v_add_f32_e64 v60, v60, v61
    v_smfmac_f32_16x16x64_bf16 v[68:71], v[28:31], v[112:119], v1
    ds_read_b128 v[120:123], v4 offset:128
    ds_read_b128 v[124:127], v4 offset:192
    v_add_f32_e64 v62, v62, v63
    v_smfmac_f32_16x16x64_bf16 v[64:67], v[32:35], v[160:167], v1
    ds_read_b128 v[104:107], v2 offset:4096
    ds_read_b128 v[108:111], v2 offset:5120
    v_cvt_pk_bf16_f32 v56, v56, v60
    v_smfmac_f32_16x16x64_bf16 v[64:67], v[36:39], v[168:175], v1
    ds_read_b128 v[112:115], v2 offset:6144
    ds_read_b128 v[116:119], v2 offset:7168
    v_cvt_pk_bf16_f32 v57, v58, v62
    v_smfmac_f32_16x16x64_bf16 v[64:67], v[40:43], v[176:183], v1
    ds_write2_b32 v3, v56, v57 offset0:64 offset1:200
    v_smfmac_f32_16x16x64_bf16 v[64:67], v[44:47], v[184:191], v1
    v_smfmac_f32_16x16x64_bf16 v[68:71], v[32:35], v[224:231], v1
    v_mov_b64_e64 v[24:25], 0
    v_smfmac_f32_16x16x64_bf16 v[68:71], v[36:39], v[232:239], v1
    s_waitcnt lgkmcnt(5)
    v_mov_b64 v[26:27], 0
    v_mfma_f32_16x16x32_bf16 v[48:51], v[88:91], v[16:19], 0
    v_mov_b64 v[28:29], 0
    v_mov_b64 v[30:31], 0
    v_mfma_f32_16x16x32_bf16 v[48:51], v[92:95], v[20:23], v[48:51]
    s_mov_b32 m0, 0
    v_mov_b64 v[32:33], 0
    v_mov_b64_e64 v[34:35], 0
    v_mfma_f32_16x16x32_bf16 v[48:51], v[96:99], v[120:123], v[48:51]
    s_waitcnt lgkmcnt(0)
    s_barrier
    ds_read_b128 v[88:91], v5 offset:0
    v_mfma_f32_16x16x32_bf16 v[48:51], v[100:103], v[124:127], v[48:51]
    ds_read_b128 v[92:95], v5 offset:64
    ds_read_b128 v[96:99], v5 offset:128
    ds_read_b128 v[100:103], v5 offset:192
    v_mfma_f32_16x16x32_bf16 v[52:55], v[104:107], v[16:19], 0
    buffer_load_dwordx4 v2, s[24:27], s90 offen sc1 lds
    v_add_f32 v64, v64, v65
    v_add_f32 v66, v66, v67
    v_mfma_f32_16x16x32_bf16 v[52:55], v[108:111], v[20:23], v[52:55]
    buffer_load_dwordx4 v2, s[24:27], s90 offen offset:1024 sc1 lds
    v_mfma_f32_16x16x32_bf16 v[52:55], v[112:115], v[120:123], v[52:55]
    v_cvt_pk_bf16_f32 v84, v64, v66
    v_max3_f32 v0, v48, v49, v50
    v_mfma_f32_16x16x32_bf16 v[52:55], v[116:119], v[124:127], v[52:55]
    v_mov_b64 v[36:37], 0
    v_mov_b64 v[38:39], 0
    v_smfmac_f32_16x16x64_bf16 v[68:71], v[40:43], v[240:247], v1
    ds_read_b128 v[104:107], v7 offset:0
    ds_read_b128 v[108:111], v7 offset:1024
    v_smfmac_f32_16x16x64_bf16 v[68:71], v[44:47], v[248:255], v1
    s_waitcnt lgkmcnt(2)
    ds_read_b128 v[112:115], v7 offset:16384
    ds_read_b128 v[116:119], v7 offset:17408
    v_max3_f32 v58, v51, v52, v53
    v_mfma_f32_16x16x32_bf16 v[60:63], v[88:91], v[16:19], 0
    s_cmp_ge_u32 s72, 59
    v_max3_f32 v0, v0, v54, v55
    v_max_f32_e64 v0, v0, v58
    v_mfma_f32_16x16x32_bf16 v[60:63], v[92:95], v[20:23], v[60:63]
    s_cbranch_scc1 rec_lf_s0
rec_lfx_s0:
    v_mov_b32 v58, v0
    v_mfma_f32_16x16x32_bf16 v[60:63], v[96:99], v[120:123], v[60:63]
    ds_read_b128 v[88:91], v7 offset:2048
    ds_read_b128 v[92:95], v7 offset:3072
    v_add_f32 v68, v68, v69
    v_add_f32 v70, v70, v71
    v_mfma_f32_16x16x32_bf16 v[60:63], v[100:103], v[124:127], v[60:63]
    v_permlane16_swap_b32 v58, v0
    v_cvt_pk_bf16_f32 v86, v68, v70
    v_max_f32 v0, v0, v58
    v_cndmask_b32 v52, v48, v52, s[82:83]
    v_cndmask_b32 v53, v49, v53, s[82:83]
    v_cndmask_b32 v54, v50, v54, s[82:83]
    v_cndmask_b32 v55, v51, v55, s[82:83]
    v_pk_mul_f32 v[52:53], v[52:53], s[86:87]
    v_max3_f32 v0, v0, v60, v61
    v_max3_f32 v0, v0, v62, v63
    v_mov_b32_e64 v58, v0
    v_pk_mul_f32 v[60:61], v[60:61], s[86:87]
    v_pk_mul_f32 v[54:55], v[54:55], s[86:87]
    v_permlane32_swap_b32 v58, v0
    v_max_f32 v0, v58, v0
    v_mul_f32_e64 v58, s86, v0
    v_pk_add_f32 v[60:61], v[60:61], v[58:59] op_sel_hi:[1,0] neg_lo:[0,1] neg_hi:[0,1]
    v_pk_add_f32 v[52:53], v[52:53], v[58:59] op_sel_hi:[1,0] neg_lo:[0,1] neg_hi:[0,1]
    v_pk_add_f32 v[54:55], v[54:55], v[58:59] op_sel_hi:[1,0] neg_lo:[0,1] neg_hi:[0,1]
    v_exp_f32 v60, v60
    v_exp_f32 v61, v61
    v_exp_f32_e64 v52, v52
    v_cvt_pk_bf16_f32 v14, v60, v61
    v_exp_f32 v53, v53
    v_exp_f32 v54, v54
    v_mfma_f32_16x16x16_bf16 v[60:63], v[80:81], v[14:15], 0
    v_exp_f32_e64 v55, v55
    v_cvt_pk_bf16_f32 v52, v52, v53
    v_mfma_f32_16x16x16_bf16 v[64:67], v[84:85], v[14:15], 0
    v_cvt_pk_bf16_f32 v53, v54, v55
    v_mov_b32 v48, v52 quad_perm:[0,0,2,2] row_mask:0xf bank_mask:0xf
    v_mfma_f32_16x16x16_bf16 v[68:71], v[86:87], v[14:15], 0
    v_mov_b32 v50, v52 quad_perm:[1,1,3,3] row_mask:0xf bank_mask:0xf
    v_mov_b32 v49, v53 quad_perm:[0,0,2,2] row_mask:0xf bank_mask:0xf
    v_mov_b32 v51, v53 quad_perm:[1,1,3,3] row_mask:0xf bank_mask:0xf
    s_nop 1
    v_mfma_f32_16x16x32_bf16 v[60:63], v[80:83], v[48:51], v[60:63]
    v_mfma_f32_16x16x32_bf16 v[64:67], v[72:75], v[48:51], v[64:67]
    v_mfma_f32_16x16x32_bf16 v[68:71], v[76:79], v[48:51], v[68:71]
    v_rcp_f32 v60, v60
    v_mov_b64 v[72:73], 0
    v_mov_b64 v[74:75], 0
    v_mov_b64 v[76:77], 0
    v_mov_b64 v[78:79], 0
    v_mov_b64 v[48:49], 0
    v_mov_b64 v[50:51], 0
    v_mov_b64_e64 v[52:53], 0
    v_cndmask_b32 v64, v64, v68, s[82:83]
    v_cndmask_b32 v65, v65, v69, s[82:83]
    v_cndmask_b32 v66, v66, v70, s[82:83]
    v_cndmask_b32 v67, v67, v71, s[82:83]
    v_pk_mul_f32 v[64:65], v[64:65], v[60:61] op_sel_hi:[1,0]
    v_pk_mul_f32 v[66:67], v[66:67], v[60:61] op_sel_hi:[1,0]
    v_cvt_pk_bf16_f32 v68, v64, v65
    v_cvt_pk_bf16_f32 v69, v66, v67
    ds_write_b64 v6, v[68:69]
    v_mov_b64 v[54:55], 0
    s_mov_b32 s88, s73
    s_mov_b32 s73, s74
    s_mov_b32 s74, s75
    s_mov_b32 s75, s88
    s_add_u32 s79, s73, s85
    s_waitcnt lgkmcnt(0)
    s_barrier
    ds_read_b128 v[56:59], v2 offset:29184
    ds_read_b128 v[60:63], v2 offset:30208
    s_mov_b32 s99, s98
    s_waitcnt lgkmcnt(1)
    v_smfmac_f32_16x16x64_bf16 v[24:27], v[56:59], v[128:135], v1
    s_waitcnt lgkmcnt(0)
    v_smfmac_f32_16x16x64_bf16 v[24:27], v[60:63], v[192:199], v1
    v_smfmac_f32_16x16x64_bf16 v[28:31], v[56:59], v[136:143], v1
    ds_read_b128 v[96:99], v7 offset:18432
    ds_read_b128 v[100:103], v7 offset:19456
    v_smfmac_f32_16x16x64_bf16 v[28:31], v[60:63], v[200:207], v1
    ds_read_b128 v[16:19], v7 offset:32768
    ds_read_b128 v[20:23], v7 offset:33792
    v_add_f32 v24, v24, v25
    v_add_f32_e64 v26, v26, v27
    v_smfmac_f32_16x16x64_bf16 v[32:35], v[56:59], v[144:151], v1
    ds_read_b128 v[120:123], v7 offset:49152
    ds_read_b128 v[124:127], v7 offset:50176
    v_cvt_pk_bf16_f32 v24, v24, v26
    v_smfmac_f32_16x16x64_bf16 v[32:35], v[60:63], v[208:215], v1
    ds_read_b128 v[40:43], v7 offset:34816
    ds_read_b128 v[44:47], v7 offset:35840
    v_add_f32 v28, v28, v29
    v_add_f32 v30, v30, v31
    v_smfmac_f32_16x16x64_bf16 v[36:39], v[56:59], v[152:159], v1
    ds_read_b128 v[64:67], v7 offset:51200
    ds_read_b128 v[68:71], v7 offset:52224
    v_cvt_pk_bf16_f32 v25, v28, v30
    v_smfmac_f32_16x16x64_bf16 v[36:39], v[60:63], v[216:223], v1
    buffer_store_dwordx2 v[24:25], v8, s[24:27], s76 offen sc1
    v_add_f32 v32, v32, v33
    v_add_f32 v34, v34, v35
    v_smfmac_f32_16x16x64_bf16 v[72:75], v[56:59], v[104:111], v1
    v_cvt_pk_bf16_f32 v32, v32, v34
    v_smfmac_f32_16x16x64_bf16 v[72:75], v[60:63], v[112:119], v1
    v_add_f32 v36, v36, v37
    v_add_f32 v38, v38, v39
    v_smfmac_f32_16x16x64_bf16 v[76:79], v[56:59], v[88:95], v1
    s_waitcnt lgkmcnt(0)
    v_cvt_pk_bf16_f32 v33, v36, v38
    v_smfmac_f32_16x16x64_bf16 v[76:79], v[60:63], v[96:103], v1
    buffer_store_dwordx2 v[32:33], v8, s[24:27], s65 offen sc1
    v_add_f32 v72, v72, v73
    v_add_f32_e64 v74, v74, v75
    v_smfmac_f32_16x16x64_bf16 v[48:51], v[56:59], v[16:23], v1
    v_cvt_pk_bf16_f32 v72, v72, v74
    v_smfmac_f32_16x16x64_bf16 v[48:51], v[60:63], v[120:127], v1
    v_add_f32 v76, v76, v77
    v_add_f32 v78, v78, v79
    v_smfmac_f32_16x16x64_bf16 v[52:55], v[56:59], v[40:47], v1
    v_cvt_pk_bf16_f32 v73, v76, v78
    v_smfmac_f32_16x16x64_bf16 v[52:55], v[60:63], v[64:71], v1
    buffer_store_dwordx2 v[72:73], v8, s[24:27], s66 offen sc1
    v_add_f32 v48, v48, v49
    v_add_f32 v50, v50, v51
    v_cvt_pk_bf16_f32 v48, v48, v50
    s_nop 3
    v_add_f32 v52, v52, v53
    v_add_f32_e64 v54, v54, v55
    v_cvt_pk_bf16_f32 v49, v52, v54
    buffer_store_dwordx2 v[48:49], v8, s[24:27], s67 offen sc1
    v_mov_b64 v[24:25], -1
    v_mov_b64 v[26:27], -1
    v_mov_b64 v[28:29], -1
    v_mov_b64 v[30:31], -1
    v_mov_b64 v[70:71], 0
    v_mov_b64 v[68:69], 0
    v_mov_b64 v[66:67], 0
    v_mov_b64 v[64:65], 0
    v_mov_b64 v[62:63], 0
    v_mov_b64 v[60:61], 0
    v_mov_b64 v[58:59], 0
    v_mov_b64 v[56:57], 0
    v_mov_b64 v[54:55], 0
    v_mov_b64 v[52:53], 0
    v_mov_b64 v[50:51], 0
    v_mov_b64 v[48:49], 0
    buffer_load_dwordx4 v[24:27], v2, s[24:27], s99 offen offset:0 sc1
    buffer_load_dwordx4 v[28:31], v2, s[24:27], s99 offen offset:1024 sc1
    v_mov_b64 v[16:17], -1
    v_mov_b64 v[18:19], -1
    v_mov_b64 v[20:21], -1
    v_mov_b64 v[22:23], -1
    v_add_u32 v0, 0xffff0000, v7
    ds_read_b128 v[88:91], v0 offset:0
    ds_read_b128 v[92:95], v0 offset:1024
    ds_read_b128 v[96:99], v0 offset:2048
    ds_read_b128 v[100:103], v0 offset:3072
    ds_read_b128 v[104:107], v0 offset:16384
    ds_read_b128 v[108:111], v0 offset:17408
    ds_read_b128 v[112:115], v0 offset:18432
    ds_read_b128 v[116:119], v0 offset:19456
    ds_read2_b32 v[120:121], v3 offset0:64 offset1:200
    v_mov_b32 v122, v84
    v_mov_b32 v123, v86
    s_mov_b32 s88, s76
    s_mov_b32 s76, s77
    s_mov_b32 s77, s78
    s_mov_b32 s78, s88
    s_and_b32 s88, s72, 63
    s_lshl_b32 s88, s88, 17
    s_waitcnt vmcnt(6)
rec_rs_s0:
    s_add_u32 s84, s84, 1
    s_cmp_gt_u32 s84, 4194304
    v_max3_u32 v0, v24, v25, v26
    v_max3_u32 v14, v27, v28, v29
    v_max3_u32 v0, v0, v30, v31
    v_mfma_f32_16x16x32_bf16 v[124:127], v[80:83], v[24:27], 0
    v_max_u32 v0, v0, v14
    v_cmp_eq_u32 vcc, -1, v0
    v_mfma_f32_16x16x32_bf16 v[124:127], v[80:83], v[28:31], v[124:127]
    s_cbranch_vccz rec_go_s0
    s_mov_b64 exec, vcc
    buffer_load_dwordx4 v[24:27], v2, s[24:27], s99 offen offset:0 sc1
    buffer_load_dwordx4 v[28:31], v2, s[24:27], s99 offen offset:1024 sc1
    s_mov_b64 exec, -1
    v_max3_u32 v0, v24, v25, v26
    v_max3_u32 v14, v27, v28, v29
    v_max3_u32 v0, v0, v30, v31
    v_mfma_f32_16x16x32_bf16 v[124:127], v[80:83], v[24:27], 0
    v_max_u32 v0, v0, v14
    v_cmp_eq_u32_e64 vcc, -1, v0
    v_mfma_f32_16x16x32_bf16 v[124:127], v[80:83], v[28:31], v[124:127]
    s_cselect_b64 vcc, 0, vcc
    s_cbranch_vccnz rec_rs_s0
rec_go_s0:
    v_lshrrev_b32_e64 v0, 2, v2
    ds_read_b32 v14, v0 offset:31232
    ds_read_b128 v[72:75], v2 offset:8192
    ds_read_b128 v[76:79], v2 offset:9216
    s_nop 2
    v_add_f32 v126, v126, v126 row_ror:4 row_mask:0xf bank_mask:0xf
    v_add_f32 v127, v127, v127 row_ror:4 row_mask:0xf bank_mask:0xf
    s_nop 0
    v_add_f32 v126, v126, v126 row_ror:8 row_mask:0xf bank_mask:0xf
    v_add_f32 v127, v127, v127 row_ror:8 row_mask:0xf bank_mask:0xf
    v_cvt_pk_bf16_f32 v124, v126, v127
    buffer_store_dword v124, v9, s[24:27], s73 offen sc1
    s_add_u32 s96, s63, s88
    s_mov_b32 s93, s72
    s_add_u32 s72, s72, 1
    s_add_u32 s89, s72, 1
    s_min_u32 s89, s89, 63
    s_and_b32 s88, s89, 63
    s_lshl_b32 s88, s88, 18
    s_add_u32 s88, s88, s94
    s_add_u32 s90, s88, 33554432
    s_add_u32 s91, s88, 50331648
    s_add_u32 s97, s78, s95
    s_add_u32 s98, s76, s95
    s_add_u32 s65, s76, 65536
    s_add_u32 s66, s76, 131072
    s_add_u32 s67, s76, 196608
    s_waitcnt lgkmcnt(0)
    v_cmp_eq_u32 s[80:81], s70, v14
    buffer_load_dwordx4 v[16:19], v2, s[24:27], s79 offen offset:0 sc1
    buffer_load_dwordx4 v[20:23], v2, s[24:27], s79 offen offset:1024 sc1
    s_bitcmp1_b64 s[80:81], s89
    s_cbranch_scc0 rec_kvw_s0
rec_kvok_s0:
    s_branch rec_enter_s0
rec_f0_s0:
    s_mov_b64 exec, vcc
    buffer_load_dwordx4 v[24:27], v2, s[24:27], s99 offen offset:0 sc1
    buffer_load_dwordx4 v[28:31], v2, s[24:27], s99 offen offset:1024 sc1
    s_mov_b64 exec, -1
    s_add_u32 s84, s84, 1
    s_cmp_gt_u32 s84, 4194304
    s_cbranch_scc0 rec_rs_s0
    s_branch rec_go_s0
rec_redo_s1:
    buffer_load_dwordx4 v[16:19], v2, s[24:27], s79 offen offset:0 sc1
    buffer_load_dwordx4 v[20:23], v2, s[24:27], s79 offen offset:1024 sc1
    v_add_u32 v0, 0xffff0000, v7
    ds_read_b128 v[88:91], v0 offset:0
    ds_read_b128 v[92:95], v0 offset:1024
    ds_read_b128 v[96:99], v0 offset:2048
    ds_read_b128 v[100:103], v0 offset:3072
    ds_read_b128 v[104:107], v0 offset:16384
    ds_read_b128 v[108:111], v0 offset:17408
    ds_read_b128 v[112:115], v0 offset:18432
    ds_read_b128 v[116:119], v0 offset:19456
    v_mov_b64 v[70:71], 0
    v_mov_b64 v[68:69], 0
    v_mov_b64 v[66:67], 0
    v_mov_b64 v[64:65], 0
    v_mov_b64 v[62:63], 0
    v_mov_b64 v[60:61], 0
    v_mov_b64 v[58:59], 0
    v_mov_b64 v[56:57], 0
    v_mov_b64 v[54:55], 0
    v_mov_b64 v[52:53], 0
    v_mov_b64 v[50:51], 0
    v_mov_b64 v[48:49], 0
    s_waitcnt vmcnt(0)
    ds_read_b128 v[72:75], v2 offset:10240
    ds_read_b128 v[76:79], v2 offset:11264
    s_waitcnt lgkmcnt(0)
    s_bitcmp1_b64 s[80:81], s89
    s_cbranch_scc0 rec_kvw_s1
    s_branch rec_enter_s1
rec_g0_s1:
    s_mov_b64 exec, vcc
    buffer_load_dwordx4 v[16:19], v2, s[24:27], s79 offen offset:0 sc1
    buffer_load_dwordx4 v[20:23], v2, s[24:27], s79 offen offset:1024 sc1
    s_mov_b64 exec, -1
    s_add_u32 s84, s84, 1
    s_cmp_gt_u32 s84, 4194304
    s_cbranch_scc0 rec_enter_s1
    s_branch rec_ok0_s1
rec_lf_s1:
    v_mov_b32 v14, s72
    s_waitcnt vmcnt(5)
    s_mov_b64 exec, 1
    buffer_store_dword v14, off, s[24:27], s100 sc1
    s_mov_b64 exec, -1
    s_cmp_eq_u32 s72, 63
    s_cbranch_scc1 rec_fin
    s_branch rec_lfx_s1
rec_kvw_s1:
    s_add_u32 s61, s61, 1
    v_lshrrev_b32 v14, 2, v2
    buffer_load_dword v14, v14, s[24:27], s92 offen sc1
    s_waitcnt vmcnt(0)
    v_cmp_eq_u32 s[80:81], s70, v14
    s_cmp_gt_u32 s61, 4194304
    s_cbranch_scc1 rec_kvok_s1
    s_bitcmp1_b64 s[80:81], s89
    s_cbranch_scc0 rec_kvw_s1
    s_branch rec_kvok_s1
.p2align 6
rec_enter_s1:
    v_max3_u32 v0, v16, v17, v18
    v_max3_u32 v14, v19, v20, v21
    v_max3_u32 v0, v0, v22, v23
    v_max_u32 v0, v0, v14
    v_cmp_eq_u32_e64 vcc, -1, v0
    s_cbranch_vccz rec_ok0_s1
    v_max3_u32 v0, v16, v17, v18
    v_max3_u32 v14, v19, v20, v21
    v_max3_u32 v0, v0, v22, v23
    v_max_u32 v0, v0, v14
    v_cmp_eq_u32_e64 vcc, -1, v0
    s_cbranch_vccnz rec_g0_s1
rec_ok0_s1:
    v_smfmac_f32_16x16x64_bf16 v[64:67], v[16:19], v[88:95], v1
    ds_write_b128 v2, v[16:19] offset:18432
    v_smfmac_f32_16x16x64_bf16 v[68:71], v[16:19], v[96:103], v1
    ds_write_b128 v2, v[20:23] offset:19456
    v_smfmac_f32_16x16x64_bf16 v[64:67], v[20:23], v[104:111], v1
    v_smfmac_f32_16x16x64_bf16 v[68:71], v[20:23], v[112:119], v1
    v_lshrrev_b32_e64 v0, 2, v2
    v_smfmac_f32_16x16x64_bf16 v[48:51], v[16:19], a[16:23], v1
    v_smfmac_f32_16x16x64_bf16 v[52:55], v[16:19], a[80:87], v1
    v_smfmac_f32_16x16x64_bf16 v[48:51], v[20:23], a[24:31], v1
    v_smfmac_f32_16x16x64_bf16 v[52:55], v[20:23], a[88:95], v1
    v_smfmac_f32_16x16x64_bf16 v[56:59], v[16:19], a[144:151], v1
    s_waitcnt lgkmcnt(0)
    s_barrier
    ds_read_b128 v[24:27], v2 offset:16384
    v_smfmac_f32_16x16x64_bf16 v[60:63], v[16:19], a[208:215], v1
    ds_read_b128 v[28:31], v2 offset:17408
    ds_read_b128 v[32:35], v2 offset:20480
    buffer_store_dwordx4 v[120:123], v2, s[24:27], s96 offen sc1
    v_smfmac_f32_16x16x64_bf16 v[56:59], v[20:23], a[152:159], v1
    ds_read_b128 v[36:39], v2 offset:21504
    ds_read_b128 v[40:43], v2 offset:22528
    v_smfmac_f32_16x16x64_bf16 v[60:63], v[20:23], a[216:223], v1
    ds_read_b128 v[44:47], v2 offset:23552
    s_waitcnt lgkmcnt(5)
    s_mov_b32 m0, 10240
    v_smfmac_f32_16x16x64_bf16 v[48:51], v[24:27], a[0:7], v1
    buffer_load_dwordx4 v2, s[24:27], s91 offen sc1 lds
    v_smfmac_f32_16x16x64_bf16 v[52:55], v[24:27], a[64:71], v1
    s_waitcnt lgkmcnt(4)
    buffer_load_dwordx4 v2, s[24:27], s91 offen offset:1024 sc1 lds
    v_smfmac_f32_16x16x64_bf16 v[48:51], v[28:31], a[8:15], v1
    s_mov_b32 m0, 31232
    v_smfmac_f32_16x16x64_bf16 v[52:55], v[28:31], a[72:79], v1
    s_waitcnt lgkmcnt(0)
    buffer_load_dword v0, s[24:27], s92 offen sc1 lds
    v_smfmac_f32_16x16x64_bf16 v[48:51], v[32:35], a[32:39], v1
    ds_read_b128 v[88:91], v2 offset:0
    v_add_u32 v0, 0xffff0000, v7
    v_smfmac_f32_16x16x64_bf16 v[52:55], v[32:35], a[96:103], v1
    ds_read_b128 v[92:95], v2 offset:1024
    v_smfmac_f32_16x16x64_bf16 v[48:51], v[36:39], a[40:47], v1
    ds_read_b128 v[96:99], v2 offset:2048
    s_add_u32 s60, s97, 131072
    v_smfmac_f32_16x16x64_bf16 v[52:55], v[36:39], a[104:111], v1
    ds_read_b128 v[100:103], v2 offset:3072
    s_waitcnt vmcnt(4)
    v_smfmac_f32_16x16x64_bf16 v[48:51], v[40:43], a[48:55], v1
    ds_read_b128 v[120:123], v0 offset:32768
    v_smfmac_f32_16x16x64_bf16 v[52:55], v[40:43], a[112:119], v1
    ds_read_b128 v[124:127], v0 offset:33792
    buffer_store_dwordx4 v[10:13], v2, s[24:27], s97 offen offset:0 sc1
    v_smfmac_f32_16x16x64_bf16 v[48:51], v[44:47], a[56:63], v1
    ds_read_b128 v[16:19], v0 offset:34816
    v_smfmac_f32_16x16x64_bf16 v[52:55], v[44:47], a[120:127], v1
    ds_read_b128 v[20:23], v0 offset:35840
    buffer_store_dwordx4 v[10:13], v2, s[24:27], s97 offen offset:1024 sc1
    v_smfmac_f32_16x16x64_bf16 v[56:59], v[24:27], a[128:135], v1
    ds_read_b128 v[104:107], v0 offset:49152
    v_add_f32_e64 v48, v48, v49
    v_smfmac_f32_16x16x64_bf16 v[60:63], v[24:27], a[192:199], v1
    ds_read_b128 v[108:111], v0 offset:50176
    v_add_f32_e64 v50, v50, v51
    v_smfmac_f32_16x16x64_bf16 v[56:59], v[28:31], a[136:143], v1
    ds_read_b128 v[112:115], v0 offset:51200
    v_add_f32_e64 v52, v52, v53
    v_smfmac_f32_16x16x64_bf16 v[60:63], v[28:31], a[200:207], v1
    ds_read_b128 v[116:119], v0 offset:52224
    v_add_f32_e64 v54, v54, v55
    v_smfmac_f32_16x16x64_bf16 v[56:59], v[32:35], a[160:167], v1
    buffer_store_dword v10, v9, s[24:27], s75 offen sc1
    v_cvt_pk_bf16_f32 v48, v48, v52
    v_smfmac_f32_16x16x64_bf16 v[60:63], v[32:35], a[224:231], v1
    v_cvt_pk_bf16_f32 v49, v50, v54
    v_smfmac_f32_16x16x64_bf16 v[56:59], v[36:39], a[168:175], v1
    ds_write2_b32 v3, v48, v49 offset0:0 offset1:136
    v_smfmac_f32_16x16x64_bf16 v[60:63], v[36:39], a[232:239], v1
    v_smfmac_f32_16x16x64_bf16 v[56:59], v[40:43], a[176:183], v1
    buffer_store_dwordx4 v[10:13], v2, s[24:27], s60 offen offset:0 sc1
    v_smfmac_f32_16x16x64_bf16 v[60:63], v[40:43], a[240:247], v1
    v_smfmac_f32_16x16x64_bf16 v[56:59], v[44:47], a[184:191], v1
    buffer_store_dwordx4 v[10:13], v2, s[24:27], s60 offen offset:1024 sc1
    v_smfmac_f32_16x16x64_bf16 v[60:63], v[44:47], a[248:255], v1
    s_waitcnt lgkmcnt(1)
    v_smfmac_f32_16x16x64_bf16 v[64:67], v[24:27], v[120:127], v1
    v_add_f32 v56, v56, v57
    v_smfmac_f32_16x16x64_bf16 v[68:71], v[24:27], v[16:23], v1
    s_waitcnt lgkmcnt(0)
    s_barrier
    v_add_f32_e64 v58, v58, v59
    v_smfmac_f32_16x16x64_bf16 v[64:67], v[28:31], v[104:111], v1
    ds_read_b128 v[16:19], v4 offset:0
    ds_read_b128 v[20:23], v4 offset:64
    v_add_f32_e64 v60, v60, v61
    v_smfmac_f32_16x16x64_bf16 v[68:71], v[28:31], v[112:119], v1
    ds_read_b128 v[120:123], v4 offset:128
    ds_read_b128 v[124:127], v4 offset:192
    v_add_f32_e64 v62, v62, v63
    v_smfmac_f32_16x16x64_bf16 v[64:67], v[32:35], v[160:167], v1
    ds_read_b128 v[104:107], v2 offset:4096
    ds_read_b128 v[108:111], v2 offset:5120
    v_cvt_pk_bf16_f32 v56, v56, v60
    v_smfmac_f32_16x16x64_bf16 v[64:67], v[36:39], v[168:175], v1
    ds_read_b128 v[112:115], v2 offset:6144
    ds_read_b128 v[116:119], v2 offset:7168
    v_cvt_pk_bf16_f32 v57, v58, v62
    v_smfmac_f32_16x16x64_bf16 v[64:67], v[40:43], v[176:183], v1
    ds_write2_b32 v3, v56, v57 offset0:64 offset1:200
    v_smfmac_f32_16x16x64_bf16 v[64:67], v[44:47], v[184:191], v1
    v_smfmac_f32_16x16x64_bf16 v[68:71], v[32:35], v[224:231], v1
    v_mov_b64_e64 v[24:25], 0
    v_smfmac_f32_16x16x64_bf16 v[68:71], v[36:39], v[232:239], v1
    s_waitcnt lgkmcnt(5)
    v_mov_b64 v[26:27], 0
    v_mfma_f32_16x16x32_bf16 v[48:51], v[88:91], v[16:19], 0
    v_mov_b64 v[28:29], 0
    v_mov_b64 v[30:31], 0
    v_mfma_f32_16x16x32_bf16 v[48:51], v[92:95], v[20:23], v[48:51]
    s_mov_b32 m0, 2048
    v_mov_b64 v[32:33], 0
    v_mov_b64 v[34:35], 0
    v_mfma_f32_16x16x32_bf16 v[48:51], v[96:99], v[120:123], v[48:51]
    s_waitcnt lgkmcnt(0)
    s_barrier
    ds_read_b128 v[88:91], v5 offset:0
    v_mfma_f32_16x16x32_bf16 v[48:51], v[100:103], v[124:127], v[48:51]
    ds_read_b128 v[92:95], v5 offset:64
    ds_read_b128 v[96:99], v5 offset:128
    ds_read_b128 v[100:103], v5 offset:192
    v_mfma_f32_16x16x32_bf16 v[52:55], v[104:107], v[16:19], 0
    buffer_load_dwordx4 v2, s[24:27], s90 offen sc1 lds
    v_add_f32 v64, v64, v65
    v_add_f32 v66, v66, v67
    v_mfma_f32_16x16x32_bf16 v[52:55], v[108:111], v[20:23], v[52:55]
    buffer_load_dwordx4 v2, s[24:27], s90 offen offset:1024 sc1 lds
    v_mfma_f32_16x16x32_bf16 v[52:55], v[112:115], v[120:123], v[52:55]
    v_cvt_pk_bf16_f32 v84, v64, v66
    v_max3_f32 v0, v48, v49, v50
    v_mfma_f32_16x16x32_bf16 v[52:55], v[116:119], v[124:127], v[52:55]
    v_mov_b64 v[36:37], 0
    v_mov_b64 v[38:39], 0
    v_smfmac_f32_16x16x64_bf16 v[68:71], v[40:43], v[240:247], v1
    ds_read_b128 v[104:107], v7 offset:0
    ds_read_b128 v[108:111], v7 offset:1024
    v_smfmac_f32_16x16x64_bf16 v[68:71], v[44:47], v[248:255], v1
    s_waitcnt lgkmcnt(2)
    ds_read_b128 v[112:115], v7 offset:16384
    ds_read_b128 v[116:119], v7 offset:17408
    v_max3_f32 v58, v51, v52, v53
    v_mfma_f32_16x16x32_bf16 v[60:63], v[88:91], v[16:19], 0
    s_cmp_ge_u32 s72, 59
    v_max3_f32 v0, v0, v54, v55
    v_max_f32_e64 v0, v0, v58
    v_mfma_f32_16x16x32_bf16 v[60:63], v[92:95], v[20:23], v[60:63]
    s_cbranch_scc1 rec_lf_s1
rec_lfx_s1:
    v_mov_b32 v58, v0
    v_mfma_f32_16x16x32_bf16 v[60:63], v[96:99], v[120:123], v[60:63]
    ds_read_b128 v[88:91], v7 offset:2048
    ds_read_b128 v[92:95], v7 offset:3072
    v_add_f32 v68, v68, v69
    v_add_f32 v70, v70, v71
    v_mfma_f32_16x16x32_bf16 v[60:63], v[100:103], v[124:127], v[60:63]
    v_permlane16_swap_b32 v58, v0
    v_cvt_pk_bf16_f32 v86, v68, v70
    v_max_f32 v0, v0, v58
    v_cndmask_b32 v52, v48, v52, s[82:83]
    v_cndmask_b32 v53, v49, v53, s[82:83]
    v_cndmask_b32 v54, v50, v54, s[82:83]
    v_cndmask_b32 v55, v51, v55, s[82:83]
    v_pk_mul_f32 v[52:53], v[52:53], s[86:87]
    v_max3_f32 v0, v0, v60, v61
    v_max3_f32 v0, v0, v62, v63
    v_mov_b32_e64 v58, v0
    v_pk_mul_f32 v[60:61], v[60:61], s[86:87]
    v_pk_mul_f32 v[54:55], v[54:55], s[86:87]
    v_permlane32_swap_b32 v58, v0
    v_max_f32 v0, v58, v0
    v_mul_f32_e64 v58, s86, v0
    v_pk_add_f32 v[60:61], v[60:61], v[58:59] op_sel_hi:[1,0] neg_lo:[0,1] neg_hi:[0,1]
    v_pk_add_f32 v[52:53], v[52:53], v[58:59] op_sel_hi:[1,0] neg_lo:[0,1] neg_hi:[0,1]
    v_pk_add_f32 v[54:55], v[54:55], v[58:59] op_sel_hi:[1,0] neg_lo:[0,1] neg_hi:[0,1]
    v_exp_f32 v60, v60
    v_exp_f32 v61, v61
    v_exp_f32_e64 v52, v52
    v_cvt_pk_bf16_f32 v14, v60, v61
    v_exp_f32 v53, v53
    v_exp_f32 v54, v54
    v_mfma_f32_16x16x16_bf16 v[60:63], v[80:81], v[14:15], 0
    v_exp_f32_e64 v55, v55
    v_cvt_pk_bf16_f32 v52, v52, v53
    v_mfma_f32_16x16x16_bf16 v[64:67], v[84:85], v[14:15], 0
    v_cvt_pk_bf16_f32 v53, v54, v55
    v_mov_b32 v48, v52 quad_perm:[0,0,2,2] row_mask:0xf bank_mask:0xf
    v_mfma_f32_16x16x16_bf16 v[68:71], v[86:87], v[14:15], 0
    v_mov_b32 v50, v52 quad_perm:[1,1,3,3] row_mask:0xf bank_mask:0xf
    v_mov_b32 v49, v53 quad_perm:[0,0,2,2] row_mask:0xf bank_mask:0xf
    v_mov_b32 v51, v53 quad_perm:[1,1,3,3] row_mask:0xf bank_mask:0xf
    s_nop 1
    v_mfma_f32_16x16x32_bf16 v[60:63], v[80:83], v[48:51], v[60:63]
    v_mfma_f32_16x16x32_bf16 v[64:67], v[72:75], v[48:51], v[64:67]
    v_mfma_f32_16x16x32_bf16 v[68:71], v[76:79], v[48:51], v[68:71]
    v_rcp_f32 v60, v60
    v_mov_b64 v[72:73], 0
    v_mov_b64 v[74:75], 0
    v_mov_b64 v[76:77], 0
    v_mov_b64 v[78:79], 0
    v_mov_b64 v[48:49], 0
    v_mov_b64 v[50:51], 0
    v_mov_b64_e64 v[52:53], 0
    v_cndmask_b32 v64, v64, v68, s[82:83]
    v_cndmask_b32 v65, v65, v69, s[82:83]
    v_cndmask_b32 v66, v66, v70, s[82:83]
    v_cndmask_b32 v67, v67, v71, s[82:83]
    v_pk_mul_f32 v[64:65], v[64:65], v[60:61] op_sel_hi:[1,0]
    v_pk_mul_f32 v[66:67], v[66:67], v[60:61] op_sel_hi:[1,0]
    v_cvt_pk_bf16_f32 v68, v64, v65
    v_cvt_pk_bf16_f32 v69, v66, v67
    ds_write_b64 v6, v[68:69]
    v_mov_b64 v[54:55], 0
    s_mov_b32 s88, s73
    s_mov_b32 s73, s74
    s_mov_b32 s74, s75
    s_mov_b32 s75, s88
    s_add_u32 s79, s73, s85
    s_waitcnt lgkmcnt(0)
    s_barrier
    ds_read_b128 v[56:59], v2 offset:29184
    ds_read_b128 v[60:63], v2 offset:30208
    s_mov_b32 s99, s98
    s_waitcnt lgkmcnt(1)
    v_smfmac_f32_16x16x64_bf16 v[24:27], v[56:59], v[128:135], v1
    s_waitcnt lgkmcnt(0)
    v_smfmac_f32_16x16x64_bf16 v[24:27], v[60:63], v[192:199], v1
    v_smfmac_f32_16x16x64_bf16 v[28:31], v[56:59], v[136:143], v1
    ds_read_b128 v[96:99], v7 offset:18432
    ds_read_b128 v[100:103], v7 offset:19456
    v_smfmac_f32_16x16x64_bf16 v[28:31], v[60:63], v[200:207], v1
    ds_read_b128 v[16:19], v7 offset:32768
    ds_read_b128 v[20:23], v7 offset:33792
    v_add_f32 v24, v24, v25
    v_add_f32_e64 v26, v26, v27
    v_smfmac_f32_16x16x64_bf16 v[32:35], v[56:59], v[144:151], v1
    ds_read_b128 v[120:123], v7 offset:49152
    ds_read_b128 v[124:127], v7 offset:50176
    v_cvt_pk_bf16_f32 v24, v24, v26
    v_smfmac_f32_16x16x64_bf16 v[32:35], v[60:63], v[208:215], v1
    ds_read_b128 v[40:43], v7 offset:34816
    ds_read_b128 v[44:47], v7 offset:35840
    v_add_f32 v28, v28, v29
    v_add_f32 v30, v30, v31
    v_smfmac_f32_16x16x64_bf16 v[36:39], v[56:59], v[152:159], v1
    ds_read_b128 v[64:67], v7 offset:51200
    ds_read_b128 v[68:71], v7 offset:52224
    v_cvt_pk_bf16_f32 v25, v28, v30
    v_smfmac_f32_16x16x64_bf16 v[36:39], v[60:63], v[216:223], v1
    buffer_store_dwordx2 v[24:25], v8, s[24:27], s76 offen sc1
    v_add_f32 v32, v32, v33
    v_add_f32 v34, v34, v35
    v_smfmac_f32_16x16x64_bf16 v[72:75], v[56:59], v[104:111], v1
    v_cvt_pk_bf16_f32 v32, v32, v34
    v_smfmac_f32_16x16x64_bf16 v[72:75], v[60:63], v[112:119], v1
    v_add_f32 v36, v36, v37
    v_add_f32 v38, v38, v39
    v_smfmac_f32_16x16x64_bf16 v[76:79], v[56:59], v[88:95], v1
    s_waitcnt lgkmcnt(0)
    v_cvt_pk_bf16_f32 v33, v36, v38
    v_smfmac_f32_16x16x64_bf16 v[76:79], v[60:63], v[96:103], v1
    buffer_store_dwordx2 v[32:33], v8, s[24:27], s65 offen sc1
    v_add_f32 v72, v72, v73
    v_add_f32_e64 v74, v74, v75
    v_smfmac_f32_16x16x64_bf16 v[48:51], v[56:59], v[16:23], v1
    v_cvt_pk_bf16_f32 v72, v72, v74
    v_smfmac_f32_16x16x64_bf16 v[48:51], v[60:63], v[120:127], v1
    v_add_f32 v76, v76, v77
    v_add_f32 v78, v78, v79
    v_smfmac_f32_16x16x64_bf16 v[52:55], v[56:59], v[40:47], v1
    v_cvt_pk_bf16_f32 v73, v76, v78
    v_smfmac_f32_16x16x64_bf16 v[52:55], v[60:63], v[64:71], v1
    buffer_store_dwordx2 v[72:73], v8, s[24:27], s66 offen sc1
    v_add_f32 v48, v48, v49
    v_add_f32 v50, v50, v51
    v_cvt_pk_bf16_f32 v48, v48, v50
    s_nop 3
    v_add_f32 v52, v52, v53
    v_add_f32_e64 v54, v54, v55
    v_cvt_pk_bf16_f32 v49, v52, v54
    buffer_store_dwordx2 v[48:49], v8, s[24:27], s67 offen sc1
    v_mov_b64 v[24:25], -1
    v_mov_b64 v[26:27], -1
    v_mov_b64 v[28:29], -1
    v_mov_b64 v[30:31], -1
    v_mov_b64 v[70:71], 0
    v_mov_b64 v[68:69], 0
    v_mov_b64 v[66:67], 0
    v_mov_b64 v[64:65], 0
    v_mov_b64 v[62:63], 0
    v_mov_b64 v[60:61], 0
    v_mov_b64 v[58:59], 0
    v_mov_b64 v[56:57], 0
    v_mov_b64 v[54:55], 0
    v_mov_b64 v[52:53], 0
    v_mov_b64 v[50:51], 0
    v_mov_b64 v[48:49], 0
    v_mov_b64 v[16:17], -1
    v_mov_b64 v[18:19], -1
    v_mov_b64 v[20:21], -1
    v_mov_b64 v[22:23], -1
    buffer_load_dwordx4 v[24:27], v2, s[24:27], s99 offen offset:0 sc1
    buffer_load_dwordx4 v[28:31], v2, s[24:27], s99 offen offset:1024 sc1
    v_add_u32 v0, 0xffff0000, v7
    ds_read_b128 v[88:91], v0 offset:0
    ds_read_b128 v[92:95], v0 offset:1024
    ds_read_b128 v[96:99], v0 offset:2048
    ds_read_b128 v[100:103], v0 offset:3072
    ds_read_b128 v[104:107], v0 offset:16384
    ds_read_b128 v[108:111], v0 offset:17408
    ds_read_b128 v[112:115], v0 offset:18432
    ds_read_b128 v[116:119], v0 offset:19456
    ds_read2_b32 v[120:121], v3 offset0:64 offset1:200
    v_mov_b32 v122, v84
    v_mov_b32 v123, v86
    s_mov_b32 s88, s76
    s_mov_b32 s76, s77
    s_mov_b32 s77, s78
    s_mov_b32 s78, s88
    s_and_b32 s88, s72, 63
    s_lshl_b32 s88, s88, 17
    s_waitcnt vmcnt(6)
rec_rs_s1:
    s_add_u32 s84, s84, 1
    s_cmp_gt_u32 s84, 4194304
    v_max3_u32 v0, v24, v25, v26
    v_max3_u32 v14, v27, v28, v29
    v_max3_u32 v0, v0, v30, v31
    v_mfma_f32_16x16x32_bf16 v[124:127], v[80:83], v[24:27], 0
    v_max_u32 v0, v0, v14
    v_cmp_eq_u32 vcc, -1, v0
    v_mfma_f32_16x16x32_bf16 v[124:127], v[80:83], v[28:31], v[124:127]
    s_cbranch_vccz rec_go_s1
    s_mov_b64 exec, vcc
    buffer_load_dwordx4 v[24:27], v2, s[24:27], s99 offen offset:0 sc1
    buffer_load_dwordx4 v[28:31], v2, s[24:27], s99 offen offset:1024 sc1
    s_mov_b64 exec, -1
    v_max3_u32 v0, v24, v25, v26
    v_max3_u32 v14, v27, v28, v29
    v_max3_u32 v0, v0, v30, v31
    v_mfma_f32_16x16x32_bf16 v[124:127], v[80:83], v[24:27], 0
    v_max_u32 v0, v0, v14
    v_cmp_eq_u32_e64 vcc, -1, v0
    v_mfma_f32_16x16x32_bf16 v[124:127], v[80:83], v[28:31], v[124:127]
    s_cselect_b64 vcc, 0, vcc
    s_cbranch_vccnz rec_rs_s1
rec_go_s1:
    v_lshrrev_b32_e64 v0, 2, v2
    ds_read_b32 v14, v0 offset:31232
    ds_read_b128 v[72:75], v2 offset:10240
    ds_read_b128 v[76:79], v2 offset:11264
    s_nop 2
    v_add_f32 v126, v126, v126 row_ror:4 row_mask:0xf bank_mask:0xf
    v_add_f32 v127, v127, v127 row_ror:4 row_mask:0xf bank_mask:0xf
    s_nop 0
    v_add_f32 v126, v126, v126 row_ror:8 row_mask:0xf bank_mask:0xf
    v_add_f32 v127, v127, v127 row_ror:8 row_mask:0xf bank_mask:0xf
    v_cvt_pk_bf16_f32 v124, v126, v127
    buffer_store_dword v124, v9, s[24:27], s73 offen sc1
    s_add_u32 s96, s63, s88
    s_mov_b32 s93, s72
    s_add_u32 s72, s72, 1
    s_add_u32 s89, s72, 1
    s_min_u32 s89, s89, 63
    s_and_b32 s88, s89, 63
    s_lshl_b32 s88, s88, 18
    s_add_u32 s88, s88, s94
    s_add_u32 s90, s88, 33554432
    s_add_u32 s91, s88, 50331648
    s_add_u32 s97, s78, s95
    s_add_u32 s98, s76, s95
    s_add_u32 s65, s76, 65536
    s_add_u32 s66, s76, 131072
    s_add_u32 s67, s76, 196608
    s_waitcnt lgkmcnt(0)
    v_cmp_eq_u32 s[80:81], s70, v14
    buffer_load_dwordx4 v[16:19], v2, s[24:27], s79 offen offset:0 sc1
    buffer_load_dwordx4 v[20:23], v2, s[24:27], s79 offen offset:1024 sc1
    s_bitcmp1_b64 s[80:81], s89
    s_cbranch_scc0 rec_kvw_s1
rec_kvok_s1:
    s_branch rec_enter_s1
rec_f0_s1:
    s_mov_b64 exec, vcc
    buffer_load_dwordx4 v[24:27], v2, s[24:27], s99 offen offset:0 sc1
    buffer_load_dwordx4 v[28:31], v2, s[24:27], s99 offen offset:1024 sc1
    s_mov_b64 exec, -1
    s_add_u32 s84, s84, 1
    s_cmp_gt_u32 s84, 4194304
    s_cbranch_scc0 rec_rs_s1
    s_branch rec_go_s1
rec_redo_s2:
    buffer_load_dwordx4 v[16:19], v2, s[24:27], s79 offen offset:0 sc1
    buffer_load_dwordx4 v[20:23], v2, s[24:27], s79 offen offset:1024 sc1
    v_add_u32 v0, 0xffff0000, v7
    ds_read_b128 v[88:91], v0 offset:0
    ds_read_b128 v[92:95], v0 offset:1024
    ds_read_b128 v[96:99], v0 offset:2048
    ds_read_b128 v[100:103], v0 offset:3072
    ds_read_b128 v[104:107], v0 offset:16384
    ds_read_b128 v[108:111], v0 offset:17408
    ds_read_b128 v[112:115], v0 offset:18432
    ds_read_b128 v[116:119], v0 offset:19456
    v_mov_b64 v[70:71], 0
    v_mov_b64 v[68:69], 0
    v_mov_b64 v[66:67], 0
    v_mov_b64 v[64:65], 0
    v_mov_b64 v[62:63], 0
    v_mov_b64 v[60:61], 0
    v_mov_b64 v[58:59], 0
    v_mov_b64 v[56:57], 0
    v_mov_b64 v[54:55], 0
    v_mov_b64 v[52:53], 0
    v_mov_b64 v[50:51], 0
    v_mov_b64 v[48:49], 0
    s_waitcnt vmcnt(0)
    ds_read_b128 v[72:75], v2 offset:12288
    ds_read_b128 v[76:79], v2 offset:13312
    s_waitcnt lgkmcnt(0)
    s_bitcmp1_b64 s[80:81], s89
    s_cbranch_scc0 rec_kvw_s2
    s_branch rec_enter_s2
rec_g0_s2:
    s_mov_b64 exec, vcc
    buffer_load_dwordx4 v[16:19], v2, s[24:27], s79 offen offset:0 sc1
    buffer_load_dwordx4 v[20:23], v2, s[24:27], s79 offen offset:1024 sc1
    s_mov_b64 exec, -1
    s_add_u32 s84, s84, 1
    s_cmp_gt_u32 s84, 4194304
    s_cbranch_scc0 rec_enter_s2
    s_branch rec_ok0_s2
rec_lf_s2:
    v_mov_b32 v14, s72
    s_waitcnt vmcnt(5)
    s_mov_b64 exec, 1
    buffer_store_dword v14, off, s[24:27], s100 sc1
    s_mov_b64 exec, -1
    s_cmp_eq_u32 s72, 63
    s_cbranch_scc1 rec_fin
    s_branch rec_lfx_s2
rec_kvw_s2:
    s_add_u32 s61, s61, 1
    v_lshrrev_b32 v14, 2, v2
    buffer_load_dword v14, v14, s[24:27], s92 offen sc1
    s_waitcnt vmcnt(0)
    v_cmp_eq_u32 s[80:81], s70, v14
    s_cmp_gt_u32 s61, 4194304
    s_cbranch_scc1 rec_kvok_s2
    s_bitcmp1_b64 s[80:81], s89
    s_cbranch_scc0 rec_kvw_s2
    s_branch rec_kvok_s2
.p2align 6
rec_enter_s2:
    v_max3_u32 v0, v16, v17, v18
    v_max3_u32 v14, v19, v20, v21
    v_max3_u32 v0, v0, v22, v23
    v_max_u32 v0, v0, v14
    v_cmp_eq_u32_e64 vcc, -1, v0
    s_cbranch_vccz rec_ok0_s2
    v_max3_u32 v0, v16, v17, v18
    v_max3_u32 v14, v19, v20, v21
    v_max3_u32 v0, v0, v22, v23
    v_max_u32 v0, v0, v14
    v_cmp_eq_u32_e64 vcc, -1, v0
    s_cbranch_vccnz rec_g0_s2
rec_ok0_s2:
    v_smfmac_f32_16x16x64_bf16 v[64:67], v[16:19], v[88:95], v1
    ds_write_b128 v2, v[16:19] offset:20480
    v_smfmac_f32_16x16x64_bf16 v[68:71], v[16:19], v[96:103], v1
    ds_write_b128 v2, v[20:23] offset:21504
    v_smfmac_f32_16x16x64_bf16 v[64:67], v[20:23], v[104:111], v1
    v_smfmac_f32_16x16x64_bf16 v[68:71], v[20:23], v[112:119], v1
    v_smfmac_f32_16x16x64_bf16 v[48:51], v[16:19], a[32:39], v1
    v_smfmac_f32_16x16x64_bf16 v[52:55], v[16:19], a[96:103], v1
    v_smfmac_f32_16x16x64_bf16 v[48:51], v[20:23], a[40:47], v1
    s_waitcnt lgkmcnt(0)
    s_barrier
    ds_read_b128 v[24:27], v2 offset:16384
    v_smfmac_f32_16x16x64_bf16 v[52:55], v[20:23], a[104:111], v1
    ds_read_b128 v[28:31], v2 offset:17408
    ds_read_b128 v[32:35], v2 offset:18432
    v_smfmac_f32_16x16x64_bf16 v[56:59], v[16:19], a[160:167], v1
    ds_read_b128 v[36:39], v2 offset:19456
    ds_read_b128 v[40:43], v2 offset:22528
    v_smfmac_f32_16x16x64_bf16 v[60:63], v[16:19], a[224:231], v1
    ds_read_b128 v[44:47], v2 offset:23552
    buffer_store_dwordx4 v[120:123], v2, s[24:27], s96 offen sc1
    v_smfmac_f32_16x16x64_bf16 v[56:59], v[20:23], a[168:175], v1
    v_smfmac_f32_16x16x64_bf16 v[60:63], v[20:23], a[232:239], v1
    s_waitcnt lgkmcnt(5)
    s_mov_b32 m0, 12288
    v_smfmac_f32_16x16x64_bf16 v[48:51], v[24:27], a[0:7], v1
    buffer_load_dwordx4 v2, s[24:27], s91 offen sc1 lds
    v_smfmac_f32_16x16x64_bf16 v[52:55], v[24:27], a[64:71], v1
    s_waitcnt lgkmcnt(4)
    buffer_load_dwordx4 v2, s[24:27], s91 offen offset:1024 sc1 lds
    v_smfmac_f32_16x16x64_bf16 v[48:51], v[28:31], a[8:15], v1
    v_smfmac_f32_16x16x64_bf16 v[52:55], v[28:31], a[72:79], v1
    s_waitcnt lgkmcnt(0)
    v_smfmac_f32_16x16x64_bf16 v[48:51], v[32:35], a[16:23], v1
    ds_read_b128 v[88:91], v2 offset:0
    v_add_u32 v0, 0xffff0000, v7
    v_smfmac_f32_16x16x64_bf16 v[52:55], v[32:35], a[80:87], v1
    ds_read_b128 v[92:95], v2 offset:1024
    v_smfmac_f32_16x16x64_bf16 v[48:51], v[36:39], a[24:31], v1
    ds_read_b128 v[96:99], v2 offset:2048
    v_smfmac_f32_16x16x64_bf16 v[52:55], v[36:39], a[88:95], v1
    ds_read_b128 v[100:103], v2 offset:3072
    s_waitcnt vmcnt(3)
    v_smfmac_f32_16x16x64_bf16 v[48:51], v[40:43], a[48:55], v1
    ds_read_b128 v[120:123], v0 offset:32768
    v_smfmac_f32_16x16x64_bf16 v[52:55], v[40:43], a[112:119], v1
    ds_read_b128 v[124:127], v0 offset:33792
    v_smfmac_f32_16x16x64_bf16 v[48:51], v[44:47], a[56:63], v1
    ds_read_b128 v[16:19], v0 offset:34816
    v_smfmac_f32_16x16x64_bf16 v[52:55], v[44:47], a[120:127], v1
    ds_read_b128 v[20:23], v0 offset:35840
    v_smfmac_f32_16x16x64_bf16 v[56:59], v[24:27], a[128:135], v1
    ds_read_b128 v[104:107], v0 offset:49152
    v_add_f32_e64 v48, v48, v49
    v_smfmac_f32_16x16x64_bf16 v[60:63], v[24:27], a[192:199], v1
    ds_read_b128 v[108:111], v0 offset:50176
    v_add_f32_e64 v50, v50, v51
    v_smfmac_f32_16x16x64_bf16 v[56:59], v[28:31], a[136:143], v1
    ds_read_b128 v[112:115], v0 offset:51200
    v_add_f32_e64 v52, v52, v53
    v_smfmac_f32_16x16x64_bf16 v[60:63], v[28:31], a[200:207], v1
    ds_read_b128 v[116:119], v0 offset:52224
    v_add_f32_e64 v54, v54, v55
    v_smfmac_f32_16x16x64_bf16 v[56:59], v[32:35], a[144:151], v1
    buffer_store_dword v10, v9, s[24:27], s75 offen sc1
    v_cvt_pk_bf16_f32 v48, v48, v52
    v_smfmac_f32_16x16x64_bf16 v[60:63], v[32:35], a[208:215], v1
    v_cvt_pk_bf16_f32 v49, v50, v54
    v_smfmac_f32_16x16x64_bf16 v[56:59], v[36:39], a[152:159], v1
    ds_write2_b32 v3, v48, v49 offset0:0 offset1:136
    v_smfmac_f32_16x16x64_bf16 v[60:63], v[36:39], a[216:223], v1
    v_smfmac_f32_16x16x64_bf16 v[56:59], v[40:43], a[176:183], v1
    v_smfmac_f32_16x16x64_bf16 v[60:63], v[40:43], a[240:247], v1
    v_smfmac_f32_16x16x64_bf16 v[56:59], v[44:47], a[184:191], v1
    v_smfmac_f32_16x16x64_bf16 v[60:63], v[44:47], a[248:255], v1
    s_waitcnt lgkmcnt(1)
    v_smfmac_f32_16x16x64_bf16 v[64:67], v[24:27], v[120:127], v1
    v_add_f32 v56, v56, v57
    v_smfmac_f32_16x16x64_bf16 v[68:71], v[24:27], v[16:23], v1
    s_waitcnt lgkmcnt(0)
    s_barrier
    v_add_f32_e64 v58, v58, v59
    v_smfmac_f32_16x16x64_bf16 v[64:67], v[28:31], v[104:111], v1
    ds_read_b128 v[16:19], v4 offset:0
    ds_read_b128 v[20:23], v4 offset:64
    v_add_f32_e64 v60, v60, v61
    v_smfmac_f32_16x16x64_bf16 v[68:71], v[28:31], v[112:119], v1
    ds_read_b128 v[120:123], v4 offset:128
    ds_read_b128 v[124:127], v4 offset:192
    v_add_f32_e64 v62, v62, v63
    v_smfmac_f32_16x16x64_bf16 v[64:67], v[32:35], v[160:167], v1
    ds_read_b128 v[104:107], v2 offset:4096
    ds_read_b128 v[108:111], v2 offset:5120
    v_cvt_pk_bf16_f32 v56, v56, v60
    v_smfmac_f32_16x16x64_bf16 v[64:67], v[36:39], v[168:175], v1
    ds_read_b128 v[112:115], v2 offset:6144
    ds_read_b128 v[116:119], v2 offset:7168
    v_cvt_pk_bf16_f32 v57, v58, v62
    v_smfmac_f32_16x16x64_bf16 v[64:67], v[40:43], v[176:183], v1
    ds_write2_b32 v3, v56, v57 offset0:64 offset1:200
    v_smfmac_f32_16x16x64_bf16 v[64:67], v[44:47], v[184:191], v1
    v_smfmac_f32_16x16x64_bf16 v[68:71], v[32:35], v[224:231], v1
    v_mov_b64_e64 v[24:25], 0
    v_smfmac_f32_16x16x64_bf16 v[68:71], v[36:39], v[232:239], v1
    s_waitcnt lgkmcnt(5)
    v_mov_b64 v[26:27], 0
    v_mfma_f32_16x16x32_bf16 v[48:51], v[88:91], v[16:19], 0
    v_mov_b64 v[28:29], 0
    v_mov_b64 v[30:31], 0
    v_mfma_f32_16x16x32_bf16 v[48:51], v[92:95], v[20:23], v[48:51]
    s_mov_b32 m0, 4096
    v_mov_b64 v[32:33], 0
    v_mov_b64 v[34:35], 0
    v_mfma_f32_16x16x32_bf16 v[48:51], v[96:99], v[120:123], v[48:51]
    s_waitcnt lgkmcnt(0)
    s_barrier
    ds_read_b128 v[88:91], v5 offset:0
    v_mfma_f32_16x16x32_bf16 v[48:51], v[100:103], v[124:127], v[48:51]
    ds_read_b128 v[92:95], v5 offset:64
    ds_read_b128 v[96:99], v5 offset:128
    ds_read_b128 v[100:103], v5 offset:192
    v_mfma_f32_16x16x32_bf16 v[52:55], v[104:107], v[16:19], 0
    buffer_load_dwordx4 v2, s[24:27], s90 offen sc1 lds
    v_add_f32 v64, v64, v65
    v_add_f32 v66, v66, v67
    v_mfma_f32_16x16x32_bf16 v[52:55], v[108:111], v[20:23], v[52:55]
    buffer_load_dwordx4 v2, s[24:27], s90 offen offset:1024 sc1 lds
    v_mfma_f32_16x16x32_bf16 v[52:55], v[112:115], v[120:123], v[52:55]
    v_cvt_pk_bf16_f32 v84, v64, v66
    v_max3_f32 v0, v48, v49, v50
    v_mfma_f32_16x16x32_bf16 v[52:55], v[116:119], v[124:127], v[52:55]
    v_mov_b64 v[36:37], 0
    v_mov_b64 v[38:39], 0
    v_smfmac_f32_16x16x64_bf16 v[68:71], v[40:43], v[240:247], v1
    ds_read_b128 v[104:107], v7 offset:0
    ds_read_b128 v[108:111], v7 offset:1024
    v_smfmac_f32_16x16x64_bf16 v[68:71], v[44:47], v[248:255], v1
    s_waitcnt lgkmcnt(2)
    ds_read_b128 v[112:115], v7 offset:16384
    ds_read_b128 v[116:119], v7 offset:17408
    v_max3_f32 v58, v51, v52, v53
    v_mfma_f32_16x16x32_bf16 v[60:63], v[88:91], v[16:19], 0
    s_cmp_ge_u32 s72, 59
    v_max3_f32 v0, v0, v54, v55
    v_max_f32_e64 v0, v0, v58
    v_mfma_f32_16x16x32_bf16 v[60:63], v[92:95], v[20:23], v[60:63]
    s_cbranch_scc1 rec_lf_s2
rec_lfx_s2:
    v_mov_b32 v58, v0
    v_mfma_f32_16x16x32_bf16 v[60:63], v[96:99], v[120:123], v[60:63]
    ds_read_b128 v[88:91], v7 offset:2048
    ds_read_b128 v[92:95], v7 offset:3072
    v_add_f32 v68, v68, v69
    v_add_f32 v70, v70, v71
    v_mfma_f32_16x16x32_bf16 v[60:63], v[100:103], v[124:127], v[60:63]
    v_permlane16_swap_b32 v58, v0
    v_cvt_pk_bf16_f32 v86, v68, v70
    v_max_f32 v0, v0, v58
    v_cndmask_b32 v52, v48, v52, s[82:83]
    v_cndmask_b32 v53, v49, v53, s[82:83]
    v_cndmask_b32 v54, v50, v54, s[82:83]
    v_cndmask_b32 v55, v51, v55, s[82:83]
    v_pk_mul_f32 v[52:53], v[52:53], s[86:87]
    v_max3_f32 v0, v0, v60, v61
    v_max3_f32 v0, v0, v62, v63
    v_mov_b32_e64 v58, v0
    v_pk_mul_f32 v[60:61], v[60:61], s[86:87]
    v_pk_mul_f32 v[54:55], v[54:55], s[86:87]
    v_permlane32_swap_b32 v58, v0
    v_max_f32 v0, v58, v0
    v_mul_f32_e64 v58, s86, v0
    v_pk_add_f32 v[60:61], v[60:61], v[58:59] op_sel_hi:[1,0] neg_lo:[0,1] neg_hi:[0,1]
    v_pk_add_f32 v[52:53], v[52:53], v[58:59] op_sel_hi:[1,0] neg_lo:[0,1] neg_hi:[0,1]
    v_pk_add_f32 v[54:55], v[54:55], v[58:59] op_sel_hi:[1,0] neg_lo:[0,1] neg_hi:[0,1]
    v_exp_f32 v60, v60
    v_exp_f32 v61, v61
    v_exp_f32_e64 v52, v52
    v_cvt_pk_bf16_f32 v14, v60, v61
    v_exp_f32 v53, v53
    v_exp_f32 v54, v54
    v_mfma_f32_16x16x16_bf16 v[60:63], v[80:81], v[14:15], 0
    v_exp_f32_e64 v55, v55
    v_cvt_pk_bf16_f32 v52, v52, v53
    v_mfma_f32_16x16x16_bf16 v[64:67], v[84:85], v[14:15], 0
    v_cvt_pk_bf16_f32 v53, v54, v55
    v_mov_b32 v48, v52 quad_perm:[0,0,2,2] row_mask:0xf bank_mask:0xf
    v_mfma_f32_16x16x16_bf16 v[68:71], v[86:87], v[14:15], 0
    v_mov_b32 v50, v52 quad_perm:[1,1,3,3] row_mask:0xf bank_mask:0xf
    v_mov_b32 v49, v53 quad_perm:[0,0,2,2] row_mask:0xf bank_mask:0xf
    v_mov_b32 v51, v53 quad_perm:[1,1,3,3] row_mask:0xf bank_mask:0xf
    s_nop 1
    v_mfma_f32_16x16x32_bf16 v[60:63], v[80:83], v[48:51], v[60:63]
    v_mfma_f32_16x16x32_bf16 v[64:67], v[72:75], v[48:51], v[64:67]
    v_mfma_f32_16x16x32_bf16 v[68:71], v[76:79], v[48:51], v[68:71]
    v_rcp_f32 v60, v60
    v_mov_b64 v[72:73], 0
    v_mov_b64 v[74:75], 0
    v_mov_b64 v[76:77], 0
    v_mov_b64 v[78:79], 0
    v_mov_b64 v[48:49], 0
    v_mov_b64 v[50:51], 0
    v_mov_b64_e64 v[52:53], 0
    v_cndmask_b32 v64, v64, v68, s[82:83]
    v_cndmask_b32 v65, v65, v69, s[82:83]
    v_cndmask_b32 v66, v66, v70, s[82:83]
    v_cndmask_b32 v67, v67, v71, s[82:83]
    v_pk_mul_f32 v[64:65], v[64:65], v[60:61] op_sel_hi:[1,0]
    v_pk_mul_f32 v[66:67], v[66:67], v[60:61] op_sel_hi:[1,0]
    v_cvt_pk_bf16_f32 v68, v64, v65
    v_cvt_pk_bf16_f32 v69, v66, v67
    ds_write_b64 v6, v[68:69]
    v_mov_b64 v[54:55], 0
    s_mov_b32 s88, s73
    s_mov_b32 s73, s74
    s_mov_b32 s74, s75
    s_mov_b32 s75, s88
    s_add_u32 s79, s73, s85
    s_waitcnt lgkmcnt(0)
    s_barrier
    ds_read_b128 v[56:59], v2 offset:29184
    ds_read_b128 v[60:63], v2 offset:30208
    s_mov_b32 s99, s98
    s_waitcnt lgkmcnt(1)
    v_smfmac_f32_16x16x64_bf16 v[24:27], v[56:59], v[128:135], v1
    s_waitcnt lgkmcnt(0)
    v_smfmac_f32_16x16x64_bf16 v[24:27], v[60:63], v[192:199], v1
    v_smfmac_f32_16x16x64_bf16 v[28:31], v[56:59], v[136:143], v1
    ds_read_b128 v[96:99], v7 offset:18432
    ds_read_b128 v[100:103], v7 offset:19456
    v_smfmac_f32_16x16x64_bf16 v[28:31], v[60:63], v[200:207], v1
    ds_read_b128 v[16:19], v7 offset:32768
    ds_read_b128 v[20:23], v7 offset:33792
    v_add_f32 v24, v24, v25
    v_add_f32_e64 v26, v26, v27
    v_smfmac_f32_16x16x64_bf16 v[32:35], v[56:59], v[144:151], v1
    ds_read_b128 v[120:123], v7 offset:49152
    ds_read_b128 v[124:127], v7 offset:50176
    v_cvt_pk_bf16_f32 v24, v24, v26
    v_smfmac_f32_16x16x64_bf16 v[32:35], v[60:63], v[208:215], v1
    ds_read_b128 v[40:43], v7 offset:34816
    ds_read_b128 v[44:47], v7 offset:35840
    v_add_f32 v28, v28, v29
    v_add_f32 v30, v30, v31
    v_smfmac_f32_16x16x64_bf16 v[36:39], v[56:59], v[152:159], v1
    ds_read_b128 v[64:67], v7 offset:51200
    ds_read_b128 v[68:71], v7 offset:52224
    v_cvt_pk_bf16_f32 v25, v28, v30
    v_smfmac_f32_16x16x64_bf16 v[36:39], v[60:63], v[216:223], v1
    buffer_store_dwordx2 v[24:25], v8, s[24:27], s76 offen sc1
    v_add_f32 v32, v32, v33
    v_add_f32 v34, v34, v35
    v_smfmac_f32_16x16x64_bf16 v[72:75], v[56:59], v[104:111], v1
    v_cvt_pk_bf16_f32 v32, v32, v34
    v_smfmac_f32_16x16x64_bf16 v[72:75], v[60:63], v[112:119], v1
    v_add_f32 v36, v36, v37
    v_add_f32 v38, v38, v39
    v_smfmac_f32_16x16x64_bf16 v[76:79], v[56:59], v[88:95], v1
    s_waitcnt lgkmcnt(0)
    v_cvt_pk_bf16_f32 v33, v36, v38
    v_smfmac_f32_16x16x64_bf16 v[76:79], v[60:63], v[96:103], v1
    buffer_store_dwordx2 v[32:33], v8, s[24:27], s65 offen sc1
    v_add_f32 v72, v72, v73
    v_add_f32_e64 v74, v74, v75
    v_smfmac_f32_16x16x64_bf16 v[48:51], v[56:59], v[16:23], v1
    v_cvt_pk_bf16_f32 v72, v72, v74
    v_smfmac_f32_16x16x64_bf16 v[48:51], v[60:63], v[120:127], v1
    v_add_f32 v76, v76, v77
    v_add_f32 v78, v78, v79
    v_smfmac_f32_16x16x64_bf16 v[52:55], v[56:59], v[40:47], v1
    v_cvt_pk_bf16_f32 v73, v76, v78
    v_smfmac_f32_16x16x64_bf16 v[52:55], v[60:63], v[64:71], v1
    buffer_store_dwordx2 v[72:73], v8, s[24:27], s66 offen sc1
    v_add_f32 v48, v48, v49
    v_add_f32 v50, v50, v51
    v_cvt_pk_bf16_f32 v48, v48, v50
    s_nop 3
    v_add_f32 v52, v52, v53
    v_add_f32_e64 v54, v54, v55
    v_cvt_pk_bf16_f32 v49, v52, v54
    buffer_store_dwordx2 v[48:49], v8, s[24:27], s67 offen sc1
    v_mov_b64 v[24:25], -1
    v_mov_b64 v[26:27], -1
    v_mov_b64 v[28:29], -1
    v_mov_b64 v[30:31], -1
    v_mov_b64 v[70:71], 0
    v_mov_b64 v[68:69], 0
    v_mov_b64 v[66:67], 0
    v_mov_b64 v[64:65], 0
    v_mov_b64 v[62:63], 0
    v_mov_b64 v[60:61], 0
    v_mov_b64 v[58:59], 0
    v_mov_b64 v[56:57], 0
    v_mov_b64 v[54:55], 0
    v_mov_b64 v[52:53], 0
    v_mov_b64 v[50:51], 0
    v_mov_b64 v[48:49], 0
    v_mov_b64 v[16:17], -1
    v_mov_b64 v[18:19], -1
    v_mov_b64 v[20:21], -1
    v_mov_b64 v[22:23], -1
    v_add_u32 v0, 0xffff0000, v7
    ds_read_b128 v[88:91], v0 offset:0
    ds_read_b128 v[92:95], v0 offset:1024
    ds_read_b128 v[96:99], v0 offset:2048
    ds_read_b128 v[100:103], v0 offset:3072
    ds_read_b128 v[104:107], v0 offset:16384
    ds_read_b128 v[108:111], v0 offset:17408
    ds_read_b128 v[112:115], v0 offset:18432
    buffer_load_dwordx4 v[24:27], v2, s[24:27], s99 offen offset:0 sc1
    buffer_load_dwordx4 v[28:31], v2, s[24:27], s99 offen offset:1024 sc1
    ds_read_b128 v[116:119], v0 offset:19456
    ds_read2_b32 v[120:121], v3 offset0:64 offset1:200
    v_mov_b32 v122, v84
    v_mov_b32 v123, v86
    s_mov_b32 s88, s76
    s_mov_b32 s76, s77
    s_mov_b32 s77, s78
    s_mov_b32 s78, s88
    s_and_b32 s88, s72, 63
    s_lshl_b32 s88, s88, 17
    s_waitcnt vmcnt(6)
rec_rs_s2:
    s_add_u32 s84, s84, 1
    s_cmp_gt_u32 s84, 4194304
    v_max3_u32 v0, v24, v25, v26
    v_max3_u32 v14, v27, v28, v29
    v_max3_u32 v0, v0, v30, v31
    v_mfma_f32_16x16x32_bf16 v[124:127], v[80:83], v[24:27], 0
    v_max_u32 v0, v0, v14
    v_cmp_eq_u32 vcc, -1, v0
    v_mfma_f32_16x16x32_bf16 v[124:127], v[80:83], v[28:31], v[124:127]
    s_cbranch_vccz rec_go_s2
    s_mov_b64 exec, vcc
    buffer_load_dwordx4 v[24:27], v2, s[24:27], s99 offen offset:0 sc1
    buffer_load_dwordx4 v[28:31], v2, s[24:27], s99 offen offset:1024 sc1
    s_mov_b64 exec, -1
    v_max3_u32 v0, v24, v25, v26
    v_max3_u32 v14, v27, v28, v29
    v_max3_u32 v0, v0, v30, v31
    v_mfma_f32_16x16x32_bf16 v[124:127], v[80:83], v[24:27], 0
    v_max_u32 v0, v0, v14
    v_cmp_eq_u32_e64 vcc, -1, v0
    v_mfma_f32_16x16x32_bf16 v[124:127], v[80:83], v[28:31], v[124:127]
    s_cselect_b64 vcc, 0, vcc
    s_cbranch_vccnz rec_rs_s2
rec_go_s2:
    v_lshrrev_b32_e64 v0, 2, v2
    ds_read_b32 v14, v0 offset:31232
    ds_read_b128 v[72:75], v2 offset:12288
    ds_read_b128 v[76:79], v2 offset:13312
    s_nop 2
    v_add_f32 v126, v126, v126 row_ror:4 row_mask:0xf bank_mask:0xf
    v_add_f32 v127, v127, v127 row_ror:4 row_mask:0xf bank_mask:0xf
    s_nop 0
    v_add_f32 v126, v126, v126 row_ror:8 row_mask:0xf bank_mask:0xf
    v_add_f32 v127, v127, v127 row_ror:8 row_mask:0xf bank_mask:0xf
    v_cvt_pk_bf16_f32 v124, v126, v127
    buffer_store_dword v124, v9, s[24:27], s73 offen sc1
    s_add_u32 s96, s63, s88
    s_mov_b32 s93, s72
    s_add_u32 s72, s72, 1
    s_add_u32 s89, s72, 1
    s_min_u32 s89, s89, 63
    s_and_b32 s88, s89, 63
    s_lshl_b32 s88, s88, 18
    s_add_u32 s88, s88, s94
    s_add_u32 s90, s88, 33554432
    s_add_u32 s91, s88, 50331648
    s_add_u32 s97, s78, s95
    s_add_u32 s98, s76, s95
    s_add_u32 s65, s76, 65536
    s_add_u32 s66, s76, 131072
    s_add_u32 s67, s76, 196608
    s_waitcnt lgkmcnt(0)
    v_cmp_eq_u32 s[80:81], s70, v14
    buffer_load_dwordx4 v[16:19], v2, s[24:27], s79 offen offset:0 sc1
    buffer_load_dwordx4 v[20:23], v2, s[24:27], s79 offen offset:1024 sc1
    s_bitcmp1_b64 s[80:81], s89
    s_cbranch_scc0 rec_kvw_s2
rec_kvok_s2:
    s_branch rec_enter_s2
rec_f0_s2:
    s_mov_b64 exec, vcc
    buffer_load_dwordx4 v[24:27], v2, s[24:27], s99 offen offset:0 sc1
    buffer_load_dwordx4 v[28:31], v2, s[24:27], s99 offen offset:1024 sc1
    s_mov_b64 exec, -1
    s_add_u32 s84, s84, 1
    s_cmp_gt_u32 s84, 4194304
    s_cbranch_scc0 rec_rs_s2
    s_branch rec_go_s2
rec_redo_s3:
    buffer_load_dwordx4 v[16:19], v2, s[24:27], s79 offen offset:0 sc1
    buffer_load_dwordx4 v[20:23], v2, s[24:27], s79 offen offset:1024 sc1
    v_add_u32 v0, 0xffff0000, v7
    ds_read_b128 v[88:91], v0 offset:0
    ds_read_b128 v[92:95], v0 offset:1024
    ds_read_b128 v[96:99], v0 offset:2048
    ds_read_b128 v[100:103], v0 offset:3072
    ds_read_b128 v[104:107], v0 offset:16384
    ds_read_b128 v[108:111], v0 offset:17408
    ds_read_b128 v[112:115], v0 offset:18432
    ds_read_b128 v[116:119], v0 offset:19456
    v_mov_b64 v[70:71], 0
    v_mov_b64 v[68:69], 0
    v_mov_b64 v[66:67], 0
    v_mov_b64 v[64:65], 0
    v_mov_b64 v[62:63], 0
    v_mov_b64 v[60:61], 0
    v_mov_b64 v[58:59], 0
    v_mov_b64 v[56:57], 0
    v_mov_b64 v[54:55], 0
    v_mov_b64 v[52:53], 0
    v_mov_b64 v[50:51], 0
    v_mov_b64 v[48:49], 0
    s_waitcnt vmcnt(0)
    ds_read_b128 v[72:75], v2 offset:14336
    ds_read_b128 v[76:79], v2 offset:15360
    s_waitcnt lgkmcnt(0)
    s_bitcmp1_b64 s[80:81], s89
    s_cbranch_scc0 rec_kvw_s3
    s_branch rec_enter_s3
rec_g0_s3:
    s_mov_b64 exec, vcc
    buffer_load_dwordx4 v[16:19], v2, s[24:27], s79 offen offset:0 sc1
    buffer_load_dwordx4 v[20:23], v2, s[24:27], s79 offen offset:1024 sc1
    s_mov_b64 exec, -1
    s_add_u32 s84, s84, 1
    s_cmp_gt_u32 s84, 4194304
    s_cbranch_scc0 rec_enter_s3
    s_branch rec_ok0_s3
rec_lf_s3:
    v_mov_b32 v14, s72
    s_waitcnt vmcnt(5)
    s_mov_b64 exec, 1
    buffer_store_dword v14, off, s[24:27], s100 sc1
    s_mov_b64 exec, -1
    s_cmp_eq_u32 s72, 63
    s_cbranch_scc1 rec_fin
    s_branch rec_lfx_s3
rec_kvw_s3:
    s_add_u32 s61, s61, 1
    v_lshrrev_b32 v14, 2, v2
    buffer_load_dword v14, v14, s[24:27], s92 offen sc1
    s_waitcnt vmcnt(0)
    v_cmp_eq_u32 s[80:81], s70, v14
    s_cmp_gt_u32 s61, 4194304
    s_cbranch_scc1 rec_kvok_s3
    s_bitcmp1_b64 s[80:81], s89
    s_cbranch_scc0 rec_kvw_s3
    s_branch rec_kvok_s3
.p2align 6
rec_enter_s3:
    v_max3_u32 v0, v16, v17, v18
    v_max3_u32 v14, v19, v20, v21
    v_max3_u32 v0, v0, v22, v23
    v_max_u32 v0, v0, v14
    v_cmp_eq_u32_e64 vcc, -1, v0
    s_cbranch_vccz rec_ok0_s3
    v_max3_u32 v0, v16, v17, v18
    v_max3_u32 v14, v19, v20, v21
    v_max3_u32 v0, v0, v22, v23
    v_max_u32 v0, v0, v14
    v_cmp_eq_u32_e64 vcc, -1, v0
    s_cbranch_vccnz rec_g0_s3
rec_ok0_s3:
    v_smfmac_f32_16x16x64_bf16 v[64:67], v[16:19], v[88:95], v1
    ds_write_b128 v2, v[16:19] offset:22528
    v_smfmac_f32_16x16x64_bf16 v[68:71], v[16:19], v[96:103], v1
    ds_write_b128 v2, v[20:23] offset:23552
    v_smfmac_f32_16x16x64_bf16 v[64:67], v[20:23], v[104:111], v1
    v_smfmac_f32_16x16x64_bf16 v[68:71], v[20:23], v[112:119], v1
    v_smfmac_f32_16x16x64_bf16 v[48:51], v[16:19], a[48:55], v1
    v_smfmac_f32_16x16x64_bf16 v[52:55], v[16:19], a[112:119], v1
    s_waitcnt lgkmcnt(0)
    s_barrier
    ds_read_b128 v[24:27], v2 offset:16384
    v_smfmac_f32_16x16x64_bf16 v[48:51], v[20:23], a[56:63], v1
    ds_read_b128 v[28:31], v2 offset:17408
    ds_read_b128 v[32:35], v2 offset:18432
    v_smfmac_f32_16x16x64_bf16 v[52:55], v[20:23], a[120:127], v1
    ds_read_b128 v[36:39], v2 offset:19456
    ds_read_b128 v[40:43], v2 offset:20480
    v_smfmac_f32_16x16x64_bf16 v[56:59], v[16:19], a[176:183], v1
    ds_read_b128 v[44:47], v2 offset:21504
    v_smfmac_f32_16x16x64_bf16 v[60:63], v[16:19], a[240:247], v1
    buffer_store_dwordx4 v[120:123], v2, s[24:27], s96 offen sc1
    v_smfmac_f32_16x16x64_bf16 v[56:59], v[20:23], a[184:191], v1
    v_smfmac_f32_16x16x64_bf16 v[60:63], v[20:23], a[248:255], v1
    s_waitcnt lgkmcnt(5)
    s_mov_b32 m0, 14336
    v_smfmac_f32_16x16x64_bf16 v[48:51], v[24:27], a[0:7], v1
    buffer_load_dwordx4 v2, s[24:27], s91 offen sc1 lds
    v_smfmac_f32_16x16x64_bf16 v[52:55], v[24:27], a[64:71], v1
    s_waitcnt lgkmcnt(4)
    buffer_load_dwordx4 v2, s[24:27], s91 offen offset:1024 sc1 lds
    v_smfmac_f32_16x16x64_bf16 v[48:51], v[28:31], a[8:15], v1
    v_smfmac_f32_16x16x64_bf16 v[52:55], v[28:31], a[72:79], v1
    s_waitcnt lgkmcnt(0)
    v_smfmac_f32_16x16x64_bf16 v[48:51], v[32:35], a[16:23], v1
    ds_read_b128 v[88:91], v2 offset:0
    v_add_u32 v0, 0xffff0000, v7
    v_smfmac_f32_16x16x64_bf16 v[52:55], v[32:35], a[80:87], v1
    ds_read_b128 v[92:95], v2 offset:1024
    v_smfmac_f32_16x16x64_bf16 v[48:51], v[36:39], a[24:31], v1
    ds_read_b128 v[96:99], v2 offset:2048
    v_smfmac_f32_16x16x64_bf16 v[52:55], v[36:39], a[88:95], v1
    ds_read_b128 v[100:103], v2 offset:3072
    s_waitcnt vmcnt(3)
    v_smfmac_f32_16x16x64_bf16 v[48:51], v[40:43], a[32:39], v1
    ds_read_b128 v[120:123], v0 offset:32768
    v_smfmac_f32_16x16x64_bf16 v[52:55], v[40:43], a[96:103], v1
    ds_read_b128 v[124:127], v0 offset:33792
    v_smfmac_f32_16x16x64_bf16 v[48:51], v[44:47], a[40:47], v1
    ds_read_b128 v[16:19], v0 offset:34816
    v_smfmac_f32_16x16x64_bf16 v[52:55], v[44:47], a[104:111], v1
    ds_read_b128 v[20:23], v0 offset:35840
    v_smfmac_f32_16x16x64_bf16 v[56:59], v[24:27], a[128:135], v1
    ds_read_b128 v[104:107], v0 offset:49152
    v_add_f32_e64 v48, v48, v49
    v_smfmac_f32_16x16x64_bf16 v[60:63], v[24:27], a[192:199], v1
    ds_read_b128 v[108:111], v0 offset:50176
    v_add_f32_e64 v50, v50, v51
    v_smfmac_f32_16x16x64_bf16 v[56:59], v[28:31], a[136:143], v1
    ds_read_b128 v[112:115], v0 offset:51200
    v_add_f32_e64 v52, v52, v53
    v_smfmac_f32_16x16x64_bf16 v[60:63], v[28:31], a[200:207], v1
    ds_read_b128 v[116:119], v0 offset:52224
    v_add_f32_e64 v54, v54, v55
    v_smfmac_f32_16x16x64_bf16 v[56:59], v[32:35], a[144:151], v1
    buffer_store_dword v10, v9, s[24:27], s75 offen sc1
    v_cvt_pk_bf16_f32 v48, v48, v52
    v_smfmac_f32_16x16x64_bf16 v[60:63], v[32:35], a[208:215], v1
    v_cvt_pk_bf16_f32 v49, v50, v54
    v_smfmac_f32_16x16x64_bf16 v[56:59], v[36:39], a[152:159], v1
    ds_write2_b32 v3, v48, v49 offset0:0 offset1:136
    v_smfmac_f32_16x16x64_bf16 v[60:63], v[36:39], a[216:223], v1
    v_smfmac_f32_16x16x64_bf16 v[56:59], v[40:43], a[160:167], v1
    v_smfmac_f32_16x16x64_bf16 v[60:63], v[40:43], a[224:231], v1
    v_smfmac_f32_16x16x64_bf16 v[56:59], v[44:47], a[168:175], v1
    v_smfmac_f32_16x16x64_bf16 v[60:63], v[44:47], a[232:239], v1
    s_waitcnt lgkmcnt(1)
    v_smfmac_f32_16x16x64_bf16 v[64:67], v[24:27], v[120:127], v1
    v_add_f32 v56, v56, v57
    v_smfmac_f32_16x16x64_bf16 v[68:71], v[24:27], v[16:23], v1
    s_waitcnt lgkmcnt(0)
    s_barrier
    v_add_f32_e64 v58, v58, v59
    v_smfmac_f32_16x16x64_bf16 v[64:67], v[28:31], v[104:111], v1
    ds_read_b128 v[16:19], v4 offset:0
    ds_read_b128 v[20:23], v4 offset:64
    v_add_f32_e64 v60, v60, v61
    v_smfmac_f32_16x16x64_bf16 v[68:71], v[28:31], v[112:119], v1
    ds_read_b128 v[120:123], v4 offset:128
    ds_read_b128 v[124:127], v4 offset:192
    v_add_f32_e64 v62, v62, v63
    v_smfmac_f32_16x16x64_bf16 v[64:67], v[32:35], v[160:167], v1
    ds_read_b128 v[104:107], v2 offset:4096
    ds_read_b128 v[108:111], v2 offset:5120
    v_cvt_pk_bf16_f32 v56, v56, v60
    v_smfmac_f32_16x16x64_bf16 v[64:67], v[36:39], v[168:175], v1
    ds_read_b128 v[112:115], v2 offset:6144
    ds_read_b128 v[116:119], v2 offset:7168
    v_cvt_pk_bf16_f32 v57, v58, v62
    v_smfmac_f32_16x16x64_bf16 v[64:67], v[40:43], v[176:183], v1
    ds_write2_b32 v3, v56, v57 offset0:64 offset1:200
    v_smfmac_f32_16x16x64_bf16 v[64:67], v[44:47], v[184:191], v1
    v_smfmac_f32_16x16x64_bf16 v[68:71], v[32:35], v[224:231], v1
    v_mov_b64_e64 v[24:25], 0
    v_smfmac_f32_16x16x64_bf16 v[68:71], v[36:39], v[232:239], v1
    s_waitcnt lgkmcnt(5)
    v_mov_b64 v[26:27], 0
    v_mfma_f32_16x16x32_bf16 v[48:51], v[88:91], v[16:19], 0
    v_mov_b64 v[28:29], 0
    v_mov_b64 v[30:31], 0
    v_mfma_f32_16x16x32_bf16 v[48:51], v[92:95], v[20:23], v[48:51]
    s_mov_b32 m0, 6144
    v_mov_b64 v[32:33], 0
    v_mov_b64 v[34:35], 0
    v_mfma_f32_16x16x32_bf16 v[48:51], v[96:99], v[120:123], v[48:51]
    s_waitcnt lgkmcnt(0)
    s_barrier
    ds_read_b128 v[88:91], v5 offset:0
    v_mfma_f32_16x16x32_bf16 v[48:51], v[100:103], v[124:127], v[48:51]
    ds_read_b128 v[92:95], v5 offset:64
    ds_read_b128 v[96:99], v5 offset:128
    ds_read_b128 v[100:103], v5 offset:192
    v_mfma_f32_16x16x32_bf16 v[52:55], v[104:107], v[16:19], 0
    buffer_load_dwordx4 v2, s[24:27], s90 offen sc1 lds
    v_add_f32 v64, v64, v65
    v_add_f32 v66, v66, v67
    v_mfma_f32_16x16x32_bf16 v[52:55], v[108:111], v[20:23], v[52:55]
    buffer_load_dwordx4 v2, s[24:27], s90 offen offset:1024 sc1 lds
    v_mfma_f32_16x16x32_bf16 v[52:55], v[112:115], v[120:123], v[52:55]
    v_cvt_pk_bf16_f32 v84, v64, v66
    v_max3_f32 v0, v48, v49, v50
    v_mfma_f32_16x16x32_bf16 v[52:55], v[116:119], v[124:127], v[52:55]
    v_mov_b64 v[36:37], 0
    v_mov_b64 v[38:39], 0
    v_smfmac_f32_16x16x64_bf16 v[68:71], v[40:43], v[240:247], v1
    ds_read_b128 v[104:107], v7 offset:0
    ds_read_b128 v[108:111], v7 offset:1024
    v_smfmac_f32_16x16x64_bf16 v[68:71], v[44:47], v[248:255], v1
    s_waitcnt lgkmcnt(2)
    ds_read_b128 v[112:115], v7 offset:16384
    ds_read_b128 v[116:119], v7 offset:17408
    v_max3_f32 v58, v51, v52, v53
    v_mfma_f32_16x16x32_bf16 v[60:63], v[88:91], v[16:19], 0
    s_cmp_ge_u32 s72, 59
    v_max3_f32 v0, v0, v54, v55
    v_max_f32_e64 v0, v0, v58
    v_mfma_f32_16x16x32_bf16 v[60:63], v[92:95], v[20:23], v[60:63]
    s_cbranch_scc1 rec_lf_s3
rec_lfx_s3:
    v_mov_b32 v58, v0
    v_mfma_f32_16x16x32_bf16 v[60:63], v[96:99], v[120:123], v[60:63]
    ds_read_b128 v[88:91], v7 offset:2048
    ds_read_b128 v[92:95], v7 offset:3072
    v_add_f32 v68, v68, v69
    v_add_f32 v70, v70, v71
    v_mfma_f32_16x16x32_bf16 v[60:63], v[100:103], v[124:127], v[60:63]
    v_permlane16_swap_b32 v58, v0
    v_cvt_pk_bf16_f32 v86, v68, v70
    v_max_f32 v0, v0, v58
    v_cndmask_b32 v52, v48, v52, s[82:83]
    v_cndmask_b32 v53, v49, v53, s[82:83]
    v_cndmask_b32 v54, v50, v54, s[82:83]
    v_cndmask_b32 v55, v51, v55, s[82:83]
    v_pk_mul_f32 v[52:53], v[52:53], s[86:87]
    v_max3_f32 v0, v0, v60, v61
    v_max3_f32 v0, v0, v62, v63
    v_mov_b32_e64 v58, v0
    v_pk_mul_f32 v[60:61], v[60:61], s[86:87]
    v_pk_mul_f32 v[54:55], v[54:55], s[86:87]
    v_permlane32_swap_b32 v58, v0
    v_max_f32 v0, v58, v0
    v_mul_f32_e64 v58, s86, v0
    v_pk_add_f32 v[60:61], v[60:61], v[58:59] op_sel_hi:[1,0] neg_lo:[0,1] neg_hi:[0,1]
    v_pk_add_f32 v[52:53], v[52:53], v[58:59] op_sel_hi:[1,0] neg_lo:[0,1] neg_hi:[0,1]
    v_pk_add_f32 v[54:55], v[54:55], v[58:59] op_sel_hi:[1,0] neg_lo:[0,1] neg_hi:[0,1]
    v_exp_f32 v60, v60
    v_exp_f32 v61, v61
    v_exp_f32_e64 v52, v52
    v_cvt_pk_bf16_f32 v14, v60, v61
    v_exp_f32 v53, v53
    v_exp_f32 v54, v54
    v_mfma_f32_16x16x16_bf16 v[60:63], v[80:81], v[14:15], 0
    v_exp_f32_e64 v55, v55
    v_cvt_pk_bf16_f32 v52, v52, v53
    v_mfma_f32_16x16x16_bf16 v[64:67], v[84:85], v[14:15], 0
    v_cvt_pk_bf16_f32 v53, v54, v55
    v_mov_b32 v48, v52 quad_perm:[0,0,2,2] row_mask:0xf bank_mask:0xf
    v_mfma_f32_16x16x16_bf16 v[68:71], v[86:87], v[14:15], 0
    v_mov_b32 v50, v52 quad_perm:[1,1,3,3] row_mask:0xf bank_mask:0xf
    v_mov_b32 v49, v53 quad_perm:[0,0,2,2] row_mask:0xf bank_mask:0xf
    v_mov_b32 v51, v53 quad_perm:[1,1,3,3] row_mask:0xf bank_mask:0xf
    s_nop 1
    v_mfma_f32_16x16x32_bf16 v[60:63], v[80:83], v[48:51], v[60:63]
    v_mfma_f32_16x16x32_bf16 v[64:67], v[72:75], v[48:51], v[64:67]
    v_mfma_f32_16x16x32_bf16 v[68:71], v[76:79], v[48:51], v[68:71]
    v_rcp_f32 v60, v60
    v_mov_b64 v[72:73], 0
    v_mov_b64 v[74:75], 0
    v_mov_b64 v[76:77], 0
    v_mov_b64 v[78:79], 0
    v_mov_b64 v[48:49], 0
    v_mov_b64 v[50:51], 0
    v_mov_b64_e64 v[52:53], 0
    v_cndmask_b32 v64, v64, v68, s[82:83]
    v_cndmask_b32 v65, v65, v69, s[82:83]
    v_cndmask_b32 v66, v66, v70, s[82:83]
    v_cndmask_b32 v67, v67, v71, s[82:83]
    v_pk_mul_f32 v[64:65], v[64:65], v[60:61] op_sel_hi:[1,0]
    v_pk_mul_f32 v[66:67], v[66:67], v[60:61] op_sel_hi:[1,0]
    v_cvt_pk_bf16_f32 v68, v64, v65
    v_cvt_pk_bf16_f32 v69, v66, v67
    ds_write_b64 v6, v[68:69]
    v_mov_b64 v[54:55], 0
    s_mov_b32 s88, s73
    s_mov_b32 s73, s74
    s_mov_b32 s74, s75
    s_mov_b32 s75, s88
    s_add_u32 s79, s73, s85
    s_waitcnt lgkmcnt(0)
    s_barrier
    ds_read_b128 v[56:59], v2 offset:29184
    ds_read_b128 v[60:63], v2 offset:30208
    s_mov_b32 s99, s98
    s_waitcnt lgkmcnt(1)
    v_smfmac_f32_16x16x64_bf16 v[24:27], v[56:59], v[128:135], v1
    s_waitcnt lgkmcnt(0)
    v_smfmac_f32_16x16x64_bf16 v[24:27], v[60:63], v[192:199], v1
    v_smfmac_f32_16x16x64_bf16 v[28:31], v[56:59], v[136:143], v1
    ds_read_b128 v[96:99], v7 offset:18432
    ds_read_b128 v[100:103], v7 offset:19456
    v_smfmac_f32_16x16x64_bf16 v[28:31], v[60:63], v[200:207], v1
    ds_read_b128 v[16:19], v7 offset:32768
    ds_read_b128 v[20:23], v7 offset:33792
    v_add_f32 v24, v24, v25
    v_add_f32_e64 v26, v26, v27
    v_smfmac_f32_16x16x64_bf16 v[32:35], v[56:59], v[144:151], v1
    ds_read_b128 v[120:123], v7 offset:49152
    ds_read_b128 v[124:127], v7 offset:50176
    v_cvt_pk_bf16_f32 v24, v24, v26
    v_smfmac_f32_16x16x64_bf16 v[32:35], v[60:63], v[208:215], v1
    ds_read_b128 v[40:43], v7 offset:34816
    ds_read_b128 v[44:47], v7 offset:35840
    v_add_f32 v28, v28, v29
    v_add_f32 v30, v30, v31
    v_smfmac_f32_16x16x64_bf16 v[36:39], v[56:59], v[152:159], v1
    ds_read_b128 v[64:67], v7 offset:51200
    ds_read_b128 v[68:71], v7 offset:52224
    v_cvt_pk_bf16_f32 v25, v28, v30
    v_smfmac_f32_16x16x64_bf16 v[36:39], v[60:63], v[216:223], v1
    buffer_store_dwordx2 v[24:25], v8, s[24:27], s76 offen sc1
    v_add_f32 v32, v32, v33
    v_add_f32 v34, v34, v35
    v_smfmac_f32_16x16x64_bf16 v[72:75], v[56:59], v[104:111], v1
    v_cvt_pk_bf16_f32 v32, v32, v34
    v_smfmac_f32_16x16x64_bf16 v[72:75], v[60:63], v[112:119], v1
    v_add_f32 v36, v36, v37
    v_add_f32 v38, v38, v39
    v_smfmac_f32_16x16x64_bf16 v[76:79], v[56:59], v[88:95], v1
    s_waitcnt lgkmcnt(0)
    v_cvt_pk_bf16_f32 v33, v36, v38
    v_smfmac_f32_16x16x64_bf16 v[76:79], v[60:63], v[96:103], v1
    buffer_store_dwordx2 v[32:33], v8, s[24:27], s65 offen sc1
    v_add_f32 v72, v72, v73
    v_add_f32_e64 v74, v74, v75
    v_smfmac_f32_16x16x64_bf16 v[48:51], v[56:59], v[16:23], v1
    v_cvt_pk_bf16_f32 v72, v72, v74
    v_smfmac_f32_16x16x64_bf16 v[48:51], v[60:63], v[120:127], v1
    v_add_f32 v76, v76, v77
    v_add_f32 v78, v78, v79
    v_smfmac_f32_16x16x64_bf16 v[52:55], v[56:59], v[40:47], v1
    v_cvt_pk_bf16_f32 v73, v76, v78
    v_smfmac_f32_16x16x64_bf16 v[52:55], v[60:63], v[64:71], v1
    buffer_store_dwordx2 v[72:73], v8, s[24:27], s66 offen sc1
    v_add_f32 v48, v48, v49
    v_add_f32 v50, v50, v51
    v_cvt_pk_bf16_f32 v48, v48, v50
    s_nop 3
    v_add_f32 v52, v52, v53
    v_add_f32_e64 v54, v54, v55
    v_cvt_pk_bf16_f32 v49, v52, v54
    buffer_store_dwordx2 v[48:49], v8, s[24:27], s67 offen sc1
    v_mov_b64 v[24:25], -1
    v_mov_b64 v[26:27], -1
    v_mov_b64 v[28:29], -1
    v_mov_b64 v[30:31], -1
    v_mov_b64 v[70:71], 0
    v_mov_b64 v[68:69], 0
    v_mov_b64 v[66:67], 0
    v_mov_b64 v[64:65], 0
    v_mov_b64 v[62:63], 0
    v_mov_b64 v[60:61], 0
    v_mov_b64 v[58:59], 0
    v_mov_b64 v[56:57], 0
    v_mov_b64 v[54:55], 0
    v_mov_b64 v[52:53], 0
    v_mov_b64 v[50:51], 0
    v_mov_b64 v[48:49], 0
    v_mov_b64 v[16:17], -1
    v_mov_b64 v[18:19], -1
    v_mov_b64 v[20:21], -1
    v_mov_b64 v[22:23], -1
    v_add_u32 v0, 0xffff0000, v7
    ds_read_b128 v[88:91], v0 offset:0
    ds_read_b128 v[92:95], v0 offset:1024
    ds_read_b128 v[96:99], v0 offset:2048
    ds_read_b128 v[100:103], v0 offset:3072
    ds_read_b128 v[104:107], v0 offset:16384
    ds_read_b128 v[108:111], v0 offset:17408
    ds_read_b128 v[112:115], v0 offset:18432
    ds_read_b128 v[116:119], v0 offset:19456
    ds_read2_b32 v[120:121], v3 offset0:64 offset1:200
    v_mov_b32 v122, v84
    v_mov_b32 v123, v86
    s_mov_b32 s88, s76
    s_mov_b32 s76, s77
    s_mov_b32 s77, s78
    s_mov_b32 s78, s88
    buffer_load_dwordx4 v[24:27], v2, s[24:27], s99 offen offset:0 sc1
    buffer_load_dwordx4 v[28:31], v2, s[24:27], s99 offen offset:1024 sc1
    s_and_b32 s88, s72, 63
    s_lshl_b32 s88, s88, 17
    s_waitcnt vmcnt(6)
rec_rs_s3:
    s_add_u32 s84, s84, 1
    s_cmp_gt_u32 s84, 4194304
    v_max3_u32 v0, v24, v25, v26
    v_max3_u32 v14, v27, v28, v29
    v_max3_u32 v0, v0, v30, v31
    v_mfma_f32_16x16x32_bf16 v[124:127], v[80:83], v[24:27], 0
    v_max_u32 v0, v0, v14
    v_cmp_eq_u32 vcc, -1, v0
    v_mfma_f32_16x16x32_bf16 v[124:127], v[80:83], v[28:31], v[124:127]
    s_cbranch_vccz rec_go_s3
    s_mov_b64 exec, vcc
    buffer_load_dwordx4 v[24:27], v2, s[24:27], s99 offen offset:0 sc1
    buffer_load_dwordx4 v[28:31], v2, s[24:27], s99 offen offset:1024 sc1
    s_mov_b64 exec, -1
    v_max3_u32 v0, v24, v25, v26
    v_max3_u32 v14, v27, v28, v29
    v_max3_u32 v0, v0, v30, v31
    v_mfma_f32_16x16x32_bf16 v[124:127], v[80:83], v[24:27], 0
    v_max_u32 v0, v0, v14
    v_cmp_eq_u32_e64 vcc, -1, v0
    v_mfma_f32_16x16x32_bf16 v[124:127], v[80:83], v[28:31], v[124:127]
    s_cselect_b64 vcc, 0, vcc
    s_cbranch_vccnz rec_rs_s3
rec_go_s3:
    v_lshrrev_b32_e64 v0, 2, v2
    ds_read_b32 v14, v0 offset:31232
    ds_read_b128 v[72:75], v2 offset:14336
    ds_read_b128 v[76:79], v2 offset:15360
    s_nop 2
    v_add_f32 v126, v126, v126 row_ror:4 row_mask:0xf bank_mask:0xf
    v_add_f32 v127, v127, v127 row_ror:4 row_mask:0xf bank_mask:0xf
    s_nop 0
    v_add_f32 v126, v126, v126 row_ror:8 row_mask:0xf bank_mask:0xf
    v_add_f32 v127, v127, v127 row_ror:8 row_mask:0xf bank_mask:0xf
    v_cvt_pk_bf16_f32 v124, v126, v127
    buffer_store_dword v124, v9, s[24:27], s73 offen sc1
    s_add_u32 s96, s63, s88
    s_mov_b32 s93, s72
    s_add_u32 s72, s72, 1
    s_add_u32 s89, s72, 1
    s_min_u32 s89, s89, 63
    s_and_b32 s88, s89, 63
    s_lshl_b32 s88, s88, 18
    s_add_u32 s88, s88, s94
    s_add_u32 s90, s88, 33554432
    s_add_u32 s91, s88, 50331648
    s_add_u32 s97, s78, s95
    s_add_u32 s98, s76, s95
    s_add_u32 s65, s76, 65536
    s_add_u32 s66, s76, 131072
    s_add_u32 s67, s76, 196608
    s_waitcnt lgkmcnt(0)
    v_cmp_eq_u32 s[80:81], s70, v14
    buffer_load_dwordx4 v[16:19], v2, s[24:27], s79 offen offset:0 sc1
    buffer_load_dwordx4 v[20:23], v2, s[24:27], s79 offen offset:1024 sc1
    s_bitcmp1_b64 s[80:81], s89
    s_cbranch_scc0 rec_kvw_s3
rec_kvok_s3:
    s_branch rec_enter_s3
rec_f0_s3:
    s_mov_b64 exec, vcc
    buffer_load_dwordx4 v[24:27], v2, s[24:27], s99 offen offset:0 sc1
    buffer_load_dwordx4 v[28:31], v2, s[24:27], s99 offen offset:1024 sc1
    s_mov_b64 exec, -1
    s_add_u32 s84, s84, 1
    s_cmp_gt_u32 s84, 4194304
    s_cbranch_scc0 rec_rs_s3
    s_branch rec_go_s3
rec_fin:
    v_mov_b32 v58, v84
    v_add_f32 v68, v68, v69
    v_add_f32 v70, v70, v71
    v_cvt_pk_bf16_f32 v59, v68, v70
    s_add_u32 s88, s63, 8257536
    buffer_store_dwordx4 v[56:59], v2, s[24:27], s88 offen sc1
    s_waitcnt vmcnt(0)
    v_mov_b32_e64 v124, 64
    s_mov_b64 exec, 1
    buffer_store_dword v124, off, s[24:27], s100 sc1
    s_mov_b64 exec, -1
    s_branch main_done
work_start:
    s_mov_b32 s52, 0
    s_cmp_lt_u32 s53, 96
    s_cbranch_scc1 qkv_start
    s_sub_u32 s63, s53, 96
    s_cmp_ge_u32 s63, 128
    s_cbranch_scc1 pre_init
    s_cmp_ge_u32 s63, 96
    s_cbranch_scc1 pre_ln
    s_load_dwordx4 s[4:7], s[0:1], 88
    s_lshl_b32 s59, s54, 6
    v_add_u32 v64, s59, v0
    v_and_b32 v1, 3, v64
    v_lshrrev_b32 v2, 2, v64
    v_lshlrev_b32_e64 v3, 4, v2
    s_mov_b32 s59, 49152
    v_mul_lo_u32 v8, v2, s59
    s_lshl_b32 s59, s63, 6
    v_lshl_add_u32 v8, v1, 4, v8
    v_add_u32 v8, s59, v8
    s_waitcnt lgkmcnt(0)
    s_mov_b32 s32, s4
    s_and_b32 s33, s5, 0xffff
    s_mov_b32 s34, 1024
    s_mov_b32 s35, 0x00020000
    s_mov_b32 s36, s6
    s_and_b32 s37, s7, 0xffff
    s_mov_b32 s38, 3145728
    s_mov_b32 s39, 0x00020000
    buffer_load_dwordx4 v[4:7], v3, s[32:35], 0 offen
    s_mov_b32 s59, 0
    buffer_load_dwordx4 v[16:19], v8, s[36:39], s59 offen
    s_mov_b32 s59, 6144
    buffer_load_dwordx4 v[20:23], v8, s[36:39], s59 offen
    s_mov_b32 s59, 12288
    buffer_load_dwordx4 v[24:27], v8, s[36:39], s59 offen
    s_mov_b32 s59, 18432
    buffer_load_dwordx4 v[28:31], v8, s[36:39], s59 offen
    s_mov_b32 s59, 24576
    buffer_load_dwordx4 v[32:35], v8, s[36:39], s59 offen
    s_mov_b32 s59, 30720
    buffer_load_dwordx4 v[36:39], v8, s[36:39], s59 offen
    s_mov_b32 s59, 36864
    buffer_load_dwordx4 v[40:43], v8, s[36:39], s59 offen
    s_mov_b32 s59, 43008
    buffer_load_dwordx4 v[44:47], v8, s[36:39], s59 offen
    s_waitcnt vmcnt(8)
    v_lshlrev_b32 v48, 16, v4
    v_and_b32 v49, 0xffff0000, v4
    v_lshlrev_b32_e64 v50, 16, v5
    v_and_b32 v51, 0xffff0000, v5
    v_lshlrev_b32_e64 v52, 16, v6
    v_and_b32 v53, 0xffff0000, v6
    v_lshlrev_b32_e64 v54, 16, v7
    v_and_b32 v55, 0xffff0000, v7
    v_mul_f32 v56, 0xbfb8aa3b, v48
    v_mul_f32 v57, 0xbfb8aa3b, v49
    v_mul_f32 v58, 0xbfb8aa3b, v50
    v_mul_f32 v59, 0xbfb8aa3b, v51
    v_mul_f32 v60, 0xbfb8aa3b, v52
    v_mul_f32 v61, 0xbfb8aa3b, v53
    v_mul_f32 v62, 0xbfb8aa3b, v54
    v_mul_f32 v63, 0xbfb8aa3b, v55
    v_exp_f32 v56, v56
    v_exp_f32 v57, v57
    v_exp_f32 v58, v58
    v_exp_f32 v59, v59
    v_exp_f32 v60, v60
    v_exp_f32 v61, v61
    v_exp_f32 v62, v62
    v_exp_f32 v63, v63
    v_add_f32 v56, 1.0, v56
    v_add_f32 v57, 1.0, v57
    v_add_f32 v58, 1.0, v58
    v_add_f32 v59, 1.0, v59
    v_add_f32 v60, 1.0, v60
    v_add_f32 v61, 1.0, v61
    v_add_f32 v62, 1.0, v62
    v_add_f32 v63, 1.0, v63
    v_rcp_f32 v56, v56
    v_rcp_f32 v57, v57
    v_rcp_f32 v58, v58
    v_rcp_f32 v59, v59
    v_rcp_f32 v60, v60
    v_rcp_f32 v61, v61
    v_rcp_f32 v62, v62
    v_rcp_f32 v63, v63
    v_mul_f32 v48, v48, v56
    v_mul_f32 v49, v49, v57
    v_mul_f32 v50, v50, v58
    v_mul_f32 v51, v51, v59
    v_mul_f32 v52, v52, v60
    v_mul_f32 v53, v53, v61
    v_mul_f32 v54, v54, v62
    v_mul_f32 v55, v55, v63
    v_cvt_pk_bf16_f32 v56, v48, v49
    v_lshlrev_b32_e64 v48, 16, v56
    v_and_b32 v49, 0xffff0000, v56
    v_cvt_pk_bf16_f32 v56, v50, v51
    v_lshlrev_b32_e64 v50, 16, v56
    v_and_b32 v51, 0xffff0000, v56
    v_cvt_pk_bf16_f32 v56, v52, v53
    v_lshlrev_b32_e64 v52, 16, v56
    v_and_b32 v53, 0xffff0000, v56
    v_cvt_pk_bf16_f32 v56, v54, v55
    v_lshlrev_b32_e64 v54, 16, v56
    v_and_b32 v55, 0xffff0000, v56
    s_waitcnt vmcnt(0)
    v_lshlrev_b32 v10, 16, v16
    v_and_b32 v11, 0xffff0000, v16
    v_mul_f32 v56, v48, v10
    v_mul_f32 v57, v48, v11
    v_lshlrev_b32_e64 v10, 16, v17
    v_and_b32 v11, 0xffff0000, v17
    v_mul_f32 v58, v48, v10
    v_mul_f32 v59, v48, v11
    v_lshlrev_b32_e64 v10, 16, v18
    v_and_b32 v11, 0xffff0000, v18
    v_mul_f32 v60, v48, v10
    v_mul_f32 v61, v48, v11
    v_lshlrev_b32_e64 v10, 16, v19
    v_and_b32 v11, 0xffff0000, v19
    v_mul_f32 v62, v48, v10
    v_mul_f32 v63, v48, v11
    v_lshlrev_b32_e64 v10, 16, v20
    v_and_b32 v11, 0xffff0000, v20
    v_fmac_f32 v56, v49, v10
    v_fmac_f32 v57, v49, v11
    v_lshlrev_b32_e64 v10, 16, v21
    v_and_b32 v11, 0xffff0000, v21
    v_fmac_f32 v58, v49, v10
    v_fmac_f32 v59, v49, v11
    v_lshlrev_b32_e64 v10, 16, v22
    v_and_b32 v11, 0xffff0000, v22
    v_fmac_f32 v60, v49, v10
    v_fmac_f32 v61, v49, v11
    v_lshlrev_b32_e64 v10, 16, v23
    v_and_b32 v11, 0xffff0000, v23
    v_fmac_f32 v62, v49, v10
    v_fmac_f32 v63, v49, v11
    v_lshlrev_b32_e64 v10, 16, v24
    v_and_b32 v11, 0xffff0000, v24
    v_fmac_f32 v56, v50, v10
    v_fmac_f32 v57, v50, v11
    v_lshlrev_b32_e64 v10, 16, v25
    v_and_b32 v11, 0xffff0000, v25
    v_fmac_f32 v58, v50, v10
    v_fmac_f32 v59, v50, v11
    v_lshlrev_b32_e64 v10, 16, v26
    v_and_b32 v11, 0xffff0000, v26
    v_fmac_f32 v60, v50, v10
    v_fmac_f32 v61, v50, v11
    v_lshlrev_b32_e64 v10, 16, v27
    v_and_b32 v11, 0xffff0000, v27
    v_fmac_f32 v62, v50, v10
    v_fmac_f32 v63, v50, v11
    v_lshlrev_b32_e64 v10, 16, v28
    v_and_b32 v11, 0xffff0000, v28
    v_fmac_f32 v56, v51, v10
    v_fmac_f32 v57, v51, v11
    v_lshlrev_b32_e64 v10, 16, v29
    v_and_b32 v11, 0xffff0000, v29
    v_fmac_f32 v58, v51, v10
    v_fmac_f32 v59, v51, v11
    v_lshlrev_b32_e64 v10, 16, v30
    v_and_b32 v11, 0xffff0000, v30
    v_fmac_f32 v60, v51, v10
    v_fmac_f32 v61, v51, v11
    v_lshlrev_b32_e64 v10, 16, v31
    v_and_b32 v11, 0xffff0000, v31
    v_fmac_f32 v62, v51, v10
    v_fmac_f32 v63, v51, v11
    v_lshlrev_b32_e64 v10, 16, v32
    v_and_b32 v11, 0xffff0000, v32
    v_fmac_f32 v56, v52, v10
    v_fmac_f32 v57, v52, v11
    v_lshlrev_b32_e64 v10, 16, v33
    v_and_b32 v11, 0xffff0000, v33
    v_fmac_f32 v58, v52, v10
    v_fmac_f32 v59, v52, v11
    v_lshlrev_b32_e64 v10, 16, v34
    v_and_b32 v11, 0xffff0000, v34
    v_fmac_f32 v60, v52, v10
    v_fmac_f32 v61, v52, v11
    v_lshlrev_b32_e64 v10, 16, v35
    v_and_b32 v11, 0xffff0000, v35
    v_fmac_f32 v62, v52, v10
    v_fmac_f32 v63, v52, v11
    v_lshlrev_b32_e64 v10, 16, v36
    v_and_b32 v11, 0xffff0000, v36
    v_fmac_f32 v56, v53, v10
    v_fmac_f32 v57, v53, v11
    v_lshlrev_b32_e64 v10, 16, v37
    v_and_b32 v11, 0xffff0000, v37
    v_fmac_f32 v58, v53, v10
    v_fmac_f32 v59, v53, v11
    v_lshlrev_b32_e64 v10, 16, v38
    v_and_b32 v11, 0xffff0000, v38
    v_fmac_f32 v60, v53, v10
    v_fmac_f32 v61, v53, v11
    v_lshlrev_b32_e64 v10, 16, v39
    v_and_b32 v11, 0xffff0000, v39
    v_fmac_f32 v62, v53, v10
    v_fmac_f32 v63, v53, v11
    v_lshlrev_b32_e64 v10, 16, v40
    v_and_b32 v11, 0xffff0000, v40
    v_fmac_f32 v56, v54, v10
    v_fmac_f32 v57, v54, v11
    v_lshlrev_b32_e64 v10, 16, v41
    v_and_b32 v11, 0xffff0000, v41
    v_fmac_f32 v58, v54, v10
    v_fmac_f32 v59, v54, v11
    v_lshlrev_b32_e64 v10, 16, v42
    v_and_b32 v11, 0xffff0000, v42
    v_fmac_f32 v60, v54, v10
    v_fmac_f32 v61, v54, v11
    v_lshlrev_b32_e64 v10, 16, v43
    v_and_b32 v11, 0xffff0000, v43
    v_fmac_f32 v62, v54, v10
    v_fmac_f32 v63, v54, v11
    v_lshlrev_b32_e64 v10, 16, v44
    v_and_b32 v11, 0xffff0000, v44
    v_fmac_f32 v56, v55, v10
    v_fmac_f32 v57, v55, v11
    v_lshlrev_b32_e64 v10, 16, v45
    v_and_b32 v11, 0xffff0000, v45
    v_fmac_f32 v58, v55, v10
    v_fmac_f32 v59, v55, v11
    v_lshlrev_b32_e64 v10, 16, v46
    v_and_b32 v11, 0xffff0000, v46
    v_fmac_f32 v60, v55, v10
    v_fmac_f32 v61, v55, v11
    v_lshlrev_b32_e64 v10, 16, v47
    v_and_b32 v11, 0xffff0000, v47
    v_fmac_f32 v62, v55, v10
    v_fmac_f32 v63, v55, v11
    v_lshlrev_b32_e64 v9, 5, v64
    ds_write_b128 v9, v[56:59]
    ds_write_b128 v9, v[60:63] offset:16
    s_waitcnt lgkmcnt(0)
    s_barrier
    v_and_b32 v1, 31, v64
    v_lshrrev_b32 v2, 5, v64
    v_lshlrev_b32_e64 v9, 10, v2
    v_lshl_add_u32 v9, v1, 2, v9
    ds_read_b32 v16, v9 offset:0
    ds_read_b32 v17, v9 offset:128
    ds_read_b32 v18, v9 offset:256
    ds_read_b32 v19, v9 offset:384
    ds_read_b32 v20, v9 offset:512
    ds_read_b32 v21, v9 offset:640
    ds_read_b32 v22, v9 offset:768
    ds_read_b32 v23, v9 offset:896
    s_waitcnt lgkmcnt(0)
    v_add_f32 v16, v16, v17
    v_add_f32 v16, v16, v18
    v_add_f32 v16, v16, v19
    v_add_f32 v16, v16, v20
    v_add_f32 v16, v16, v21
    v_add_f32 v16, v16, v22
    v_add_f32 v16, v16, v23
    v_lshlrev_b32_e64 v9, 2, v64
    ds_write_b32 v9, v16 offset:8192
    s_waitcnt lgkmcnt(0)
    s_barrier
    v_lshlrev_b32_e64 v9, 2, v1
    ds_read_b32 v16, v9 offset:8192
    ds_read_b32 v17, v9 offset:8320
    ds_read_b32 v18, v9 offset:8448
    ds_read_b32 v19, v9 offset:8576
    ds_read_b32 v20, v9 offset:8704
    ds_read_b32 v21, v9 offset:8832
    ds_read_b32 v22, v9 offset:8960
    ds_read_b32 v23, v9 offset:9088
    s_waitcnt lgkmcnt(0)
    v_add_f32 v16, v16, v17
    v_add_f32 v16, v16, v18
    v_add_f32 v16, v16, v19
    v_add_f32 v16, v16, v20
    v_add_f32 v16, v16, v21
    v_add_f32 v16, v16, v22
    v_add_f32 v16, v16, v23
    v_cvt_pk_bf16_f32 v17, v16, v16
    v_lshlrev_b32 v16, 16, v17
    s_lshr_b32 s59, s63, 4
    s_cmp_eq_u32 s59, 1
    s_cbranch_scc1 mod_p1
    s_cmp_eq_u32 s59, 4
    s_cbranch_scc0 mod_st
mod_p1:
    v_add_f32_e64 v16, 1.0, v16
    v_cvt_pk_bf16_f32 v17, v16, v16
    v_lshlrev_b32 v16, 16, v17
mod_st:
    s_lshl_b32 s59, s63, 7
    s_add_u32 s59, s59, 65536
    s_cmp_lg_u32 s54, 0
    s_cbranch_scc1 mod_ns
    buffer_store_dword v16, v9, s[24:27], s59 offen sc1
    s_cmp_ge_u32 s63, 32
    s_cbranch_scc1 mod_ns
    s_waitcnt vmcnt(0)
    v_mov_b32 v124, 1
    s_mov_b32 s60, 96
    s_mov_b64 exec, 1
    buffer_atomic_add v124, off, s[28:31], s60 sc0
    s_mov_b64 exec, -1
    s_waitcnt vmcnt(0)
    v_readfirstlane_b32 s59, v124
    s_nop 0
    s_cmp_lg_u32 s59, 31
    s_cbranch_scc1 moda_na
    v_min_u32 v126, 7, v0
    v_lshlrev_b32_e64 v126, 2, v126
    v_add_u32 v125, 144, v126
    v_cmp_eq_u32 vcc, 0, v126
    s_nop 1
    v_cndmask_b32_e64 v126, v125, v126, vcc
moda_tk:
    buffer_load_dword v127, v126, s[28:31], 0 offen sc1
    s_add_u32 s52, s52, 1
    s_cmp_gt_u32 s52, 4194304
    s_waitcnt vmcnt(0)
    v_and_b32 v127, 0xffff, v127
    v_cmp_gt_u32 vcc, 32, v127
    s_cbranch_scc1 moda_tg
    s_cbranch_vccnz moda_tk
moda_tg:
    v_lshlrev_b32 v126, 7, v0
    v_mov_b32_e64 v127, 1
    s_mov_b32 s60, 98304
    buffer_store_dword v127, v126, s[24:27], s60 offen sc1
    s_mov_b32 s60, 106496
    buffer_store_dword v127, v126, s[24:27], s60 offen sc1
    s_mov_b32 s60, 114688
    buffer_store_dword v127, v126, s[24:27], s60 offen sc1
    s_mov_b32 s60, 122880
    buffer_store_dword v127, v126, s[24:27], s60 offen sc1
moda_na:
mod_ns:
pre_ln:
    s_load_dwordx2 s[4:5], s[0:1], 0
    v_and_b32 v1, 15, v0
    v_lshrrev_b32 v2, 4, v0
    v_lshlrev_b32_e64 v4, 10, v1
    v_lshl_add_u32 v4, v2, 4, v4
    s_lshl_b32 s59, s54, 8
    v_add_u32 v4, s59, v4
    v_lshlrev_b32 v5, 5, v2
    s_lshl_b32 s59, s54, 9
    v_add_u32 v5, s59, v5
    v_lshlrev_b32 v8, 2, v1
    v_add_u32 v8, 162816, v8
    s_lshl_b32 s59, s54, 6
    v_add_u32 v9, s59, v8
    v_lshlrev_b32_e64 v3, 4, v0
    s_waitcnt lgkmcnt(0)
    s_mov_b32 s32, s4
    s_and_b32 s33, s5, 0xffff
    s_mov_b32 s34, 2097152
    s_mov_b32 s35, 0x00020000
    s_lshl_b32 s61, s63, 14
    buffer_load_dwordx4 v[16:19], v4, s[32:35], s61 offen offset:0
    buffer_load_dwordx4 v[20:23], v4, s[32:35], s61 offen offset:64
    buffer_load_dwordx4 v[24:27], v4, s[32:35], s61 offen offset:128
    buffer_load_dwordx4 v[28:31], v4, s[32:35], s61 offen offset:192
    s_waitcnt vmcnt(0)
    v_lshlrev_b32_e64 v32, 16, v16
    v_and_b32 v33, 0xffff0000, v16
    v_lshlrev_b32_e64 v34, 16, v17
    v_and_b32 v35, 0xffff0000, v17
    v_lshlrev_b32_e64 v36, 16, v18
    v_and_b32 v37, 0xffff0000, v18
    v_lshlrev_b32_e64 v38, 16, v19
    v_and_b32 v39, 0xffff0000, v19
    v_lshlrev_b32_e64 v40, 16, v20
    v_and_b32 v41, 0xffff0000, v20
    v_lshlrev_b32_e64 v42, 16, v21
    v_and_b32 v43, 0xffff0000, v21
    v_lshlrev_b32_e64 v44, 16, v22
    v_and_b32 v45, 0xffff0000, v22
    v_lshlrev_b32_e64 v46, 16, v23
    v_and_b32 v47, 0xffff0000, v23
    v_lshlrev_b32_e64 v48, 16, v24
    v_and_b32 v49, 0xffff0000, v24
    v_lshlrev_b32_e64 v50, 16, v25
    v_and_b32 v51, 0xffff0000, v25
    v_lshlrev_b32_e64 v52, 16, v26
    v_and_b32 v53, 0xffff0000, v26
    v_lshlrev_b32_e64 v54, 16, v27
    v_and_b32 v55, 0xffff0000, v27
    v_lshlrev_b32_e64 v56, 16, v28
    v_and_b32 v57, 0xffff0000, v28
    v_lshlrev_b32_e64 v58, 16, v29
    v_and_b32 v59, 0xffff0000, v29
    v_lshlrev_b32_e64 v60, 16, v30
    v_and_b32 v61, 0xffff0000, v30
    v_lshlrev_b32_e64 v62, 16, v31
    v_and_b32 v63, 0xffff0000, v31
    v_add_f32 v6, v32, v33
    v_add_f32 v7, v34, v35
    v_add_f32 v6, v6, v36
    v_add_f32 v7, v7, v37
    v_add_f32 v6, v6, v38
    v_add_f32 v7, v7, v39
    v_add_f32 v6, v6, v40
    v_add_f32 v7, v7, v41
    v_add_f32 v6, v6, v42
    v_add_f32 v7, v7, v43
    v_add_f32 v6, v6, v44
    v_add_f32 v7, v7, v45
    v_add_f32 v6, v6, v46
    v_add_f32 v7, v7, v47
    v_add_f32 v6, v6, v48
    v_add_f32 v7, v7, v49
    v_add_f32 v6, v6, v50
    v_add_f32 v7, v7, v51
    v_add_f32 v6, v6, v52
    v_add_f32 v7, v7, v53
    v_add_f32 v6, v6, v54
    v_add_f32 v7, v7, v55
    v_add_f32 v6, v6, v56
    v_add_f32 v7, v7, v57
    v_add_f32 v6, v6, v58
    v_add_f32 v7, v7, v59
    v_add_f32 v6, v6, v60
    v_add_f32 v7, v7, v61
    v_add_f32 v6, v6, v62
    v_add_f32 v7, v7, v63
    v_add_f32 v6, v6, v7
    v_mov_b32 v7, v6
    s_nop 1
    v_permlane16_swap_b32 v7, v6
    v_add_f32 v6, v7, v6
    v_mov_b32 v7, v6
    s_nop 1
    v_permlane32_swap_b32 v7, v6
    v_add_f32_e64 v6, v7, v6
    ds_write_b32 v9, v6
    s_waitcnt lgkmcnt(0)
    s_barrier
    ds_read_b32 v10, v8 offset:0
    ds_read_b32 v11, v8 offset:64
    ds_read_b32 v12, v8 offset:128
    ds_read_b32 v13, v8 offset:192
    s_waitcnt lgkmcnt(0)
    v_add_f32 v10, v10, v11
    v_add_f32 v12, v12, v13
    v_add_f32 v10, v10, v12
    v_mul_f32 v10, 0x3b000000, v10
    v_sub_f32 v11, v32, v10
    v_mul_f32 v6, v11, v11
    v_sub_f32 v12, v33, v10
    v_mul_f32 v7, v12, v12
    v_sub_f32 v11, v34, v10
    v_sub_f32 v12, v35, v10
    v_fmac_f32 v6, v11, v11
    v_fmac_f32 v7, v12, v12
    v_sub_f32 v11, v36, v10
    v_sub_f32 v12, v37, v10
    v_fmac_f32 v6, v11, v11
    v_fmac_f32 v7, v12, v12
    v_sub_f32 v11, v38, v10
    v_sub_f32 v12, v39, v10
    v_fmac_f32 v6, v11, v11
    v_fmac_f32 v7, v12, v12
    v_sub_f32 v11, v40, v10
    v_sub_f32 v12, v41, v10
    v_fmac_f32 v6, v11, v11
    v_fmac_f32 v7, v12, v12
    v_sub_f32 v11, v42, v10
    v_sub_f32 v12, v43, v10
    v_fmac_f32 v6, v11, v11
    v_fmac_f32 v7, v12, v12
    v_sub_f32 v11, v44, v10
    v_sub_f32 v12, v45, v10
    v_fmac_f32 v6, v11, v11
    v_fmac_f32 v7, v12, v12
    v_sub_f32 v11, v46, v10
    v_sub_f32 v12, v47, v10
    v_fmac_f32 v6, v11, v11
    v_fmac_f32 v7, v12, v12
    v_sub_f32 v11, v48, v10
    v_sub_f32 v12, v49, v10
    v_fmac_f32 v6, v11, v11
    v_fmac_f32 v7, v12, v12
    v_sub_f32 v11, v50, v10
    v_sub_f32 v12, v51, v10
    v_fmac_f32 v6, v11, v11
    v_fmac_f32 v7, v12, v12
    v_sub_f32 v11, v52, v10
    v_sub_f32 v12, v53, v10
    v_fmac_f32 v6, v11, v11
    v_fmac_f32 v7, v12, v12
    v_sub_f32 v11, v54, v10
    v_sub_f32 v12, v55, v10
    v_fmac_f32 v6, v11, v11
    v_fmac_f32 v7, v12, v12
    v_sub_f32 v11, v56, v10
    v_sub_f32 v12, v57, v10
    v_fmac_f32 v6, v11, v11
    v_fmac_f32 v7, v12, v12
    v_sub_f32 v11, v58, v10
    v_sub_f32 v12, v59, v10
    v_fmac_f32 v6, v11, v11
    v_fmac_f32 v7, v12, v12
    v_sub_f32 v11, v60, v10
    v_sub_f32 v12, v61, v10
    v_fmac_f32 v6, v11, v11
    v_fmac_f32 v7, v12, v12
    v_sub_f32 v11, v62, v10
    v_sub_f32 v12, v63, v10
    v_fmac_f32 v6, v11, v11
    v_fmac_f32 v7, v12, v12
    v_add_f32 v6, v6, v7
    v_mov_b32 v7, v6
    s_nop 1
    v_permlane16_swap_b32 v7, v6
    v_add_f32 v6, v7, v6
    v_mov_b32 v7, v6
    s_nop 1
    v_permlane32_swap_b32 v7, v6
    v_add_f32_e64 v6, v7, v6
    ds_write_b32 v9, v6 offset:256
    s_waitcnt lgkmcnt(0)
    s_barrier
    ds_read_b32 v11, v8 offset:256
    ds_read_b32 v12, v8 offset:320
    ds_read_b32 v13, v8 offset:384
    ds_read_b32 v14, v8 offset:448
    s_waitcnt lgkmcnt(0)
    v_add_f32 v11, v11, v12
    v_add_f32 v13, v13, v14
    v_add_f32 v11, v11, v13
    v_mul_f32 v11, 0x3b000000, v11
    v_cvt_pk_bf16_f32 v12, v10, v11
    v_lshlrev_b32_e64 v10, 16, v12
    v_and_b32 v11, 0xffff0000, v12
    v_add_f32 v11, 0x3727c5ac, v11
    v_cvt_pk_bf16_f32 v12, v11, v11
    v_lshlrev_b32 v11, 16, v12
    v_sqrt_f32_e64 v11, v11
    s_nop 0
    v_cvt_pk_bf16_f32 v12, v11, v11
    v_lshlrev_b32 v11, 16, v12
    v_rcp_f32 v11, v11
    s_cmp_lg_u32 s54, 0
    s_cbranch_scc1 ln1m_ok
ln1m_w:
    buffer_load_dword v127, off, s[24:27], s3 offset:0 sc1
    s_add_u32 s52, s52, 1
    s_waitcnt vmcnt(0)
    v_readfirstlane_b32 s59, v127
    s_nop 0
    s_cmp_ge_u32 s59, 1
    s_cbranch_scc1 ln1m_ok
    s_cmp_gt_u32 s52, 4194304
    s_cbranch_scc1 ln1m_ok
    s_sleep 1
    s_branch ln1m_w
ln1m_ok:
    s_barrier
    s_mov_b32 s59, 67584
    s_mov_b32 s60, 65536
    buffer_load_dwordx4 v[64:67], v5, s[24:27], s59 offen offset:0 sc1
    buffer_load_dwordx4 v[96:99], v5, s[24:27], s60 offen offset:0 sc1
    buffer_load_dwordx4 v[68:71], v5, s[24:27], s59 offen offset:16 sc1
    buffer_load_dwordx4 v[100:103], v5, s[24:27], s60 offen offset:16 sc1
    buffer_load_dwordx4 v[72:75], v5, s[24:27], s59 offen offset:128 sc1
    buffer_load_dwordx4 v[104:107], v5, s[24:27], s60 offen offset:128 sc1
    buffer_load_dwordx4 v[76:79], v5, s[24:27], s59 offen offset:144 sc1
    buffer_load_dwordx4 v[108:111], v5, s[24:27], s60 offen offset:144 sc1
    buffer_load_dwordx4 v[80:83], v5, s[24:27], s59 offen offset:256 sc1
    buffer_load_dwordx4 v[112:115], v5, s[24:27], s60 offen offset:256 sc1
    buffer_load_dwordx4 v[84:87], v5, s[24:27], s59 offen offset:272 sc1
    buffer_load_dwordx4 v[116:119], v5, s[24:27], s60 offen offset:272 sc1
    buffer_load_dwordx4 v[88:91], v5, s[24:27], s59 offen offset:384 sc1
    buffer_load_dwordx4 v[120:123], v5, s[24:27], s60 offen offset:384 sc1
    buffer_load_dwordx4 v[92:95], v5, s[24:27], s59 offen offset:400 sc1
    buffer_load_dwordx4 v[124:127], v5, s[24:27], s60 offen offset:400 sc1
    s_waitcnt vmcnt(0)
    v_sub_f32 v32, v32, v10
    v_sub_f32_e64 v33, v33, v10
    v_cvt_pk_bf16_f32 v12, v32, v33
    v_lshlrev_b32_e64 v32, 16, v12
    v_and_b32 v33, 0xffff0000, v12
    v_mul_f32 v32, v32, v11
    v_mul_f32 v33, v33, v11
    v_cvt_pk_bf16_f32 v12, v32, v33
    v_lshlrev_b32_e64 v32, 16, v12
    v_and_b32 v33, 0xffff0000, v12
    v_mul_f32 v32, v32, v64
    v_mul_f32 v33, v33, v65
    v_cvt_pk_bf16_f32 v12, v32, v33
    v_lshlrev_b32_e64 v32, 16, v12
    v_and_b32 v33, 0xffff0000, v12
    v_add_f32 v32, v32, v96
    v_add_f32 v33, v33, v97
    v_cvt_pk_bf16_f32 v16, v32, v33
    v_sub_f32 v34, v34, v10
    v_sub_f32 v35, v35, v10
    v_cvt_pk_bf16_f32 v12, v34, v35
    v_lshlrev_b32_e64 v34, 16, v12
    v_and_b32 v35, 0xffff0000, v12
    v_mul_f32 v34, v34, v11
    v_mul_f32 v35, v35, v11
    v_cvt_pk_bf16_f32 v12, v34, v35
    v_lshlrev_b32_e64 v34, 16, v12
    v_and_b32 v35, 0xffff0000, v12
    v_mul_f32 v34, v34, v66
    v_mul_f32 v35, v35, v67
    v_cvt_pk_bf16_f32 v12, v34, v35
    v_lshlrev_b32_e64 v34, 16, v12
    v_and_b32 v35, 0xffff0000, v12
    v_add_f32 v34, v34, v98
    v_add_f32 v35, v35, v99
    v_cvt_pk_bf16_f32 v18, v34, v35
    v_sub_f32 v36, v36, v10
    v_sub_f32 v37, v37, v10
    v_cvt_pk_bf16_f32 v12, v36, v37
    v_lshlrev_b32_e64 v36, 16, v12
    v_and_b32 v37, 0xffff0000, v12
    v_mul_f32 v36, v36, v11
    v_mul_f32 v37, v37, v11
    v_cvt_pk_bf16_f32 v12, v36, v37
    v_lshlrev_b32_e64 v36, 16, v12
    v_and_b32 v37, 0xffff0000, v12
    v_mul_f32 v36, v36, v68
    v_mul_f32 v37, v37, v69
    v_cvt_pk_bf16_f32 v12, v36, v37
    v_lshlrev_b32_e64 v36, 16, v12
    v_and_b32 v37, 0xffff0000, v12
    v_add_f32 v36, v36, v100
    v_add_f32 v37, v37, v101
    v_cvt_pk_bf16_f32 v17, v36, v37
    v_sub_f32 v38, v38, v10
    v_sub_f32 v39, v39, v10
    v_cvt_pk_bf16_f32 v12, v38, v39
    v_lshlrev_b32_e64 v38, 16, v12
    v_and_b32 v39, 0xffff0000, v12
    v_mul_f32 v38, v38, v11
    v_mul_f32 v39, v39, v11
    v_cvt_pk_bf16_f32 v12, v38, v39
    v_lshlrev_b32_e64 v38, 16, v12
    v_and_b32 v39, 0xffff0000, v12
    v_mul_f32 v38, v38, v70
    v_mul_f32 v39, v39, v71
    v_cvt_pk_bf16_f32 v12, v38, v39
    v_lshlrev_b32_e64 v38, 16, v12
    v_and_b32 v39, 0xffff0000, v12
    v_add_f32 v38, v38, v102
    v_add_f32 v39, v39, v103
    v_cvt_pk_bf16_f32 v19, v38, v39
    v_sub_f32 v40, v40, v10
    v_sub_f32 v41, v41, v10
    v_cvt_pk_bf16_f32 v12, v40, v41
    v_lshlrev_b32_e64 v40, 16, v12
    v_and_b32 v41, 0xffff0000, v12
    v_mul_f32 v40, v40, v11
    v_mul_f32 v41, v41, v11
    v_cvt_pk_bf16_f32 v12, v40, v41
    v_lshlrev_b32_e64 v40, 16, v12
    v_and_b32 v41, 0xffff0000, v12
    v_mul_f32 v40, v40, v72
    v_mul_f32 v41, v41, v73
    v_cvt_pk_bf16_f32 v12, v40, v41
    v_lshlrev_b32_e64 v40, 16, v12
    v_and_b32 v41, 0xffff0000, v12
    v_add_f32 v40, v40, v104
    v_add_f32 v41, v41, v105
    v_cvt_pk_bf16_f32 v20, v40, v41
    v_sub_f32 v42, v42, v10
    v_sub_f32 v43, v43, v10
    v_cvt_pk_bf16_f32 v12, v42, v43
    v_lshlrev_b32_e64 v42, 16, v12
    v_and_b32 v43, 0xffff0000, v12
    v_mul_f32 v42, v42, v11
    v_mul_f32 v43, v43, v11
    v_cvt_pk_bf16_f32 v12, v42, v43
    v_lshlrev_b32_e64 v42, 16, v12
    v_and_b32 v43, 0xffff0000, v12
    v_mul_f32 v42, v42, v74
    v_mul_f32 v43, v43, v75
    v_cvt_pk_bf16_f32 v12, v42, v43
    v_lshlrev_b32_e64 v42, 16, v12
    v_and_b32 v43, 0xffff0000, v12
    v_add_f32 v42, v42, v106
    v_add_f32 v43, v43, v107
    v_cvt_pk_bf16_f32 v22, v42, v43
    v_sub_f32 v44, v44, v10
    v_sub_f32 v45, v45, v10
    v_cvt_pk_bf16_f32 v12, v44, v45
    v_lshlrev_b32_e64 v44, 16, v12
    v_and_b32 v45, 0xffff0000, v12
    v_mul_f32 v44, v44, v11
    v_mul_f32 v45, v45, v11
    v_cvt_pk_bf16_f32 v12, v44, v45
    v_lshlrev_b32_e64 v44, 16, v12
    v_and_b32 v45, 0xffff0000, v12
    v_mul_f32 v44, v44, v76
    v_mul_f32 v45, v45, v77
    v_cvt_pk_bf16_f32 v12, v44, v45
    v_lshlrev_b32_e64 v44, 16, v12
    v_and_b32 v45, 0xffff0000, v12
    v_add_f32 v44, v44, v108
    v_add_f32 v45, v45, v109
    v_cvt_pk_bf16_f32 v21, v44, v45
    v_sub_f32 v46, v46, v10
    v_sub_f32 v47, v47, v10
    v_cvt_pk_bf16_f32 v12, v46, v47
    v_lshlrev_b32_e64 v46, 16, v12
    v_and_b32 v47, 0xffff0000, v12
    v_mul_f32 v46, v46, v11
    v_mul_f32 v47, v47, v11
    v_cvt_pk_bf16_f32 v12, v46, v47
    v_lshlrev_b32_e64 v46, 16, v12
    v_and_b32 v47, 0xffff0000, v12
    v_mul_f32 v46, v46, v78
    v_mul_f32 v47, v47, v79
    v_cvt_pk_bf16_f32 v12, v46, v47
    v_lshlrev_b32_e64 v46, 16, v12
    v_and_b32 v47, 0xffff0000, v12
    v_add_f32 v46, v46, v110
    v_add_f32 v47, v47, v111
    v_cvt_pk_bf16_f32 v23, v46, v47
    v_sub_f32 v48, v48, v10
    v_sub_f32 v49, v49, v10
    v_cvt_pk_bf16_f32 v12, v48, v49
    v_lshlrev_b32_e64 v48, 16, v12
    v_and_b32 v49, 0xffff0000, v12
    v_mul_f32 v48, v48, v11
    v_mul_f32 v49, v49, v11
    v_cvt_pk_bf16_f32 v12, v48, v49
    v_lshlrev_b32_e64 v48, 16, v12
    v_and_b32 v49, 0xffff0000, v12
    v_mul_f32 v48, v48, v80
    v_mul_f32 v49, v49, v81
    v_cvt_pk_bf16_f32 v12, v48, v49
    v_lshlrev_b32_e64 v48, 16, v12
    v_and_b32 v49, 0xffff0000, v12
    v_add_f32 v48, v48, v112
    v_add_f32 v49, v49, v113
    v_cvt_pk_bf16_f32 v24, v48, v49
    v_sub_f32 v50, v50, v10
    v_sub_f32 v51, v51, v10
    v_cvt_pk_bf16_f32 v12, v50, v51
    v_lshlrev_b32_e64 v50, 16, v12
    v_and_b32 v51, 0xffff0000, v12
    v_mul_f32 v50, v50, v11
    v_mul_f32 v51, v51, v11
    v_cvt_pk_bf16_f32 v12, v50, v51
    v_lshlrev_b32_e64 v50, 16, v12
    v_and_b32 v51, 0xffff0000, v12
    v_mul_f32 v50, v50, v82
    v_mul_f32 v51, v51, v83
    v_cvt_pk_bf16_f32 v12, v50, v51
    v_lshlrev_b32_e64 v50, 16, v12
    v_and_b32 v51, 0xffff0000, v12
    v_add_f32 v50, v50, v114
    v_add_f32 v51, v51, v115
    v_cvt_pk_bf16_f32 v26, v50, v51
    v_sub_f32 v52, v52, v10
    v_sub_f32 v53, v53, v10
    v_cvt_pk_bf16_f32 v12, v52, v53
    v_lshlrev_b32_e64 v52, 16, v12
    v_and_b32 v53, 0xffff0000, v12
    v_mul_f32 v52, v52, v11
    v_mul_f32 v53, v53, v11
    v_cvt_pk_bf16_f32 v12, v52, v53
    v_lshlrev_b32_e64 v52, 16, v12
    v_and_b32 v53, 0xffff0000, v12
    v_mul_f32 v52, v52, v84
    v_mul_f32 v53, v53, v85
    v_cvt_pk_bf16_f32 v12, v52, v53
    v_lshlrev_b32_e64 v52, 16, v12
    v_and_b32 v53, 0xffff0000, v12
    v_add_f32 v52, v52, v116
    v_add_f32 v53, v53, v117
    v_cvt_pk_bf16_f32 v25, v52, v53
    v_sub_f32 v54, v54, v10
    v_sub_f32 v55, v55, v10
    v_cvt_pk_bf16_f32 v12, v54, v55
    v_lshlrev_b32_e64 v54, 16, v12
    v_and_b32 v55, 0xffff0000, v12
    v_mul_f32 v54, v54, v11
    v_mul_f32 v55, v55, v11
    v_cvt_pk_bf16_f32 v12, v54, v55
    v_lshlrev_b32_e64 v54, 16, v12
    v_and_b32 v55, 0xffff0000, v12
    v_mul_f32 v54, v54, v86
    v_mul_f32 v55, v55, v87
    v_cvt_pk_bf16_f32 v12, v54, v55
    v_lshlrev_b32_e64 v54, 16, v12
    v_and_b32 v55, 0xffff0000, v12
    v_add_f32 v54, v54, v118
    v_add_f32 v55, v55, v119
    v_cvt_pk_bf16_f32 v27, v54, v55
    v_sub_f32 v56, v56, v10
    v_sub_f32 v57, v57, v10
    v_cvt_pk_bf16_f32 v12, v56, v57
    v_lshlrev_b32_e64 v56, 16, v12
    v_and_b32 v57, 0xffff0000, v12
    v_mul_f32 v56, v56, v11
    v_mul_f32 v57, v57, v11
    v_cvt_pk_bf16_f32 v12, v56, v57
    v_lshlrev_b32_e64 v56, 16, v12
    v_and_b32 v57, 0xffff0000, v12
    v_mul_f32 v56, v56, v88
    v_mul_f32 v57, v57, v89
    v_cvt_pk_bf16_f32 v12, v56, v57
    v_lshlrev_b32_e64 v56, 16, v12
    v_and_b32 v57, 0xffff0000, v12
    v_add_f32 v56, v56, v120
    v_add_f32 v57, v57, v121
    v_cvt_pk_bf16_f32 v28, v56, v57
    v_sub_f32 v58, v58, v10
    v_sub_f32 v59, v59, v10
    v_cvt_pk_bf16_f32 v12, v58, v59
    v_lshlrev_b32_e64 v58, 16, v12
    v_and_b32 v59, 0xffff0000, v12
    v_mul_f32 v58, v58, v11
    v_mul_f32 v59, v59, v11
    v_cvt_pk_bf16_f32 v12, v58, v59
    v_lshlrev_b32_e64 v58, 16, v12
    v_and_b32 v59, 0xffff0000, v12
    v_mul_f32 v58, v58, v90
    v_mul_f32 v59, v59, v91
    v_cvt_pk_bf16_f32 v12, v58, v59
    v_lshlrev_b32_e64 v58, 16, v12
    v_and_b32 v59, 0xffff0000, v12
    v_add_f32 v58, v58, v122
    v_add_f32 v59, v59, v123
    v_cvt_pk_bf16_f32 v30, v58, v59
    v_sub_f32 v60, v60, v10
    v_sub_f32 v61, v61, v10
    v_cvt_pk_bf16_f32 v12, v60, v61
    v_lshlrev_b32_e64 v60, 16, v12
    v_and_b32 v61, 0xffff0000, v12
    v_mul_f32 v60, v60, v11
    v_mul_f32 v61, v61, v11
    v_cvt_pk_bf16_f32 v12, v60, v61
    v_lshlrev_b32_e64 v60, 16, v12
    v_and_b32 v61, 0xffff0000, v12
    v_mul_f32 v60, v60, v92
    v_mul_f32 v61, v61, v93
    v_cvt_pk_bf16_f32 v12, v60, v61
    v_lshlrev_b32_e64 v60, 16, v12
    v_and_b32 v61, 0xffff0000, v12
    v_add_f32 v60, v60, v124
    v_add_f32 v61, v61, v125
    v_cvt_pk_bf16_f32 v29, v60, v61
    v_sub_f32 v62, v62, v10
    v_sub_f32 v63, v63, v10
    v_cvt_pk_bf16_f32 v12, v62, v63
    v_lshlrev_b32_e64 v62, 16, v12
    v_and_b32 v63, 0xffff0000, v12
    v_mul_f32 v62, v62, v11
    v_mul_f32 v63, v63, v11
    v_cvt_pk_bf16_f32 v12, v62, v63
    v_lshlrev_b32_e64 v62, 16, v12
    v_and_b32 v63, 0xffff0000, v12
    v_mul_f32 v62, v62, v94
    v_mul_f32 v63, v63, v95
    v_cvt_pk_bf16_f32 v12, v62, v63
    v_lshlrev_b32_e64 v62, 16, v12
    v_and_b32 v63, 0xffff0000, v12
    v_add_f32 v62, v62, v126
    v_add_f32 v63, v63, v127
    v_cvt_pk_bf16_f32 v31, v62, v63
    v_permlane16_swap_b32 v16, v17
    v_permlane16_swap_b32 v18, v19
    v_permlane16_swap_b32 v20, v21
    v_permlane16_swap_b32 v22, v23
    v_permlane16_swap_b32 v24, v25
    v_permlane16_swap_b32 v26, v27
    v_permlane16_swap_b32 v28, v29
    v_permlane16_swap_b32 v30, v31
    s_lshl_b32 s59, s54, 12
    s_add_u32 s61, s61, s59
    s_add_u32 s61, s61, 1048576
    buffer_store_dwordx4 v[16:19], v3, s[24:27], s61 offen offset:0 sc1
    buffer_store_dwordx4 v[20:23], v3, s[24:27], s61 offen offset:1024 sc1
    buffer_store_dwordx4 v[24:27], v3, s[24:27], s61 offen offset:2048 sc1
    buffer_store_dwordx4 v[28:31], v3, s[24:27], s61 offen offset:3072 sc1
    s_waitcnt vmcnt(0)
    s_barrier
    s_cmp_lg_u32 s54, 0
    s_cbranch_scc1 ln1a_na
    s_cmp_ge_u32 s63, 8
    s_cbranch_scc1 ln1ae_na
    v_mov_b32_e64 v124, 1
    s_mov_b32 s60, 112
    s_mov_b64 exec, 1
    buffer_atomic_add v124, off, s[28:31], s60 sc0
    s_mov_b64 exec, -1
    s_waitcnt vmcnt(0)
    v_readfirstlane_b32 s59, v124
    s_nop 0
    s_cmp_lg_u32 s59, 39
    s_cbranch_scc1 ln1ae_na
ln1ae_tg:
    v_lshlrev_b32 v126, 7, v0
    v_mov_b32_e64 v127, 2
    s_mov_b32 s60, 98308
    buffer_store_dword v127, v126, s[24:27], s60 offen sc1
    s_mov_b32 s60, 106500
    buffer_store_dword v127, v126, s[24:27], s60 offen sc1
    s_mov_b32 s60, 114692
    buffer_store_dword v127, v126, s[24:27], s60 offen sc1
    s_mov_b32 s60, 122884
    buffer_store_dword v127, v126, s[24:27], s60 offen sc1
ln1ae_na:
    v_mov_b32_e64 v124, 1
    s_mov_b32 s60, 192
    s_mov_b64 exec, 1
    buffer_atomic_add v124, off, s[28:31], s60 sc0
    s_mov_b64 exec, -1
    s_waitcnt vmcnt(0)
    v_readfirstlane_b32 s59, v124
    s_nop 0
    s_cmp_lg_u32 s59, 159
    s_cbranch_scc1 ln1a_na
ln1a_tg:
    v_lshlrev_b32 v126, 7, v0
    v_mov_b32 v127, 3
    s_mov_b32 s60, 98312
    buffer_store_dword v127, v126, s[24:27], s60 offen sc1
    s_mov_b32 s60, 106504
    buffer_store_dword v127, v126, s[24:27], s60 offen sc1
    s_mov_b32 s60, 114696
    buffer_store_dword v127, v126, s[24:27], s60 offen sc1
    s_mov_b32 s60, 122888
    buffer_store_dword v127, v126, s[24:27], s60 offen sc1
ln1a_na:
    s_branch pre_done
pre_init:
    v_mov_b64 v[4:5], 0
    v_mov_b64 v[6:7], 0
    v_lshlrev_b32 v3, 4, v0
    s_sub_u32 s59, s63, 128
    s_lshl_b32 s59, s59, 13
    s_lshl_b32 s60, s54, 11
    s_add_u32 s59, s59, s60
    s_add_u32 s59, s59, 7340032
    buffer_store_dwordx4 v[4:7], v3, s[24:27], s59 offen sc1
    buffer_store_dwordx4 v[4:7], v3, s[24:27], s59 offen offset:1024 sc1
    v_mov_b32 v8, -1
    v_mov_b32 v9, -1
    v_mov_b32 v10, -1
    v_mov_b32_e64 v11, -1
    s_sub_u32 s59, s59, 7077888
    buffer_store_dwordx4 v[8:11], v3, s[24:27], s59 offen sc1
    buffer_store_dwordx4 v[8:11], v3, s[24:27], s59 offen offset:1024 sc1
    s_add_u32 s59, s59, 0x40000
    buffer_store_dwordx4 v[8:11], v3, s[24:27], s59 offen sc1
    buffer_store_dwordx4 v[8:11], v3, s[24:27], s59 offen offset:1024 sc1
    s_add_u32 s59, s59, 0x40000
    buffer_store_dwordx4 v[8:11], v3, s[24:27], s59 offen sc1
    buffer_store_dwordx4 v[8:11], v3, s[24:27], s59 offen offset:1024 sc1
    s_add_u32 s59, s59, 0x40000
    s_sub_u32 s61, s63, 128
    s_cmp_ge_u32 s61, 6
    s_cbranch_scc1 ini_nm
    s_lshl_b32 s61, s61, 2
    s_add_u32 s61, s61, s54
    s_cmp_ge_u32 s61, 8
    s_cbranch_scc1 ini_ms
    v_bfe_u32 v1, v0, 1, 3
    v_lshlrev_b32_e64 v2, 10, v1
    v_bfe_u32 v1, v0, 5, 1
    v_lshl_add_u32 v2, v1, 6, v2
    v_and_b32_e64 v1, 1, v0
    v_lshl_add_u32 v2, v1, 5, v2
    v_bfe_u32 v1, v0, 4, 1
    v_lshl_add_u32 v2, v1, 4, v2
    s_lshl_b32 s59, s61, 7
    buffer_load_dwordx4 v[8:11], v2, s[48:51], s59 offen
    s_waitcnt vmcnt(0)
ini_ms:
    s_lshl_b32 s59, s61, 10
    s_add_u32 s59, s59, 131072
    buffer_store_dwordx4 v[8:11], v3, s[24:27], s59 offen sc1
ini_nm:
    s_waitcnt vmcnt(0)
    s_barrier
    s_cmp_lg_u32 s54, 0
    s_cbranch_scc1 inia_na
    v_mov_b32 v124, 1
    s_mov_b32 s60, 112
    s_mov_b64 exec, 1
    buffer_atomic_add v124, off, s[28:31], s60 sc0
    s_mov_b64 exec, -1
    s_waitcnt vmcnt(0)
    v_readfirstlane_b32 s59, v124
    s_nop 0
    s_cmp_lg_u32 s59, 39
    s_cbranch_scc1 iniae_na
iniae_tg:
    v_lshlrev_b32 v126, 7, v0
    v_mov_b32_e64 v127, 2
    s_mov_b32 s60, 98308
    buffer_store_dword v127, v126, s[24:27], s60 offen sc1
    s_mov_b32 s60, 106500
    buffer_store_dword v127, v126, s[24:27], s60 offen sc1
    s_mov_b32 s60, 114692
    buffer_store_dword v127, v126, s[24:27], s60 offen sc1
    s_mov_b32 s60, 122884
    buffer_store_dword v127, v126, s[24:27], s60 offen sc1
iniae_na:
    v_mov_b32_e64 v124, 1
    s_mov_b32 s60, 192
    s_mov_b64 exec, 1
    buffer_atomic_add v124, off, s[28:31], s60 sc0
    s_mov_b64 exec, -1
    s_waitcnt vmcnt(0)
    v_readfirstlane_b32 s59, v124
    s_nop 0
    s_cmp_lg_u32 s59, 159
    s_cbranch_scc1 inia_na
inia_tg:
    v_lshlrev_b32 v126, 7, v0
    v_mov_b32 v127, 3
    s_mov_b32 s60, 98312
    buffer_store_dword v127, v126, s[24:27], s60 offen sc1
    s_mov_b32 s60, 106504
    buffer_store_dword v127, v126, s[24:27], s60 offen sc1
    s_mov_b32 s60, 114696
    buffer_store_dword v127, v126, s[24:27], s60 offen sc1
    s_mov_b32 s60, 122888
    buffer_store_dword v127, v126, s[24:27], s60 offen sc1
inia_na:
pre_done:
    s_cmp_ge_u32 s63, 128
    s_cbranch_scc1 dn_start
    s_bitcmp1_b32 s63, 4
    s_cbranch_scc0 wo_start
    s_branch up_start
wo_start:
    s_load_dwordx2 s[4:5], s[0:1], 40
    s_load_dwordx2 s[6:7], s[0:1], 0
    s_lshr_b32 s65, s63, 5
    s_and_b32 s64, s63, 15
    s_waitcnt lgkmcnt(0)
    s_mov_b32 s32, s4
    s_and_b32 s33, s5, 0xffff
    s_mov_b32 s34, 4194304
    s_mov_b32 s35, 0x00020000
    s_mov_b32 s36, s6
    s_and_b32 s37, s7, 0xffff
    s_mov_b32 s38, 2097152
    s_mov_b32 s39, 0x00020000
    s_barrier
    v_lshlrev_b32 v2, 4, v0
    v_lshrrev_b32 v3, 2, v0
    v_lshlrev_b32 v1, 10, v3
    v_and_b32 v3, 3, v0
    v_lshl_add_u32 v1, v3, 4, v1
    s_mul_i32 s59, s64, 64
    v_add_u32 v1, s59, v1
    s_lshl_b32 s58, s54, 15
    v_lshrrev_b32 v3, 2, v0
    v_mul_u32_u24 v4, 64, v3
    v_and_b32 v3, 3, v0
    v_lshl_add_u32 v4, v3, 3, v4
    v_add_u32_e64 v4, s58, v4
    s_add_u32 s59, s64, 0
    s_and_b32 s59, s59, 15
    s_mul_i32 s60, s54, 32
    s_lshl_b32 s59, s59, 1
    s_add_u32 s59, s59, s60
    s_lshl_b32 s72, s59, 10
    s_add_u32 s59, s64, 1
    s_and_b32 s59, s59, 15
    s_mul_i32 s60, s54, 32
    s_lshl_b32 s59, s59, 1
    s_add_u32 s59, s59, s60
    s_lshl_b32 s73, s59, 10
    s_add_u32 s59, s64, 2
    s_and_b32 s59, s59, 15
    s_mul_i32 s60, s54, 32
    s_lshl_b32 s59, s59, 1
    s_add_u32 s59, s59, s60
    s_lshl_b32 s74, s59, 10
    s_add_u32 s59, s64, 3
    s_and_b32 s59, s59, 15
    s_mul_i32 s60, s54, 32
    s_lshl_b32 s59, s59, 1
    s_add_u32 s59, s59, s60
    s_lshl_b32 s75, s59, 10
    s_add_u32 s59, s64, 4
    s_and_b32 s59, s59, 15
    s_mul_i32 s60, s54, 32
    s_lshl_b32 s59, s59, 1
    s_add_u32 s59, s59, s60
    s_lshl_b32 s76, s59, 10
    s_add_u32 s59, s64, 5
    s_and_b32 s59, s59, 15
    s_mul_i32 s60, s54, 32
    s_lshl_b32 s59, s59, 1
    s_add_u32 s59, s59, s60
    s_lshl_b32 s77, s59, 10
    s_add_u32 s59, s64, 6
    s_and_b32 s59, s59, 15
    s_mul_i32 s60, s54, 32
    s_lshl_b32 s59, s59, 1
    s_add_u32 s59, s59, s60
    s_lshl_b32 s78, s59, 10
    s_add_u32 s59, s64, 7
    s_and_b32 s59, s59, 15
    s_mul_i32 s60, s54, 32
    s_lshl_b32 s59, s59, 1
    s_add_u32 s59, s59, s60
    s_lshl_b32 s79, s59, 10
    s_add_u32 s59, s64, 8
    s_and_b32 s59, s59, 15
    s_mul_i32 s60, s54, 32
    s_lshl_b32 s59, s59, 1
    s_add_u32 s59, s59, s60
    s_lshl_b32 s80, s59, 10
    s_add_u32 s59, s64, 9
    s_and_b32 s59, s59, 15
    s_mul_i32 s60, s54, 32
    s_lshl_b32 s59, s59, 1
    s_add_u32 s59, s59, s60
    s_lshl_b32 s81, s59, 10
    s_add_u32 s59, s64, 10
    s_and_b32 s59, s59, 15
    s_mul_i32 s60, s54, 32
    s_lshl_b32 s59, s59, 1
    s_add_u32 s59, s59, s60
    s_lshl_b32 s82, s59, 10
    s_add_u32 s59, s64, 11
    s_and_b32 s59, s59, 15
    s_mul_i32 s60, s54, 32
    s_lshl_b32 s59, s59, 1
    s_add_u32 s59, s59, s60
    s_lshl_b32 s83, s59, 10
    s_add_u32 s59, s64, 12
    s_and_b32 s59, s59, 15
    s_mul_i32 s60, s54, 32
    s_lshl_b32 s59, s59, 1
    s_add_u32 s59, s59, s60
    s_lshl_b32 s84, s59, 10
    s_add_u32 s59, s64, 13
    s_and_b32 s59, s59, 15
    s_mul_i32 s60, s54, 32
    s_lshl_b32 s59, s59, 1
    s_add_u32 s59, s59, s60
    s_lshl_b32 s85, s59, 10
    s_add_u32 s59, s64, 14
    s_and_b32 s59, s59, 15
    s_mul_i32 s60, s54, 32
    s_lshl_b32 s59, s59, 1
    s_add_u32 s59, s59, s60
    s_lshl_b32 s86, s59, 10
    s_add_u32 s59, s64, 15
    s_and_b32 s59, s59, 15
    s_mul_i32 s60, s54, 32
    s_lshl_b32 s59, s59, 1
    s_add_u32 s59, s59, s60
    s_lshl_b32 s87, s59, 10
    s_waitcnt vmcnt(0)
    s_lshl_b32 s69, s72, 5
    s_add_u32 m0, s58, 0
    s_add_u32 s59, s69, 0
    buffer_load_dwordx4 v1, s[32:35], s59 offen lds
    s_add_u32 m0, s58, 1024
    s_add_u32 s59, s69, 16384
    buffer_load_dwordx4 v1, s[32:35], s59 offen lds
    s_lshl_b32 s69, s72, 5
    s_add_u32 m0, s58, 2048
    s_add_u32 s59, s69, 32768
    buffer_load_dwordx4 v1, s[32:35], s59 offen lds
    s_add_u32 m0, s58, 3072
    s_add_u32 s59, s69, 49152
    buffer_load_dwordx4 v1, s[32:35], s59 offen lds
    s_lshl_b32 s69, s73, 5
    s_add_u32 m0, s58, 4096
    s_add_u32 s59, s69, 0
    buffer_load_dwordx4 v1, s[32:35], s59 offen lds
    s_add_u32 m0, s58, 5120
    s_add_u32 s59, s69, 16384
    buffer_load_dwordx4 v1, s[32:35], s59 offen lds
    s_lshl_b32 s69, s73, 5
    s_add_u32 m0, s58, 6144
    s_add_u32 s59, s69, 32768
    buffer_load_dwordx4 v1, s[32:35], s59 offen lds
    s_add_u32 m0, s58, 7168
    s_add_u32 s59, s69, 49152
    buffer_load_dwordx4 v1, s[32:35], s59 offen lds
    s_lshl_b32 s69, s74, 5
    s_add_u32 m0, s58, 8192
    s_add_u32 s59, s69, 0
    buffer_load_dwordx4 v1, s[32:35], s59 offen lds
    s_add_u32 m0, s58, 9216
    s_add_u32 s59, s69, 16384
    buffer_load_dwordx4 v1, s[32:35], s59 offen lds
    s_lshl_b32 s69, s74, 5
    s_add_u32 m0, s58, 10240
    s_add_u32 s59, s69, 32768
    buffer_load_dwordx4 v1, s[32:35], s59 offen lds
    s_add_u32 m0, s58, 11264
    s_add_u32 s59, s69, 49152
    buffer_load_dwordx4 v1, s[32:35], s59 offen lds
    s_lshl_b32 s69, s75, 5
    s_add_u32 m0, s58, 12288
    s_add_u32 s59, s69, 0
    buffer_load_dwordx4 v1, s[32:35], s59 offen lds
    s_add_u32 m0, s58, 13312
    s_add_u32 s59, s69, 16384
    buffer_load_dwordx4 v1, s[32:35], s59 offen lds
    s_lshl_b32 s69, s75, 5
    s_add_u32 m0, s58, 14336
    s_add_u32 s59, s69, 32768
    buffer_load_dwordx4 v1, s[32:35], s59 offen lds
    s_add_u32 m0, s58, 15360
    s_add_u32 s59, s69, 49152
    buffer_load_dwordx4 v1, s[32:35], s59 offen lds
    s_lshl_b32 s69, s76, 5
    s_add_u32 m0, s58, 16384
    s_add_u32 s59, s69, 0
    buffer_load_dwordx4 v1, s[32:35], s59 offen lds
    s_add_u32 m0, s58, 17408
    s_add_u32 s59, s69, 16384
    buffer_load_dwordx4 v1, s[32:35], s59 offen lds
    s_lshl_b32 s69, s76, 5
    s_add_u32 m0, s58, 18432
    s_add_u32 s59, s69, 32768
    buffer_load_dwordx4 v1, s[32:35], s59 offen lds
    s_add_u32 m0, s58, 19456
    s_add_u32 s59, s69, 49152
    buffer_load_dwordx4 v1, s[32:35], s59 offen lds
    s_lshl_b32 s69, s77, 5
    s_add_u32 m0, s58, 20480
    s_add_u32 s59, s69, 0
    buffer_load_dwordx4 v1, s[32:35], s59 offen lds
    s_add_u32 m0, s58, 21504
    s_add_u32 s59, s69, 16384
    buffer_load_dwordx4 v1, s[32:35], s59 offen lds
    s_lshl_b32 s69, s77, 5
    s_add_u32 m0, s58, 22528
    s_add_u32 s59, s69, 32768
    buffer_load_dwordx4 v1, s[32:35], s59 offen lds
    s_add_u32 m0, s58, 23552
    s_add_u32 s59, s69, 49152
    buffer_load_dwordx4 v1, s[32:35], s59 offen lds
    s_lshl_b32 s69, s78, 5
    s_add_u32 m0, s58, 24576
    s_add_u32 s59, s69, 0
    buffer_load_dwordx4 v1, s[32:35], s59 offen lds
    s_add_u32 m0, s58, 25600
    s_add_u32 s59, s69, 16384
    buffer_load_dwordx4 v1, s[32:35], s59 offen lds
    s_lshl_b32 s69, s78, 5
    s_add_u32 m0, s58, 26624
    s_add_u32 s59, s69, 32768
    buffer_load_dwordx4 v1, s[32:35], s59 offen lds
    s_add_u32 m0, s58, 27648
    s_add_u32 s59, s69, 49152
    buffer_load_dwordx4 v1, s[32:35], s59 offen lds
    s_lshl_b32 s69, s79, 5
    s_add_u32 m0, s58, 28672
    s_add_u32 s59, s69, 0
    buffer_load_dwordx4 v1, s[32:35], s59 offen lds
    s_add_u32 m0, s58, 29696
    s_add_u32 s59, s69, 16384
    buffer_load_dwordx4 v1, s[32:35], s59 offen lds
    s_lshl_b32 s69, s79, 5
    s_add_u32 m0, s58, 30720
    s_add_u32 s59, s69, 32768
    buffer_load_dwordx4 v1, s[32:35], s59 offen lds
    s_add_u32 m0, s58, 31744
    s_add_u32 s59, s69, 49152
    buffer_load_dwordx4 v1, s[32:35], s59 offen lds
    s_waitcnt vmcnt(30)
    ds_read_b64_tr_b16 a[0:1], v4 offset:0
    ds_read_b64_tr_b16 a[2:3], v4 offset:1024
    ds_read_b64_tr_b16 a[4:5], v4 offset:32
    ds_read_b64_tr_b16 a[6:7], v4 offset:1056
    s_waitcnt lgkmcnt(0)
    s_lshl_b32 s69, s80, 5
    s_add_u32 m0, s58, 0
    s_add_u32 s59, s69, 0
    buffer_load_dwordx4 v1, s[32:35], s59 offen lds
    s_add_u32 m0, s58, 1024
    s_add_u32 s59, s69, 16384
    buffer_load_dwordx4 v1, s[32:35], s59 offen lds
    s_waitcnt vmcnt(30)
    ds_read_b64_tr_b16 a[8:9], v4 offset:2048
    ds_read_b64_tr_b16 a[10:11], v4 offset:3072
    ds_read_b64_tr_b16 a[12:13], v4 offset:2080
    ds_read_b64_tr_b16 a[14:15], v4 offset:3104
    s_waitcnt lgkmcnt(0)
    s_lshl_b32 s69, s80, 5
    s_add_u32 m0, s58, 2048
    s_add_u32 s59, s69, 32768
    buffer_load_dwordx4 v1, s[32:35], s59 offen lds
    s_add_u32 m0, s58, 3072
    s_add_u32 s59, s69, 49152
    buffer_load_dwordx4 v1, s[32:35], s59 offen lds
    s_waitcnt vmcnt(30)
    ds_read_b64_tr_b16 a[16:17], v4 offset:4096
    ds_read_b64_tr_b16 a[18:19], v4 offset:5120
    ds_read_b64_tr_b16 a[20:21], v4 offset:4128
    ds_read_b64_tr_b16 a[22:23], v4 offset:5152
    s_waitcnt lgkmcnt(0)
    s_lshl_b32 s69, s81, 5
    s_add_u32 m0, s58, 4096
    s_add_u32 s59, s69, 0
    buffer_load_dwordx4 v1, s[32:35], s59 offen lds
    s_add_u32 m0, s58, 5120
    s_add_u32 s59, s69, 16384
    buffer_load_dwordx4 v1, s[32:35], s59 offen lds
    s_waitcnt vmcnt(30)
    ds_read_b64_tr_b16 a[24:25], v4 offset:6144
    ds_read_b64_tr_b16 a[26:27], v4 offset:7168
    ds_read_b64_tr_b16 a[28:29], v4 offset:6176
    ds_read_b64_tr_b16 a[30:31], v4 offset:7200
    s_waitcnt lgkmcnt(0)
    s_lshl_b32 s69, s81, 5
    s_add_u32 m0, s58, 6144
    s_add_u32 s59, s69, 32768
    buffer_load_dwordx4 v1, s[32:35], s59 offen lds
    s_add_u32 m0, s58, 7168
    s_add_u32 s59, s69, 49152
    buffer_load_dwordx4 v1, s[32:35], s59 offen lds
    s_waitcnt vmcnt(30)
    ds_read_b64_tr_b16 a[32:33], v4 offset:8192
    ds_read_b64_tr_b16 a[34:35], v4 offset:9216
    ds_read_b64_tr_b16 a[36:37], v4 offset:8224
    ds_read_b64_tr_b16 a[38:39], v4 offset:9248
    s_waitcnt lgkmcnt(0)
    s_lshl_b32 s69, s82, 5
    s_add_u32 m0, s58, 8192
    s_add_u32 s59, s69, 0
    buffer_load_dwordx4 v1, s[32:35], s59 offen lds
    s_add_u32 m0, s58, 9216
    s_add_u32 s59, s69, 16384
    buffer_load_dwordx4 v1, s[32:35], s59 offen lds
    s_waitcnt vmcnt(30)
    ds_read_b64_tr_b16 a[40:41], v4 offset:10240
    ds_read_b64_tr_b16 a[42:43], v4 offset:11264
    ds_read_b64_tr_b16 a[44:45], v4 offset:10272
    ds_read_b64_tr_b16 a[46:47], v4 offset:11296
    s_waitcnt lgkmcnt(0)
    s_lshl_b32 s69, s82, 5
    s_add_u32 m0, s58, 10240
    s_add_u32 s59, s69, 32768
    buffer_load_dwordx4 v1, s[32:35], s59 offen lds
    s_add_u32 m0, s58, 11264
    s_add_u32 s59, s69, 49152
    buffer_load_dwordx4 v1, s[32:35], s59 offen lds
    s_waitcnt vmcnt(30)
    ds_read_b64_tr_b16 a[48:49], v4 offset:12288
    ds_read_b64_tr_b16 a[50:51], v4 offset:13312
    ds_read_b64_tr_b16 a[52:53], v4 offset:12320
    ds_read_b64_tr_b16 a[54:55], v4 offset:13344
    s_waitcnt lgkmcnt(0)
    s_lshl_b32 s69, s83, 5
    s_add_u32 m0, s58, 12288
    s_add_u32 s59, s69, 0
    buffer_load_dwordx4 v1, s[32:35], s59 offen lds
    s_add_u32 m0, s58, 13312
    s_add_u32 s59, s69, 16384
    buffer_load_dwordx4 v1, s[32:35], s59 offen lds
    s_waitcnt vmcnt(30)
    ds_read_b64_tr_b16 a[56:57], v4 offset:14336
    ds_read_b64_tr_b16 a[58:59], v4 offset:15360
    ds_read_b64_tr_b16 a[60:61], v4 offset:14368
    ds_read_b64_tr_b16 a[62:63], v4 offset:15392
    s_waitcnt lgkmcnt(0)
    s_lshl_b32 s69, s83, 5
    s_add_u32 m0, s58, 14336
    s_add_u32 s59, s69, 32768
    buffer_load_dwordx4 v1, s[32:35], s59 offen lds
    s_add_u32 m0, s58, 15360
    s_add_u32 s59, s69, 49152
    buffer_load_dwordx4 v1, s[32:35], s59 offen lds
    s_waitcnt vmcnt(30)
    ds_read_b64_tr_b16 a[64:65], v4 offset:16384
    ds_read_b64_tr_b16 a[66:67], v4 offset:17408
    ds_read_b64_tr_b16 a[68:69], v4 offset:16416
    ds_read_b64_tr_b16 a[70:71], v4 offset:17440
    s_waitcnt lgkmcnt(0)
    s_lshl_b32 s69, s84, 5
    s_add_u32 m0, s58, 16384
    s_add_u32 s59, s69, 0
    buffer_load_dwordx4 v1, s[32:35], s59 offen lds
    s_add_u32 m0, s58, 17408
    s_add_u32 s59, s69, 16384
    buffer_load_dwordx4 v1, s[32:35], s59 offen lds
    s_waitcnt vmcnt(30)
    ds_read_b64_tr_b16 a[72:73], v4 offset:18432
    ds_read_b64_tr_b16 a[74:75], v4 offset:19456
    ds_read_b64_tr_b16 a[76:77], v4 offset:18464
    ds_read_b64_tr_b16 a[78:79], v4 offset:19488
    s_waitcnt lgkmcnt(0)
    s_lshl_b32 s69, s84, 5
    s_add_u32 m0, s58, 18432
    s_add_u32 s59, s69, 32768
    buffer_load_dwordx4 v1, s[32:35], s59 offen lds
    s_add_u32 m0, s58, 19456
    s_add_u32 s59, s69, 49152
    buffer_load_dwordx4 v1, s[32:35], s59 offen lds
    s_waitcnt vmcnt(30)
    ds_read_b64_tr_b16 a[80:81], v4 offset:20480
    ds_read_b64_tr_b16 a[82:83], v4 offset:21504
    ds_read_b64_tr_b16 a[84:85], v4 offset:20512
    ds_read_b64_tr_b16 a[86:87], v4 offset:21536
    s_waitcnt lgkmcnt(0)
    s_lshl_b32 s69, s85, 5
    s_add_u32 m0, s58, 20480
    s_add_u32 s59, s69, 0
    buffer_load_dwordx4 v1, s[32:35], s59 offen lds
    s_add_u32 m0, s58, 21504
    s_add_u32 s59, s69, 16384
    buffer_load_dwordx4 v1, s[32:35], s59 offen lds
    s_waitcnt vmcnt(30)
    ds_read_b64_tr_b16 a[88:89], v4 offset:22528
    ds_read_b64_tr_b16 a[90:91], v4 offset:23552
    ds_read_b64_tr_b16 a[92:93], v4 offset:22560
    ds_read_b64_tr_b16 a[94:95], v4 offset:23584
    s_waitcnt lgkmcnt(0)
    s_lshl_b32 s69, s85, 5
    s_add_u32 m0, s58, 22528
    s_add_u32 s59, s69, 32768
    buffer_load_dwordx4 v1, s[32:35], s59 offen lds
    s_add_u32 m0, s58, 23552
    s_add_u32 s59, s69, 49152
    buffer_load_dwordx4 v1, s[32:35], s59 offen lds
    s_waitcnt vmcnt(30)
    ds_read_b64_tr_b16 a[96:97], v4 offset:24576
    ds_read_b64_tr_b16 a[98:99], v4 offset:25600
    ds_read_b64_tr_b16 a[100:101], v4 offset:24608
    ds_read_b64_tr_b16 a[102:103], v4 offset:25632
    s_waitcnt lgkmcnt(0)
    s_lshl_b32 s69, s86, 5
    s_add_u32 m0, s58, 24576
    s_add_u32 s59, s69, 0
    buffer_load_dwordx4 v1, s[32:35], s59 offen lds
    s_add_u32 m0, s58, 25600
    s_add_u32 s59, s69, 16384
    buffer_load_dwordx4 v1, s[32:35], s59 offen lds
    s_waitcnt vmcnt(30)
    ds_read_b64_tr_b16 a[104:105], v4 offset:26624
    ds_read_b64_tr_b16 a[106:107], v4 offset:27648
    ds_read_b64_tr_b16 a[108:109], v4 offset:26656
    ds_read_b64_tr_b16 a[110:111], v4 offset:27680
    s_waitcnt lgkmcnt(0)
    s_lshl_b32 s69, s86, 5
    s_add_u32 m0, s58, 26624
    s_add_u32 s59, s69, 32768
    buffer_load_dwordx4 v1, s[32:35], s59 offen lds
    s_add_u32 m0, s58, 27648
    s_add_u32 s59, s69, 49152
    buffer_load_dwordx4 v1, s[32:35], s59 offen lds
    s_waitcnt vmcnt(30)
    ds_read_b64_tr_b16 a[112:113], v4 offset:28672
    ds_read_b64_tr_b16 a[114:115], v4 offset:29696
    ds_read_b64_tr_b16 a[116:117], v4 offset:28704
    ds_read_b64_tr_b16 a[118:119], v4 offset:29728
    s_waitcnt lgkmcnt(0)
    s_lshl_b32 s69, s87, 5
    s_add_u32 m0, s58, 28672
    s_add_u32 s59, s69, 0
    buffer_load_dwordx4 v1, s[32:35], s59 offen lds
    s_add_u32 m0, s58, 29696
    s_add_u32 s59, s69, 16384
    buffer_load_dwordx4 v1, s[32:35], s59 offen lds
    s_waitcnt vmcnt(30)
    ds_read_b64_tr_b16 a[120:121], v4 offset:30720
    ds_read_b64_tr_b16 a[122:123], v4 offset:31744
    ds_read_b64_tr_b16 a[124:125], v4 offset:30752
    ds_read_b64_tr_b16 a[126:127], v4 offset:31776
    s_waitcnt lgkmcnt(0)
    s_lshl_b32 s69, s87, 5
    s_add_u32 m0, s58, 30720
    s_add_u32 s59, s69, 32768
    buffer_load_dwordx4 v1, s[32:35], s59 offen lds
    s_add_u32 m0, s58, 31744
    s_add_u32 s59, s69, 49152
    buffer_load_dwordx4 v1, s[32:35], s59 offen lds
    s_waitcnt vmcnt(30)
    ds_read_b64_tr_b16 a[128:129], v4 offset:0
    ds_read_b64_tr_b16 a[130:131], v4 offset:1024
    ds_read_b64_tr_b16 a[132:133], v4 offset:32
    ds_read_b64_tr_b16 a[134:135], v4 offset:1056
    s_waitcnt vmcnt(28)
    ds_read_b64_tr_b16 a[136:137], v4 offset:2048
    ds_read_b64_tr_b16 a[138:139], v4 offset:3072
    ds_read_b64_tr_b16 a[140:141], v4 offset:2080
    ds_read_b64_tr_b16 a[142:143], v4 offset:3104
    s_waitcnt vmcnt(26)
    ds_read_b64_tr_b16 a[144:145], v4 offset:4096
    ds_read_b64_tr_b16 a[146:147], v4 offset:5120
    ds_read_b64_tr_b16 a[148:149], v4 offset:4128
    ds_read_b64_tr_b16 a[150:151], v4 offset:5152
    s_waitcnt vmcnt(24)
    ds_read_b64_tr_b16 a[152:153], v4 offset:6144
    ds_read_b64_tr_b16 a[154:155], v4 offset:7168
    ds_read_b64_tr_b16 a[156:157], v4 offset:6176
    ds_read_b64_tr_b16 a[158:159], v4 offset:7200
    s_waitcnt vmcnt(22)
    ds_read_b64_tr_b16 a[160:161], v4 offset:8192
    ds_read_b64_tr_b16 a[162:163], v4 offset:9216
    ds_read_b64_tr_b16 a[164:165], v4 offset:8224
    ds_read_b64_tr_b16 a[166:167], v4 offset:9248
    s_waitcnt vmcnt(20)
    ds_read_b64_tr_b16 a[168:169], v4 offset:10240
    ds_read_b64_tr_b16 a[170:171], v4 offset:11264
    ds_read_b64_tr_b16 a[172:173], v4 offset:10272
    ds_read_b64_tr_b16 a[174:175], v4 offset:11296
    s_waitcnt vmcnt(18)
    ds_read_b64_tr_b16 a[176:177], v4 offset:12288
    ds_read_b64_tr_b16 a[178:179], v4 offset:13312
    ds_read_b64_tr_b16 a[180:181], v4 offset:12320
    ds_read_b64_tr_b16 a[182:183], v4 offset:13344
    s_waitcnt vmcnt(16)
    ds_read_b64_tr_b16 a[184:185], v4 offset:14336
    ds_read_b64_tr_b16 a[186:187], v4 offset:15360
    ds_read_b64_tr_b16 a[188:189], v4 offset:14368
    ds_read_b64_tr_b16 a[190:191], v4 offset:15392
    s_waitcnt vmcnt(14)
    ds_read_b64_tr_b16 a[192:193], v4 offset:16384
    ds_read_b64_tr_b16 a[194:195], v4 offset:17408
    ds_read_b64_tr_b16 a[196:197], v4 offset:16416
    ds_read_b64_tr_b16 a[198:199], v4 offset:17440
    s_waitcnt vmcnt(12)
    ds_read_b64_tr_b16 a[200:201], v4 offset:18432
    ds_read_b64_tr_b16 a[202:203], v4 offset:19456
    ds_read_b64_tr_b16 a[204:205], v4 offset:18464
    ds_read_b64_tr_b16 a[206:207], v4 offset:19488
    s_waitcnt vmcnt(10)
    ds_read_b64_tr_b16 a[208:209], v4 offset:20480
    ds_read_b64_tr_b16 a[210:211], v4 offset:21504
    ds_read_b64_tr_b16 a[212:213], v4 offset:20512
    ds_read_b64_tr_b16 a[214:215], v4 offset:21536
    s_waitcnt vmcnt(8)
    ds_read_b64_tr_b16 a[216:217], v4 offset:22528
    ds_read_b64_tr_b16 a[218:219], v4 offset:23552
    ds_read_b64_tr_b16 a[220:221], v4 offset:22560
    ds_read_b64_tr_b16 a[222:223], v4 offset:23584
    s_waitcnt vmcnt(6)
    ds_read_b64_tr_b16 a[224:225], v4 offset:24576
    ds_read_b64_tr_b16 a[226:227], v4 offset:25600
    ds_read_b64_tr_b16 a[228:229], v4 offset:24608
    ds_read_b64_tr_b16 a[230:231], v4 offset:25632
    s_waitcnt vmcnt(4)
    ds_read_b64_tr_b16 a[232:233], v4 offset:26624
    ds_read_b64_tr_b16 a[234:235], v4 offset:27648
    ds_read_b64_tr_b16 a[236:237], v4 offset:26656
    ds_read_b64_tr_b16 a[238:239], v4 offset:27680
    s_waitcnt vmcnt(2)
    ds_read_b64_tr_b16 a[240:241], v4 offset:28672
    ds_read_b64_tr_b16 a[242:243], v4 offset:29696
    ds_read_b64_tr_b16 a[244:245], v4 offset:28704
    ds_read_b64_tr_b16 a[246:247], v4 offset:29728
    s_waitcnt vmcnt(0)
    ds_read_b64_tr_b16 a[248:249], v4 offset:30720
    ds_read_b64_tr_b16 a[250:251], v4 offset:31744
    ds_read_b64_tr_b16 a[252:253], v4 offset:30752
    ds_read_b64_tr_b16 a[254:255], v4 offset:31776
    s_cmp_lg_u32 s54, 0
    s_cbranch_scc1 word_ok
word_w:
    buffer_load_dword v127, off, s[24:27], s3 offset:8 sc1
    s_add_u32 s52, s52, 1
    s_waitcnt vmcnt(0)
    v_readfirstlane_b32 s59, v127
    s_nop 0
    s_cmp_ge_u32 s59, 3
    s_cbranch_scc1 word_ok
    s_cmp_gt_u32 s52, 4194304
    s_cbranch_scc1 word_ok
    s_sleep 1
    s_branch word_w
word_ok:
    s_barrier
    v_and_b32 v5, 15, v0
    v_lshrrev_b32 v6, 4, v0
    v_lshlrev_b32 v7, 10, v5
    v_lshl_add_u32 v7, v6, 3, v7
    s_mul_i32 s59, s64, 64
    s_and_b32 s60, s54, 1
    s_lshl_b32 s60, s60, 5
    s_add_u32 s59, s59, s60
    v_add_u32 v7, s59, v7
    v_lshlrev_b32 v30, 4, v5
    v_lshrrev_b32_e64 v8, 1, v6
    v_lshl_add_u32 v30, v8, 8, v30
    v_and_b32_e64 v8, 1, v6
    v_lshl_add_u32 v30, v8, 3, v30
    s_lshl_b32 s61, s59, 4
    v_add_u32 v30, s61, v30
    v_lshlrev_b32 v8, 4, v6
    s_lshl_b32 s59, s59, 1
    s_add_u32 s59, s59, 69632
    buffer_load_dwordx4 v[12:15], v8, s[24:27], s59 offen sc1
    s_mul_i32 s59, s54, 2048
    s_add_u32 s59, s59, 131072
    v_add_u32 v9, s59, v2
    s_lshl_b32 s59, s60, 5
    s_add_u32 s59, s59, 131072
    v_add_u32 v10, s59, v2
    v_and_b32 v11, 15, v0
    s_lshl_b32 s59, s54, 4
    v_add_u32 v11, s59, v11
    v_lshlrev_b32 v11, 7, v11
    s_lshl_b32 s67, s65, 13
    s_add_u32 s67, s67, 7405568
    s_lshl_b32 s68, s65, 13
    s_lshl_b32 s59, s64, 8
    s_add_u32 s68, s68, s59
    s_lshl_b32 s59, s54, 7
    s_add_u32 s68, s68, s59
    s_add_u32 s68, s68, 7471104
    s_waitcnt vmcnt(0) lgkmcnt(0)
wo_loop:
    s_add_u32 s66, s65, 1
    s_mul_i32 s61, s65, 131072
    s_add_u32 s61, s61, 67108864
    s_lshl_b32 s69, s65, 14
    s_add_u32 s60, s69, 0
wo_pw:
    buffer_load_dword v127, v11, s[24:27], s67 offen sc1
    s_add_u32 s52, s52, 1
    s_cmp_gt_u32 s52, 4194304
    s_waitcnt vmcnt(0)
    v_cmp_gt_u32_e64 vcc, s66, v127
    s_cbranch_scc1 wo_pk
    s_cbranch_vccz wo_pk
    s_sleep 1
    s_branch wo_pw
wo_pk:
    s_add_u32 s59, s61, s72
    buffer_load_dwordx4 v[128:131], v2, s[24:27], s59 offen offset:0 sc1
    buffer_load_dwordx4 v[132:135], v2, s[24:27], s59 offen offset:1024 sc1
    s_add_u32 s59, s61, s73
    buffer_load_dwordx4 v[136:139], v2, s[24:27], s59 offen offset:0 sc1
    buffer_load_dwordx4 v[140:143], v2, s[24:27], s59 offen offset:1024 sc1
    s_add_u32 s59, s61, s74
    buffer_load_dwordx4 v[144:147], v2, s[24:27], s59 offen offset:0 sc1
    buffer_load_dwordx4 v[148:151], v2, s[24:27], s59 offen offset:1024 sc1
    s_add_u32 s59, s61, s75
    buffer_load_dwordx4 v[152:155], v2, s[24:27], s59 offen offset:0 sc1
    buffer_load_dwordx4 v[156:159], v2, s[24:27], s59 offen offset:1024 sc1
    s_add_u32 s59, s61, s76
    buffer_load_dwordx4 v[160:163], v2, s[24:27], s59 offen offset:0 sc1
    buffer_load_dwordx4 v[164:167], v2, s[24:27], s59 offen offset:1024 sc1
    s_add_u32 s59, s61, s77
    buffer_load_dwordx4 v[168:171], v2, s[24:27], s59 offen offset:0 sc1
    buffer_load_dwordx4 v[172:175], v2, s[24:27], s59 offen offset:1024 sc1
    s_add_u32 s59, s61, s78
    buffer_load_dwordx4 v[176:179], v2, s[24:27], s59 offen offset:0 sc1
    buffer_load_dwordx4 v[180:183], v2, s[24:27], s59 offen offset:1024 sc1
    s_add_u32 s59, s61, s79
    buffer_load_dwordx4 v[184:187], v2, s[24:27], s59 offen offset:0 sc1
    buffer_load_dwordx4 v[188:191], v2, s[24:27], s59 offen offset:1024 sc1
    s_add_u32 s59, s61, s80
    buffer_load_dwordx4 v[192:195], v2, s[24:27], s59 offen offset:0 sc1
    buffer_load_dwordx4 v[196:199], v2, s[24:27], s59 offen offset:1024 sc1
    s_add_u32 s59, s61, s81
    buffer_load_dwordx4 v[200:203], v2, s[24:27], s59 offen offset:0 sc1
    buffer_load_dwordx4 v[204:207], v2, s[24:27], s59 offen offset:1024 sc1
    s_add_u32 s59, s61, s82
    buffer_load_dwordx4 v[208:211], v2, s[24:27], s59 offen offset:0 sc1
    buffer_load_dwordx4 v[212:215], v2, s[24:27], s59 offen offset:1024 sc1
    s_add_u32 s59, s61, s83
    buffer_load_dwordx4 v[216:219], v2, s[24:27], s59 offen offset:0 sc1
    buffer_load_dwordx4 v[220:223], v2, s[24:27], s59 offen offset:1024 sc1
    s_add_u32 s59, s61, s84
    buffer_load_dwordx4 v[224:227], v2, s[24:27], s59 offen offset:0 sc1
    buffer_load_dwordx4 v[228:231], v2, s[24:27], s59 offen offset:1024 sc1
    s_add_u32 s59, s61, s85
    buffer_load_dwordx4 v[232:235], v2, s[24:27], s59 offen offset:0 sc1
    buffer_load_dwordx4 v[236:239], v2, s[24:27], s59 offen offset:1024 sc1
    s_add_u32 s59, s61, s86
    buffer_load_dwordx4 v[240:243], v2, s[24:27], s59 offen offset:0 sc1
    buffer_load_dwordx4 v[244:247], v2, s[24:27], s59 offen offset:1024 sc1
    s_add_u32 s59, s61, s87
    buffer_load_dwordx4 v[248:251], v2, s[24:27], s59 offen offset:0 sc1
    buffer_load_dwordx4 v[252:255], v2, s[24:27], s59 offen offset:1024 sc1
    buffer_load_dwordx2 v[24:25], v7, s[36:39], s60 offen
    s_waitcnt vmcnt(32)
    v_mfma_f32_16x16x32_bf16 v[64:67], a[0:3], v[128:131], 0
    v_mfma_f32_16x16x32_bf16 v[68:71], a[4:7], v[128:131], 0
    s_waitcnt vmcnt(31)
    v_mfma_f32_16x16x32_bf16 v[64:67], a[8:11], v[132:135], v[64:67]
    v_mfma_f32_16x16x32_bf16 v[68:71], a[12:15], v[132:135], v[68:71]
    s_waitcnt vmcnt(30)
    v_mfma_f32_16x16x32_bf16 v[64:67], a[16:19], v[136:139], v[64:67]
    v_mfma_f32_16x16x32_bf16 v[68:71], a[20:23], v[136:139], v[68:71]
    s_waitcnt vmcnt(29)
    v_mfma_f32_16x16x32_bf16 v[64:67], a[24:27], v[140:143], v[64:67]
    v_mfma_f32_16x16x32_bf16 v[68:71], a[28:31], v[140:143], v[68:71]
    s_waitcnt vmcnt(28)
    v_mfma_f32_16x16x32_bf16 v[64:67], a[32:35], v[144:147], v[64:67]
    v_mfma_f32_16x16x32_bf16 v[68:71], a[36:39], v[144:147], v[68:71]
    s_waitcnt vmcnt(27)
    v_mfma_f32_16x16x32_bf16 v[64:67], a[40:43], v[148:151], v[64:67]
    v_mfma_f32_16x16x32_bf16 v[68:71], a[44:47], v[148:151], v[68:71]
    s_waitcnt vmcnt(26)
    v_mfma_f32_16x16x32_bf16 v[64:67], a[48:51], v[152:155], v[64:67]
    v_mfma_f32_16x16x32_bf16 v[68:71], a[52:55], v[152:155], v[68:71]
    s_waitcnt vmcnt(25)
    v_mfma_f32_16x16x32_bf16 v[64:67], a[56:59], v[156:159], v[64:67]
    v_mfma_f32_16x16x32_bf16 v[68:71], a[60:63], v[156:159], v[68:71]
    s_waitcnt vmcnt(24)
    v_mfma_f32_16x16x32_bf16 v[64:67], a[64:67], v[160:163], v[64:67]
    v_mfma_f32_16x16x32_bf16 v[68:71], a[68:71], v[160:163], v[68:71]
    s_waitcnt vmcnt(23)
    v_mfma_f32_16x16x32_bf16 v[64:67], a[72:75], v[164:167], v[64:67]
    v_mfma_f32_16x16x32_bf16 v[68:71], a[76:79], v[164:167], v[68:71]
    s_waitcnt vmcnt(22)
    v_mfma_f32_16x16x32_bf16 v[64:67], a[80:83], v[168:171], v[64:67]
    v_mfma_f32_16x16x32_bf16 v[68:71], a[84:87], v[168:171], v[68:71]
    s_waitcnt vmcnt(21)
    v_mfma_f32_16x16x32_bf16 v[64:67], a[88:91], v[172:175], v[64:67]
    v_mfma_f32_16x16x32_bf16 v[68:71], a[92:95], v[172:175], v[68:71]
    s_waitcnt vmcnt(20)
    v_mfma_f32_16x16x32_bf16 v[64:67], a[96:99], v[176:179], v[64:67]
    v_mfma_f32_16x16x32_bf16 v[68:71], a[100:103], v[176:179], v[68:71]
    s_waitcnt vmcnt(19)
    v_mfma_f32_16x16x32_bf16 v[64:67], a[104:107], v[180:183], v[64:67]
    v_mfma_f32_16x16x32_bf16 v[68:71], a[108:111], v[180:183], v[68:71]
    s_waitcnt vmcnt(18)
    v_mfma_f32_16x16x32_bf16 v[64:67], a[112:115], v[184:187], v[64:67]
    v_mfma_f32_16x16x32_bf16 v[68:71], a[116:119], v[184:187], v[68:71]
    s_waitcnt vmcnt(17)
    v_mfma_f32_16x16x32_bf16 v[64:67], a[120:123], v[188:191], v[64:67]
    v_mfma_f32_16x16x32_bf16 v[68:71], a[124:127], v[188:191], v[68:71]
    s_waitcnt vmcnt(16)
    v_mfma_f32_16x16x32_bf16 v[64:67], a[128:131], v[192:195], v[64:67]
    v_mfma_f32_16x16x32_bf16 v[68:71], a[132:135], v[192:195], v[68:71]
    s_waitcnt vmcnt(15)
    v_mfma_f32_16x16x32_bf16 v[64:67], a[136:139], v[196:199], v[64:67]
    v_mfma_f32_16x16x32_bf16 v[68:71], a[140:143], v[196:199], v[68:71]
    s_waitcnt vmcnt(14)
    v_mfma_f32_16x16x32_bf16 v[64:67], a[144:147], v[200:203], v[64:67]
    v_mfma_f32_16x16x32_bf16 v[68:71], a[148:151], v[200:203], v[68:71]
    s_waitcnt vmcnt(13)
    v_mfma_f32_16x16x32_bf16 v[64:67], a[152:155], v[204:207], v[64:67]
    v_mfma_f32_16x16x32_bf16 v[68:71], a[156:159], v[204:207], v[68:71]
    s_waitcnt vmcnt(12)
    v_mfma_f32_16x16x32_bf16 v[64:67], a[160:163], v[208:211], v[64:67]
    v_mfma_f32_16x16x32_bf16 v[68:71], a[164:167], v[208:211], v[68:71]
    s_waitcnt vmcnt(11)
    v_mfma_f32_16x16x32_bf16 v[64:67], a[168:171], v[212:215], v[64:67]
    v_mfma_f32_16x16x32_bf16 v[68:71], a[172:175], v[212:215], v[68:71]
    s_waitcnt vmcnt(10)
    v_mfma_f32_16x16x32_bf16 v[64:67], a[176:179], v[216:219], v[64:67]
    v_mfma_f32_16x16x32_bf16 v[68:71], a[180:183], v[216:219], v[68:71]
    s_waitcnt vmcnt(9)
    v_mfma_f32_16x16x32_bf16 v[64:67], a[184:187], v[220:223], v[64:67]
    v_mfma_f32_16x16x32_bf16 v[68:71], a[188:191], v[220:223], v[68:71]
    s_waitcnt vmcnt(8)
    v_mfma_f32_16x16x32_bf16 v[64:67], a[192:195], v[224:227], v[64:67]
    v_mfma_f32_16x16x32_bf16 v[68:71], a[196:199], v[224:227], v[68:71]
    s_waitcnt vmcnt(7)
    v_mfma_f32_16x16x32_bf16 v[64:67], a[200:203], v[228:231], v[64:67]
    v_mfma_f32_16x16x32_bf16 v[68:71], a[204:207], v[228:231], v[68:71]
    s_waitcnt vmcnt(6)
    v_mfma_f32_16x16x32_bf16 v[64:67], a[208:211], v[232:235], v[64:67]
    v_mfma_f32_16x16x32_bf16 v[68:71], a[212:215], v[232:235], v[68:71]
    s_waitcnt vmcnt(5)
    v_mfma_f32_16x16x32_bf16 v[64:67], a[216:219], v[236:239], v[64:67]
    v_mfma_f32_16x16x32_bf16 v[68:71], a[220:223], v[236:239], v[68:71]
    s_waitcnt vmcnt(4)
    v_mfma_f32_16x16x32_bf16 v[64:67], a[224:227], v[240:243], v[64:67]
    v_mfma_f32_16x16x32_bf16 v[68:71], a[228:231], v[240:243], v[68:71]
    s_waitcnt vmcnt(3)
    v_mfma_f32_16x16x32_bf16 v[64:67], a[232:235], v[244:247], v[64:67]
    v_mfma_f32_16x16x32_bf16 v[68:71], a[236:239], v[244:247], v[68:71]
    s_waitcnt vmcnt(2)
    v_mfma_f32_16x16x32_bf16 v[64:67], a[240:243], v[248:251], v[64:67]
    v_mfma_f32_16x16x32_bf16 v[68:71], a[244:247], v[248:251], v[68:71]
    s_waitcnt vmcnt(1)
    v_mfma_f32_16x16x32_bf16 v[64:67], a[248:251], v[252:255], v[64:67]
    v_mfma_f32_16x16x32_bf16 v[68:71], a[252:255], v[252:255], v[68:71]
    s_nop 3
    ds_write_b128 v9, v[64:67] offset:0
    s_nop 2
    ds_write_b128 v9, v[68:71] offset:1024
    s_waitcnt lgkmcnt(0)
    s_barrier
    ds_read_b128 v[32:35], v10 offset:0
    ds_read_b128 v[36:39], v10 offset:2048
    ds_read_b128 v[40:43], v10 offset:4096
    ds_read_b128 v[44:47], v10 offset:6144
    s_waitcnt lgkmcnt(0) vmcnt(0)
    s_barrier
    s_cmp_ge_u32 s54, 2
    s_cbranch_scc1 wo_next
    v_add_f32 v32, v32, v36
    v_add_f32 v40, v40, v44
    v_add_f32 v33, v33, v37
    v_add_f32 v41, v41, v45
    v_add_f32 v34, v34, v38
    v_add_f32 v42, v42, v46
    v_add_f32 v35, v35, v39
    v_add_f32 v43, v43, v47
    v_add_f32 v32, v32, v40
    v_add_f32 v33, v33, v41
    v_add_f32 v34, v34, v42
    v_add_f32_e64 v35, v35, v43
    v_cvt_pk_bf16_f32 v26, v32, v33
    v_lshlrev_b32_e64 v32, 16, v26
    v_and_b32 v33, 0xffff0000, v26
    v_cvt_pk_bf16_f32 v26, v34, v35
    v_lshlrev_b32_e64 v34, 16, v26
    v_and_b32 v35, 0xffff0000, v26
    v_mul_f32 v32, v32, v12
    v_mul_f32 v33, v33, v13
    v_mul_f32 v34, v34, v14
    v_mul_f32 v35, v35, v15
    v_cvt_pk_bf16_f32 v26, v32, v33
    v_lshlrev_b32_e64 v32, 16, v26
    v_and_b32 v33, 0xffff0000, v26
    v_cvt_pk_bf16_f32 v26, v34, v35
    v_lshlrev_b32_e64 v34, 16, v26
    v_and_b32 v35, 0xffff0000, v26
    v_lshlrev_b32_e64 v26, 16, v24
    v_and_b32 v27, 0xffff0000, v24
    v_lshlrev_b32_e64 v28, 16, v25
    v_and_b32 v29, 0xffff0000, v25
    v_add_f32 v32, v32, v26
    v_add_f32 v33, v33, v27
    v_add_f32 v34, v34, v28
    v_add_f32 v35, v35, v29
    v_cvt_pk_bf16_f32 v24, v32, v33
    v_cvt_pk_bf16_f32 v25, v34, v35
    s_add_u32 s60, s69, 3145728
    buffer_store_dwordx2 v[24:25], v30, s[24:27], s60 offen sc1
    v_mov_b32_e64 v127, s66
    s_waitcnt vmcnt(0)
    s_mov_b64 exec, 1
    buffer_store_dword v127, off, s[24:27], s68 sc1
    s_mov_b64 exec, -1
wo_next:
    s_add_u32 s65, s65, 4
    s_cmp_lt_u32 s65, 128
    s_cbranch_scc1 wo_loop
    s_branch main_done
dn_start:
    s_load_dwordx2 s[4:5], s[0:1], 80
    s_load_dwordx2 s[6:7], s[0:1], 104
    s_bfe_u32 s65, s63, 0x20003
    s_and_b32 s64, s63, 7
    s_waitcnt lgkmcnt(0)
    s_mov_b32 s32, s4
    s_and_b32 s33, s5, 0xffff
    s_mov_b32 s34, 1835008
    s_mov_b32 s35, 0x00020000
    s_mov_b32 s40, s6
    s_and_b32 s41, s7, 0xffff
    s_mov_b32 s42, 2097152
    s_mov_b32 s43, 0x00020000
    s_barrier
    v_lshlrev_b32 v2, 4, v0
    v_lshrrev_b32 v3, 3, v0
    v_lshlrev_b32 v1, 10, v3
    v_and_b32_e64 v3, 7, v0
    v_lshl_add_u32 v1, v3, 4, v1
    s_mul_i32 s59, s64, 128
    v_add_u32 v1, s59, v1
    s_lshl_b32 s58, s54, 15
    v_lshrrev_b32_e64 v3, 2, v0
    v_mul_u32_u24 v4, 128, v3
    v_and_b32_e64 v3, 3, v0
    v_lshl_add_u32 v4, v3, 3, v4
    v_add_u32 v4, s58, v4
    s_add_u32 s59, s64, 0
    s_sub_u32 s60, s59, 7
    s_cmp_ge_u32 s59, 7
    s_cselect_b32 s59, s60, s59
    s_sub_u32 s60, s59, 7
    s_cmp_ge_u32 s59, 7
    s_cselect_b32 s59, s60, s59
    s_mul_i32 s60, s54, 14
    s_lshl_b32 s59, s59, 1
    s_add_u32 s59, s59, s60
    s_lshl_b32 s72, s59, 10
    s_add_u32 s59, s64, 1
    s_sub_u32 s60, s59, 7
    s_cmp_ge_u32 s59, 7
    s_cselect_b32 s59, s60, s59
    s_sub_u32 s60, s59, 7
    s_cmp_ge_u32 s59, 7
    s_cselect_b32 s59, s60, s59
    s_mul_i32 s60, s54, 14
    s_lshl_b32 s59, s59, 1
    s_add_u32 s59, s59, s60
    s_lshl_b32 s73, s59, 10
    s_add_u32 s59, s64, 2
    s_sub_u32 s60, s59, 7
    s_cmp_ge_u32 s59, 7
    s_cselect_b32 s59, s60, s59
    s_sub_u32 s60, s59, 7
    s_cmp_ge_u32 s59, 7
    s_cselect_b32 s59, s60, s59
    s_mul_i32 s60, s54, 14
    s_lshl_b32 s59, s59, 1
    s_add_u32 s59, s59, s60
    s_lshl_b32 s74, s59, 10
    s_add_u32 s59, s64, 3
    s_sub_u32 s60, s59, 7
    s_cmp_ge_u32 s59, 7
    s_cselect_b32 s59, s60, s59
    s_sub_u32 s60, s59, 7
    s_cmp_ge_u32 s59, 7
    s_cselect_b32 s59, s60, s59
    s_mul_i32 s60, s54, 14
    s_lshl_b32 s59, s59, 1
    s_add_u32 s59, s59, s60
    s_lshl_b32 s75, s59, 10
    s_add_u32 s59, s64, 4
    s_sub_u32 s60, s59, 7
    s_cmp_ge_u32 s59, 7
    s_cselect_b32 s59, s60, s59
    s_sub_u32 s60, s59, 7
    s_cmp_ge_u32 s59, 7
    s_cselect_b32 s59, s60, s59
    s_mul_i32 s60, s54, 14
    s_lshl_b32 s59, s59, 1
    s_add_u32 s59, s59, s60
    s_lshl_b32 s76, s59, 10
    s_add_u32 s59, s64, 5
    s_sub_u32 s60, s59, 7
    s_cmp_ge_u32 s59, 7
    s_cselect_b32 s59, s60, s59
    s_sub_u32 s60, s59, 7
    s_cmp_ge_u32 s59, 7
    s_cselect_b32 s59, s60, s59
    s_mul_i32 s60, s54, 14
    s_lshl_b32 s59, s59, 1
    s_add_u32 s59, s59, s60
    s_lshl_b32 s77, s59, 10
    s_add_u32 s59, s64, 6
    s_sub_u32 s60, s59, 7
    s_cmp_ge_u32 s59, 7
    s_cselect_b32 s59, s60, s59
    s_sub_u32 s60, s59, 7
    s_cmp_ge_u32 s59, 7
    s_cselect_b32 s59, s60, s59
    s_mul_i32 s60, s54, 14
    s_lshl_b32 s59, s59, 1
    s_add_u32 s59, s59, s60
    s_lshl_b32 s78, s59, 10
    s_waitcnt vmcnt(0)
    s_lshl_b32 s69, s72, 5
    s_add_u32 m0, s58, 0
    s_add_u32 s59, s69, 0
    buffer_load_dwordx4 v1, s[32:35], s59 offen lds
    s_add_u32 m0, s58, 1024
    s_add_u32 s59, s69, 8192
    buffer_load_dwordx4 v1, s[32:35], s59 offen lds
    s_add_u32 m0, s58, 2048
    s_add_u32 s59, s69, 16384
    buffer_load_dwordx4 v1, s[32:35], s59 offen lds
    s_add_u32 m0, s58, 3072
    s_add_u32 s59, s69, 24576
    buffer_load_dwordx4 v1, s[32:35], s59 offen lds
    s_lshl_b32 s69, s72, 5
    s_add_u32 m0, s58, 4096
    s_add_u32 s59, s69, 32768
    buffer_load_dwordx4 v1, s[32:35], s59 offen lds
    s_add_u32 m0, s58, 5120
    s_add_u32 s59, s69, 40960
    buffer_load_dwordx4 v1, s[32:35], s59 offen lds
    s_add_u32 m0, s58, 6144
    s_add_u32 s59, s69, 49152
    buffer_load_dwordx4 v1, s[32:35], s59 offen lds
    s_add_u32 m0, s58, 7168
    s_add_u32 s59, s69, 57344
    buffer_load_dwordx4 v1, s[32:35], s59 offen lds
    s_lshl_b32 s69, s73, 5
    s_add_u32 m0, s58, 8192
    s_add_u32 s59, s69, 0
    buffer_load_dwordx4 v1, s[32:35], s59 offen lds
    s_add_u32 m0, s58, 9216
    s_add_u32 s59, s69, 8192
    buffer_load_dwordx4 v1, s[32:35], s59 offen lds
    s_add_u32 m0, s58, 10240
    s_add_u32 s59, s69, 16384
    buffer_load_dwordx4 v1, s[32:35], s59 offen lds
    s_add_u32 m0, s58, 11264
    s_add_u32 s59, s69, 24576
    buffer_load_dwordx4 v1, s[32:35], s59 offen lds
    s_lshl_b32 s69, s73, 5
    s_add_u32 m0, s58, 12288
    s_add_u32 s59, s69, 32768
    buffer_load_dwordx4 v1, s[32:35], s59 offen lds
    s_add_u32 m0, s58, 13312
    s_add_u32 s59, s69, 40960
    buffer_load_dwordx4 v1, s[32:35], s59 offen lds
    s_add_u32 m0, s58, 14336
    s_add_u32 s59, s69, 49152
    buffer_load_dwordx4 v1, s[32:35], s59 offen lds
    s_add_u32 m0, s58, 15360
    s_add_u32 s59, s69, 57344
    buffer_load_dwordx4 v1, s[32:35], s59 offen lds
    s_lshl_b32 s69, s74, 5
    s_add_u32 m0, s58, 16384
    s_add_u32 s59, s69, 0
    buffer_load_dwordx4 v1, s[32:35], s59 offen lds
    s_add_u32 m0, s58, 17408
    s_add_u32 s59, s69, 8192
    buffer_load_dwordx4 v1, s[32:35], s59 offen lds
    s_add_u32 m0, s58, 18432
    s_add_u32 s59, s69, 16384
    buffer_load_dwordx4 v1, s[32:35], s59 offen lds
    s_add_u32 m0, s58, 19456
    s_add_u32 s59, s69, 24576
    buffer_load_dwordx4 v1, s[32:35], s59 offen lds
    s_lshl_b32 s69, s74, 5
    s_add_u32 m0, s58, 20480
    s_add_u32 s59, s69, 32768
    buffer_load_dwordx4 v1, s[32:35], s59 offen lds
    s_add_u32 m0, s58, 21504
    s_add_u32 s59, s69, 40960
    buffer_load_dwordx4 v1, s[32:35], s59 offen lds
    s_add_u32 m0, s58, 22528
    s_add_u32 s59, s69, 49152
    buffer_load_dwordx4 v1, s[32:35], s59 offen lds
    s_add_u32 m0, s58, 23552
    s_add_u32 s59, s69, 57344
    buffer_load_dwordx4 v1, s[32:35], s59 offen lds
    s_lshl_b32 s69, s75, 5
    s_add_u32 m0, s58, 24576
    s_add_u32 s59, s69, 0
    buffer_load_dwordx4 v1, s[32:35], s59 offen lds
    s_add_u32 m0, s58, 25600
    s_add_u32 s59, s69, 8192
    buffer_load_dwordx4 v1, s[32:35], s59 offen lds
    s_add_u32 m0, s58, 26624
    s_add_u32 s59, s69, 16384
    buffer_load_dwordx4 v1, s[32:35], s59 offen lds
    s_add_u32 m0, s58, 27648
    s_add_u32 s59, s69, 24576
    buffer_load_dwordx4 v1, s[32:35], s59 offen lds
    s_lshl_b32 s69, s75, 5
    s_add_u32 m0, s58, 28672
    s_add_u32 s59, s69, 32768
    buffer_load_dwordx4 v1, s[32:35], s59 offen lds
    s_add_u32 m0, s58, 29696
    s_add_u32 s59, s69, 40960
    buffer_load_dwordx4 v1, s[32:35], s59 offen lds
    s_add_u32 m0, s58, 30720
    s_add_u32 s59, s69, 49152
    buffer_load_dwordx4 v1, s[32:35], s59 offen lds
    s_add_u32 m0, s58, 31744
    s_add_u32 s59, s69, 57344
    buffer_load_dwordx4 v1, s[32:35], s59 offen lds
    s_waitcnt vmcnt(28)
    ds_read_b64_tr_b16 a[0:1], v4 offset:0
    ds_read_b64_tr_b16 a[2:3], v4 offset:2048
    ds_read_b64_tr_b16 a[4:5], v4 offset:32
    ds_read_b64_tr_b16 a[6:7], v4 offset:2080
    ds_read_b64_tr_b16 a[8:9], v4 offset:64
    ds_read_b64_tr_b16 a[10:11], v4 offset:2112
    ds_read_b64_tr_b16 a[12:13], v4 offset:96
    ds_read_b64_tr_b16 a[14:15], v4 offset:2144
    s_waitcnt lgkmcnt(0)
    s_lshl_b32 s69, s76, 5
    s_add_u32 m0, s58, 0
    s_add_u32 s59, s69, 0
    buffer_load_dwordx4 v1, s[32:35], s59 offen lds
    s_add_u32 m0, s58, 1024
    s_add_u32 s59, s69, 8192
    buffer_load_dwordx4 v1, s[32:35], s59 offen lds
    s_add_u32 m0, s58, 2048
    s_add_u32 s59, s69, 16384
    buffer_load_dwordx4 v1, s[32:35], s59 offen lds
    s_add_u32 m0, s58, 3072
    s_add_u32 s59, s69, 24576
    buffer_load_dwordx4 v1, s[32:35], s59 offen lds
    s_waitcnt vmcnt(28)
    ds_read_b64_tr_b16 a[16:17], v4 offset:4096
    ds_read_b64_tr_b16 a[18:19], v4 offset:6144
    ds_read_b64_tr_b16 a[20:21], v4 offset:4128
    ds_read_b64_tr_b16 a[22:23], v4 offset:6176
    ds_read_b64_tr_b16 a[24:25], v4 offset:4160
    ds_read_b64_tr_b16 a[26:27], v4 offset:6208
    ds_read_b64_tr_b16 a[28:29], v4 offset:4192
    ds_read_b64_tr_b16 a[30:31], v4 offset:6240
    s_waitcnt lgkmcnt(0)
    s_lshl_b32 s69, s76, 5
    s_add_u32 m0, s58, 4096
    s_add_u32 s59, s69, 32768
    buffer_load_dwordx4 v1, s[32:35], s59 offen lds
    s_add_u32 m0, s58, 5120
    s_add_u32 s59, s69, 40960
    buffer_load_dwordx4 v1, s[32:35], s59 offen lds
    s_add_u32 m0, s58, 6144
    s_add_u32 s59, s69, 49152
    buffer_load_dwordx4 v1, s[32:35], s59 offen lds
    s_add_u32 m0, s58, 7168
    s_add_u32 s59, s69, 57344
    buffer_load_dwordx4 v1, s[32:35], s59 offen lds
    s_waitcnt vmcnt(28)
    ds_read_b64_tr_b16 a[32:33], v4 offset:8192
    ds_read_b64_tr_b16 a[34:35], v4 offset:10240
    ds_read_b64_tr_b16 a[36:37], v4 offset:8224
    ds_read_b64_tr_b16 a[38:39], v4 offset:10272
    ds_read_b64_tr_b16 a[40:41], v4 offset:8256
    ds_read_b64_tr_b16 a[42:43], v4 offset:10304
    ds_read_b64_tr_b16 a[44:45], v4 offset:8288
    ds_read_b64_tr_b16 a[46:47], v4 offset:10336
    s_waitcnt lgkmcnt(0)
    s_lshl_b32 s69, s77, 5
    s_add_u32 m0, s58, 8192
    s_add_u32 s59, s69, 0
    buffer_load_dwordx4 v1, s[32:35], s59 offen lds
    s_add_u32 m0, s58, 9216
    s_add_u32 s59, s69, 8192
    buffer_load_dwordx4 v1, s[32:35], s59 offen lds
    s_add_u32 m0, s58, 10240
    s_add_u32 s59, s69, 16384
    buffer_load_dwordx4 v1, s[32:35], s59 offen lds
    s_add_u32 m0, s58, 11264
    s_add_u32 s59, s69, 24576
    buffer_load_dwordx4 v1, s[32:35], s59 offen lds
    s_waitcnt vmcnt(28)
    ds_read_b64_tr_b16 a[48:49], v4 offset:12288
    ds_read_b64_tr_b16 a[50:51], v4 offset:14336
    ds_read_b64_tr_b16 a[52:53], v4 offset:12320
    ds_read_b64_tr_b16 a[54:55], v4 offset:14368
    ds_read_b64_tr_b16 a[56:57], v4 offset:12352
    ds_read_b64_tr_b16 a[58:59], v4 offset:14400
    ds_read_b64_tr_b16 a[60:61], v4 offset:12384
    ds_read_b64_tr_b16 a[62:63], v4 offset:14432
    s_waitcnt lgkmcnt(0)
    s_lshl_b32 s69, s77, 5
    s_add_u32 m0, s58, 12288
    s_add_u32 s59, s69, 32768
    buffer_load_dwordx4 v1, s[32:35], s59 offen lds
    s_add_u32 m0, s58, 13312
    s_add_u32 s59, s69, 40960
    buffer_load_dwordx4 v1, s[32:35], s59 offen lds
    s_add_u32 m0, s58, 14336
    s_add_u32 s59, s69, 49152
    buffer_load_dwordx4 v1, s[32:35], s59 offen lds
    s_add_u32 m0, s58, 15360
    s_add_u32 s59, s69, 57344
    buffer_load_dwordx4 v1, s[32:35], s59 offen lds
    s_waitcnt vmcnt(28)
    ds_read_b64_tr_b16 a[64:65], v4 offset:16384
    ds_read_b64_tr_b16 a[66:67], v4 offset:18432
    ds_read_b64_tr_b16 a[68:69], v4 offset:16416
    ds_read_b64_tr_b16 a[70:71], v4 offset:18464
    ds_read_b64_tr_b16 a[72:73], v4 offset:16448
    ds_read_b64_tr_b16 a[74:75], v4 offset:18496
    ds_read_b64_tr_b16 a[76:77], v4 offset:16480
    ds_read_b64_tr_b16 a[78:79], v4 offset:18528
    s_waitcnt lgkmcnt(0)
    s_lshl_b32 s69, s78, 5
    s_add_u32 m0, s58, 16384
    s_add_u32 s59, s69, 0
    buffer_load_dwordx4 v1, s[32:35], s59 offen lds
    s_add_u32 m0, s58, 17408
    s_add_u32 s59, s69, 8192
    buffer_load_dwordx4 v1, s[32:35], s59 offen lds
    s_add_u32 m0, s58, 18432
    s_add_u32 s59, s69, 16384
    buffer_load_dwordx4 v1, s[32:35], s59 offen lds
    s_add_u32 m0, s58, 19456
    s_add_u32 s59, s69, 24576
    buffer_load_dwordx4 v1, s[32:35], s59 offen lds
    s_waitcnt vmcnt(28)
    ds_read_b64_tr_b16 a[80:81], v4 offset:20480
    ds_read_b64_tr_b16 a[82:83], v4 offset:22528
    ds_read_b64_tr_b16 a[84:85], v4 offset:20512
    ds_read_b64_tr_b16 a[86:87], v4 offset:22560
    ds_read_b64_tr_b16 a[88:89], v4 offset:20544
    ds_read_b64_tr_b16 a[90:91], v4 offset:22592
    ds_read_b64_tr_b16 a[92:93], v4 offset:20576
    ds_read_b64_tr_b16 a[94:95], v4 offset:22624
    s_waitcnt lgkmcnt(0)
    s_lshl_b32 s69, s78, 5
    s_add_u32 m0, s58, 20480
    s_add_u32 s59, s69, 32768
    buffer_load_dwordx4 v1, s[32:35], s59 offen lds
    s_add_u32 m0, s58, 21504
    s_add_u32 s59, s69, 40960
    buffer_load_dwordx4 v1, s[32:35], s59 offen lds
    s_add_u32 m0, s58, 22528
    s_add_u32 s59, s69, 49152
    buffer_load_dwordx4 v1, s[32:35], s59 offen lds
    s_add_u32 m0, s58, 23552
    s_add_u32 s59, s69, 57344
    buffer_load_dwordx4 v1, s[32:35], s59 offen lds
    s_waitcnt vmcnt(28)
    ds_read_b64_tr_b16 a[96:97], v4 offset:24576
    ds_read_b64_tr_b16 a[98:99], v4 offset:26624
    ds_read_b64_tr_b16 a[100:101], v4 offset:24608
    ds_read_b64_tr_b16 a[102:103], v4 offset:26656
    ds_read_b64_tr_b16 a[104:105], v4 offset:24640
    ds_read_b64_tr_b16 a[106:107], v4 offset:26688
    ds_read_b64_tr_b16 a[108:109], v4 offset:24672
    ds_read_b64_tr_b16 a[110:111], v4 offset:26720
    s_waitcnt vmcnt(24)
    ds_read_b64_tr_b16 a[112:113], v4 offset:28672
    ds_read_b64_tr_b16 a[114:115], v4 offset:30720
    ds_read_b64_tr_b16 a[116:117], v4 offset:28704
    ds_read_b64_tr_b16 a[118:119], v4 offset:30752
    ds_read_b64_tr_b16 a[120:121], v4 offset:28736
    ds_read_b64_tr_b16 a[122:123], v4 offset:30784
    ds_read_b64_tr_b16 a[124:125], v4 offset:28768
    ds_read_b64_tr_b16 a[126:127], v4 offset:30816
    s_waitcnt vmcnt(20)
    ds_read_b64_tr_b16 a[128:129], v4 offset:0
    ds_read_b64_tr_b16 a[130:131], v4 offset:2048
    ds_read_b64_tr_b16 a[132:133], v4 offset:32
    ds_read_b64_tr_b16 a[134:135], v4 offset:2080
    ds_read_b64_tr_b16 a[136:137], v4 offset:64
    ds_read_b64_tr_b16 a[138:139], v4 offset:2112
    ds_read_b64_tr_b16 a[140:141], v4 offset:96
    ds_read_b64_tr_b16 a[142:143], v4 offset:2144
    s_waitcnt vmcnt(16)
    ds_read_b64_tr_b16 a[144:145], v4 offset:4096
    ds_read_b64_tr_b16 a[146:147], v4 offset:6144
    ds_read_b64_tr_b16 a[148:149], v4 offset:4128
    ds_read_b64_tr_b16 a[150:151], v4 offset:6176
    ds_read_b64_tr_b16 a[152:153], v4 offset:4160
    ds_read_b64_tr_b16 a[154:155], v4 offset:6208
    ds_read_b64_tr_b16 a[156:157], v4 offset:4192
    ds_read_b64_tr_b16 a[158:159], v4 offset:6240
    s_waitcnt vmcnt(12)
    ds_read_b64_tr_b16 a[160:161], v4 offset:8192
    ds_read_b64_tr_b16 a[162:163], v4 offset:10240
    ds_read_b64_tr_b16 a[164:165], v4 offset:8224
    ds_read_b64_tr_b16 a[166:167], v4 offset:10272
    ds_read_b64_tr_b16 a[168:169], v4 offset:8256
    ds_read_b64_tr_b16 a[170:171], v4 offset:10304
    ds_read_b64_tr_b16 a[172:173], v4 offset:8288
    ds_read_b64_tr_b16 a[174:175], v4 offset:10336
    s_waitcnt vmcnt(8)
    ds_read_b64_tr_b16 a[176:177], v4 offset:12288
    ds_read_b64_tr_b16 a[178:179], v4 offset:14336
    ds_read_b64_tr_b16 a[180:181], v4 offset:12320
    ds_read_b64_tr_b16 a[182:183], v4 offset:14368
    ds_read_b64_tr_b16 a[184:185], v4 offset:12352
    ds_read_b64_tr_b16 a[186:187], v4 offset:14400
    ds_read_b64_tr_b16 a[188:189], v4 offset:12384
    ds_read_b64_tr_b16 a[190:191], v4 offset:14432
    s_waitcnt vmcnt(4)
    ds_read_b64_tr_b16 a[192:193], v4 offset:16384
    ds_read_b64_tr_b16 a[194:195], v4 offset:18432
    ds_read_b64_tr_b16 a[196:197], v4 offset:16416
    ds_read_b64_tr_b16 a[198:199], v4 offset:18464
    ds_read_b64_tr_b16 a[200:201], v4 offset:16448
    ds_read_b64_tr_b16 a[202:203], v4 offset:18496
    ds_read_b64_tr_b16 a[204:205], v4 offset:16480
    ds_read_b64_tr_b16 a[206:207], v4 offset:18528
    s_waitcnt vmcnt(0)
    ds_read_b64_tr_b16 a[208:209], v4 offset:20480
    ds_read_b64_tr_b16 a[210:211], v4 offset:22528
    ds_read_b64_tr_b16 a[212:213], v4 offset:20512
    ds_read_b64_tr_b16 a[214:215], v4 offset:22560
    ds_read_b64_tr_b16 a[216:217], v4 offset:20544
    ds_read_b64_tr_b16 a[218:219], v4 offset:22592
    ds_read_b64_tr_b16 a[220:221], v4 offset:20576
    ds_read_b64_tr_b16 a[222:223], v4 offset:22624
    s_cmp_lg_u32 s54, 0
    s_cbranch_scc1 dnrd_ok
dnrd_w:
    buffer_load_dword v127, off, s[24:27], s3 offset:8 sc1
    s_add_u32 s52, s52, 1
    s_waitcnt vmcnt(0)
    v_readfirstlane_b32 s59, v127
    s_nop 0
    s_cmp_ge_u32 s59, 3
    s_cbranch_scc1 dnrd_ok
    s_cmp_gt_u32 s52, 4194304
    s_cbranch_scc1 dnrd_ok
    s_sleep 1
    s_branch dnrd_w
dnrd_ok:
    s_barrier
    v_and_b32 v5, 15, v0
    v_lshrrev_b32 v6, 4, v0
    v_lshlrev_b32_e64 v7, 10, v5
    v_lshl_add_u32 v7, v6, 3, v7
    s_mul_i32 s59, s64, 128
    s_and_b32 s60, s54, 3
    s_lshl_b32 s60, s60, 5
    s_add_u32 s59, s59, s60
    v_add_u32 v7, s59, v7
    v_lshlrev_b32 v30, 4, v5
    v_lshrrev_b32 v8, 1, v6
    v_lshl_add_u32 v30, v8, 8, v30
    v_and_b32_e64 v8, 1, v6
    v_lshl_add_u32 v30, v8, 3, v30
    s_lshl_b32 s61, s59, 4
    v_add_u32 v30, s61, v30
    v_lshlrev_b32 v8, 4, v6
    s_lshl_b32 s59, s59, 1
    s_add_u32 s59, s59, 75776
    buffer_load_dwordx4 v[12:15], v8, s[24:27], s59 offen sc1
    s_mul_i32 s59, s54, 4096
    s_add_u32 s59, s59, 131072
    v_add_u32 v9, s59, v2
    s_lshl_b32 s59, s60, 5
    s_add_u32 s59, s59, 131072
    v_add_u32 v10, s59, v2
    v_min_u32 v11, 13, v0
    s_mul_i32 s59, s54, 14
    v_add_u32 v11, s59, v11
    v_lshlrev_b32 v11, 7, v11
    s_lshl_b32 s67, s65, 13
    s_add_u32 s67, s67, 7536640
    s_waitcnt vmcnt(0) lgkmcnt(0)
dn_loop:
    s_add_u32 s66, s65, 1
    s_mul_i32 s61, s65, 57344
    s_add_u32 s61, s61, 8388608
    s_lshl_b32 s69, s65, 14
    s_add_u32 s60, s69, 3145728
dn_pw:
    buffer_load_dword v127, v11, s[24:27], s67 offen sc1
    s_add_u32 s52, s52, 1
    s_cmp_gt_u32 s52, 4194304
    s_waitcnt vmcnt(0)
    v_cmp_gt_u32_e64 vcc, s66, v127
    s_cbranch_scc1 dn_pk
    s_cbranch_vccz dn_pk
    s_sleep 1
    s_branch dn_pw
dn_pk:
    s_add_u32 s59, s61, s72
    buffer_load_dwordx4 v[128:131], v2, s[24:27], s59 offen offset:0 sc1
    buffer_load_dwordx4 v[132:135], v2, s[24:27], s59 offen offset:1024 sc1
    s_add_u32 s59, s61, s73
    buffer_load_dwordx4 v[136:139], v2, s[24:27], s59 offen offset:0 sc1
    buffer_load_dwordx4 v[140:143], v2, s[24:27], s59 offen offset:1024 sc1
    s_add_u32 s59, s61, s74
    buffer_load_dwordx4 v[144:147], v2, s[24:27], s59 offen offset:0 sc1
    buffer_load_dwordx4 v[148:151], v2, s[24:27], s59 offen offset:1024 sc1
    s_add_u32 s59, s61, s75
    buffer_load_dwordx4 v[152:155], v2, s[24:27], s59 offen offset:0 sc1
    buffer_load_dwordx4 v[156:159], v2, s[24:27], s59 offen offset:1024 sc1
    s_add_u32 s59, s61, s76
    buffer_load_dwordx4 v[160:163], v2, s[24:27], s59 offen offset:0 sc1
    buffer_load_dwordx4 v[164:167], v2, s[24:27], s59 offen offset:1024 sc1
    s_add_u32 s59, s61, s77
    buffer_load_dwordx4 v[168:171], v2, s[24:27], s59 offen offset:0 sc1
    buffer_load_dwordx4 v[172:175], v2, s[24:27], s59 offen offset:1024 sc1
    s_add_u32 s59, s61, s78
    buffer_load_dwordx4 v[176:179], v2, s[24:27], s59 offen offset:0 sc1
    buffer_load_dwordx4 v[180:183], v2, s[24:27], s59 offen offset:1024 sc1
    buffer_load_dwordx2 v[24:25], v30, s[24:27], s60 offen sc1
    s_waitcnt vmcnt(14)
    v_mfma_f32_16x16x32_bf16 v[64:67], a[0:3], v[128:131], 0
    v_mfma_f32_16x16x32_bf16 v[68:71], a[4:7], v[128:131], 0
    v_mfma_f32_16x16x32_bf16 v[72:75], a[8:11], v[128:131], 0
    v_mfma_f32_16x16x32_bf16 v[76:79], a[12:15], v[128:131], 0
    s_waitcnt vmcnt(13)
    v_mfma_f32_16x16x32_bf16 v[64:67], a[16:19], v[132:135], v[64:67]
    v_mfma_f32_16x16x32_bf16 v[68:71], a[20:23], v[132:135], v[68:71]
    v_mfma_f32_16x16x32_bf16 v[72:75], a[24:27], v[132:135], v[72:75]
    v_mfma_f32_16x16x32_bf16 v[76:79], a[28:31], v[132:135], v[76:79]
    s_waitcnt vmcnt(12)
    v_mfma_f32_16x16x32_bf16 v[64:67], a[32:35], v[136:139], v[64:67]
    v_mfma_f32_16x16x32_bf16 v[68:71], a[36:39], v[136:139], v[68:71]
    v_mfma_f32_16x16x32_bf16 v[72:75], a[40:43], v[136:139], v[72:75]
    v_mfma_f32_16x16x32_bf16 v[76:79], a[44:47], v[136:139], v[76:79]
    s_waitcnt vmcnt(11)
    v_mfma_f32_16x16x32_bf16 v[64:67], a[48:51], v[140:143], v[64:67]
    v_mfma_f32_16x16x32_bf16 v[68:71], a[52:55], v[140:143], v[68:71]
    v_mfma_f32_16x16x32_bf16 v[72:75], a[56:59], v[140:143], v[72:75]
    v_mfma_f32_16x16x32_bf16 v[76:79], a[60:63], v[140:143], v[76:79]
    s_waitcnt vmcnt(10)
    v_mfma_f32_16x16x32_bf16 v[64:67], a[64:67], v[144:147], v[64:67]
    v_mfma_f32_16x16x32_bf16 v[68:71], a[68:71], v[144:147], v[68:71]
    v_mfma_f32_16x16x32_bf16 v[72:75], a[72:75], v[144:147], v[72:75]
    v_mfma_f32_16x16x32_bf16 v[76:79], a[76:79], v[144:147], v[76:79]
    s_waitcnt vmcnt(9)
    v_mfma_f32_16x16x32_bf16 v[64:67], a[80:83], v[148:151], v[64:67]
    v_mfma_f32_16x16x32_bf16 v[68:71], a[84:87], v[148:151], v[68:71]
    v_mfma_f32_16x16x32_bf16 v[72:75], a[88:91], v[148:151], v[72:75]
    v_mfma_f32_16x16x32_bf16 v[76:79], a[92:95], v[148:151], v[76:79]
    s_waitcnt vmcnt(8)
    v_mfma_f32_16x16x32_bf16 v[64:67], a[96:99], v[152:155], v[64:67]
    v_mfma_f32_16x16x32_bf16 v[68:71], a[100:103], v[152:155], v[68:71]
    v_mfma_f32_16x16x32_bf16 v[72:75], a[104:107], v[152:155], v[72:75]
    v_mfma_f32_16x16x32_bf16 v[76:79], a[108:111], v[152:155], v[76:79]
    s_waitcnt vmcnt(7)
    v_mfma_f32_16x16x32_bf16 v[64:67], a[112:115], v[156:159], v[64:67]
    v_mfma_f32_16x16x32_bf16 v[68:71], a[116:119], v[156:159], v[68:71]
    v_mfma_f32_16x16x32_bf16 v[72:75], a[120:123], v[156:159], v[72:75]
    v_mfma_f32_16x16x32_bf16 v[76:79], a[124:127], v[156:159], v[76:79]
    s_waitcnt vmcnt(6)
    v_mfma_f32_16x16x32_bf16 v[64:67], a[128:131], v[160:163], v[64:67]
    v_mfma_f32_16x16x32_bf16 v[68:71], a[132:135], v[160:163], v[68:71]
    v_mfma_f32_16x16x32_bf16 v[72:75], a[136:139], v[160:163], v[72:75]
    v_mfma_f32_16x16x32_bf16 v[76:79], a[140:143], v[160:163], v[76:79]
    s_waitcnt vmcnt(5)
    v_mfma_f32_16x16x32_bf16 v[64:67], a[144:147], v[164:167], v[64:67]
    v_mfma_f32_16x16x32_bf16 v[68:71], a[148:151], v[164:167], v[68:71]
    v_mfma_f32_16x16x32_bf16 v[72:75], a[152:155], v[164:167], v[72:75]
    v_mfma_f32_16x16x32_bf16 v[76:79], a[156:159], v[164:167], v[76:79]
    s_waitcnt vmcnt(4)
    v_mfma_f32_16x16x32_bf16 v[64:67], a[160:163], v[168:171], v[64:67]
    v_mfma_f32_16x16x32_bf16 v[68:71], a[164:167], v[168:171], v[68:71]
    v_mfma_f32_16x16x32_bf16 v[72:75], a[168:171], v[168:171], v[72:75]
    v_mfma_f32_16x16x32_bf16 v[76:79], a[172:175], v[168:171], v[76:79]
    s_waitcnt vmcnt(3)
    v_mfma_f32_16x16x32_bf16 v[64:67], a[176:179], v[172:175], v[64:67]
    v_mfma_f32_16x16x32_bf16 v[68:71], a[180:183], v[172:175], v[68:71]
    v_mfma_f32_16x16x32_bf16 v[72:75], a[184:187], v[172:175], v[72:75]
    v_mfma_f32_16x16x32_bf16 v[76:79], a[188:191], v[172:175], v[76:79]
    s_waitcnt vmcnt(2)
    v_mfma_f32_16x16x32_bf16 v[64:67], a[192:195], v[176:179], v[64:67]
    v_mfma_f32_16x16x32_bf16 v[68:71], a[196:199], v[176:179], v[68:71]
    v_mfma_f32_16x16x32_bf16 v[72:75], a[200:203], v[176:179], v[72:75]
    v_mfma_f32_16x16x32_bf16 v[76:79], a[204:207], v[176:179], v[76:79]
    s_waitcnt vmcnt(1)
    v_mfma_f32_16x16x32_bf16 v[64:67], a[208:211], v[180:183], v[64:67]
    v_mfma_f32_16x16x32_bf16 v[68:71], a[212:215], v[180:183], v[68:71]
    v_mfma_f32_16x16x32_bf16 v[72:75], a[216:219], v[180:183], v[72:75]
    v_mfma_f32_16x16x32_bf16 v[76:79], a[220:223], v[180:183], v[76:79]
    ds_write_b128 v9, v[64:67] offset:0
    ds_write_b128 v9, v[68:71] offset:1024
    s_nop 1
    ds_write_b128 v9, v[72:75] offset:2048
    s_nop 2
    ds_write_b128 v9, v[76:79] offset:3072
    s_waitcnt lgkmcnt(0)
    s_barrier
    ds_read_b128 v[32:35], v10 offset:0
    ds_read_b128 v[36:39], v10 offset:4096
    ds_read_b128 v[40:43], v10 offset:8192
    ds_read_b128 v[44:47], v10 offset:12288
    s_waitcnt lgkmcnt(0) vmcnt(0)
    s_barrier
    v_add_f32 v32, v32, v36
    v_add_f32 v40, v40, v44
    v_add_f32 v33, v33, v37
    v_add_f32 v41, v41, v45
    v_add_f32 v34, v34, v38
    v_add_f32 v42, v42, v46
    v_add_f32 v35, v35, v39
    v_add_f32 v43, v43, v47
    v_add_f32 v32, v32, v40
    v_add_f32 v33, v33, v41
    v_add_f32 v34, v34, v42
    v_add_f32 v35, v35, v43
    v_cvt_pk_bf16_f32 v26, v32, v33
    v_lshlrev_b32_e64 v32, 16, v26
    v_and_b32 v33, 0xffff0000, v26
    v_cvt_pk_bf16_f32 v26, v34, v35
    v_lshlrev_b32_e64 v34, 16, v26
    v_and_b32 v35, 0xffff0000, v26
    v_mul_f32 v32, v32, v12
    v_mul_f32 v33, v33, v13
    v_mul_f32 v34, v34, v14
    v_mul_f32 v35, v35, v15
    v_cvt_pk_bf16_f32 v26, v32, v33
    v_lshlrev_b32_e64 v32, 16, v26
    v_and_b32 v33, 0xffff0000, v26
    v_cvt_pk_bf16_f32 v26, v34, v35
    v_lshlrev_b32_e64 v34, 16, v26
    v_and_b32 v35, 0xffff0000, v26
    v_lshlrev_b32_e64 v26, 16, v24
    v_and_b32 v27, 0xffff0000, v24
    v_lshlrev_b32_e64 v28, 16, v25
    v_and_b32 v29, 0xffff0000, v25
    v_add_f32 v32, v32, v26
    v_add_f32 v33, v33, v27
    v_add_f32 v34, v34, v28
    v_add_f32 v35, v35, v29
    v_cvt_pk_bf16_f32 v24, v32, v33
    v_cvt_pk_bf16_f32 v25, v34, v35
    s_add_u32 s60, s69, 0
    buffer_store_dwordx2 v[24:25], v7, s[40:43], s60 offen
dn_next:
    s_add_u32 s65, s65, 4
    s_cmp_lt_u32 s65, 128
    s_cbranch_scc1 dn_loop
    s_branch main_done
up_start:
    s_and_b32 s64, s63, 15
    s_lshr_b32 s65, s63, 5
    s_cmp_lt_u32 s64, 14
    s_cbranch_scc0 main_done
    s_load_dwordx4 s[4:7], s[0:1], 64
    s_waitcnt lgkmcnt(0)
    s_mov_b32 s32, s4
    s_and_b32 s33, s5, 0xffff
    s_mov_b32 s34, 1835008
    s_mov_b32 s35, 0x00020000
    s_mov_b32 s36, s6
    s_and_b32 s37, s7, 0xffff
    s_mov_b32 s38, 1835008
    s_mov_b32 s39, 0x00020000
    s_barrier
    s_lshl_b32 s58, s54, 15
    v_bfe_u32 v2, v0, 2, 1
    v_bfe_u32 v3, v0, 4, 1
    v_lshl_add_u32 v2, v3, 1, v2
    v_bfe_u32 v3, v0, 3, 1
    v_lshl_add_u32 v2, v3, 2, v2
    v_bfe_u32 v3, v0, 5, 1
    v_lshl_add_u32 v2, v3, 3, v2
    v_mul_u32_u24 v1, 3584, v2
    v_lshlrev_b32 v3, 1, v3
    v_xor_b32 v3, v3, v0
    v_and_b32 v3, 3, v3
    v_lshl_add_u32 v1, v3, 4, v1
    s_lshl_b32 s59, s64, 8
    s_lshl_b32 s60, s54, 6
    s_add_u32 s59, s59, s60
    v_add_u32 v1, s59, v1
    v_bfe_u32 v2, v0, 5, 1
    v_lshlrev_b32_e64 v4, 10, v2
    v_bfe_u32 v2, v0, 3, 1
    v_mul_u32_u24 v2, 544, v2
    v_add_u32_e64 v4, v4, v2
    v_bfe_u32 v2, v0, 4, 1
    v_lshl_add_u32 v4, v2, 7, v4
    v_bfe_u32 v2, v0, 2, 1
    v_lshl_add_u32 v4, v2, 6, v4
    v_and_b32_e64 v2, 3, v0
    v_lshl_add_u32 v4, v2, 3, v4
    v_add_u32 v4, s58, v4
    v_xor_b32_e64 v5, 32, v4
    s_waitcnt vmcnt(0)
    s_add_u32 m0, s58, 0
    s_mov_b32 s59, 0
    buffer_load_dwordx4 v1, s[32:35], s59 offen lds
    s_add_u32 m0, s58, 1024
    s_mov_b32 s59, 57344
    buffer_load_dwordx4 v1, s[32:35], s59 offen lds
    s_add_u32 m0, s58, 2048
    s_mov_b32 s59, 114688
    buffer_load_dwordx4 v1, s[32:35], s59 offen lds
    s_add_u32 m0, s58, 3072
    s_mov_b32 s59, 172032
    buffer_load_dwordx4 v1, s[32:35], s59 offen lds
    s_add_u32 m0, s58, 4096
    s_mov_b32 s59, 229376
    buffer_load_dwordx4 v1, s[32:35], s59 offen lds
    s_add_u32 m0, s58, 5120
    s_mov_b32 s59, 286720
    buffer_load_dwordx4 v1, s[32:35], s59 offen lds
    s_add_u32 m0, s58, 6144
    s_mov_b32 s59, 344064
    buffer_load_dwordx4 v1, s[32:35], s59 offen lds
    s_add_u32 m0, s58, 7168
    s_mov_b32 s59, 401408
    buffer_load_dwordx4 v1, s[32:35], s59 offen lds
    s_add_u32 m0, s58, 8192
    s_mov_b32 s59, 458752
    buffer_load_dwordx4 v1, s[32:35], s59 offen lds
    s_add_u32 m0, s58, 9216
    s_mov_b32 s59, 516096
    buffer_load_dwordx4 v1, s[32:35], s59 offen lds
    s_add_u32 m0, s58, 10240
    s_mov_b32 s59, 573440
    buffer_load_dwordx4 v1, s[32:35], s59 offen lds
    s_add_u32 m0, s58, 11264
    s_mov_b32 s59, 630784
    buffer_load_dwordx4 v1, s[32:35], s59 offen lds
    s_add_u32 m0, s58, 12288
    s_mov_b32 s59, 688128
    buffer_load_dwordx4 v1, s[32:35], s59 offen lds
    s_add_u32 m0, s58, 13312
    s_mov_b32 s59, 745472
    buffer_load_dwordx4 v1, s[32:35], s59 offen lds
    s_add_u32 m0, s58, 14336
    s_mov_b32 s59, 802816
    buffer_load_dwordx4 v1, s[32:35], s59 offen lds
    s_add_u32 m0, s58, 15360
    s_mov_b32 s59, 860160
    buffer_load_dwordx4 v1, s[32:35], s59 offen lds
    s_add_u32 m0, s58, 16384
    s_mov_b32 s59, 917504
    buffer_load_dwordx4 v1, s[32:35], s59 offen lds
    s_add_u32 m0, s58, 17408
    s_mov_b32 s59, 974848
    buffer_load_dwordx4 v1, s[32:35], s59 offen lds
    s_add_u32 m0, s58, 18432
    s_mov_b32 s59, 1032192
    buffer_load_dwordx4 v1, s[32:35], s59 offen lds
    s_add_u32 m0, s58, 19456
    s_mov_b32 s59, 1089536
    buffer_load_dwordx4 v1, s[32:35], s59 offen lds
    s_add_u32 m0, s58, 20480
    s_mov_b32 s59, 1146880
    buffer_load_dwordx4 v1, s[32:35], s59 offen lds
    s_add_u32 m0, s58, 21504
    s_mov_b32 s59, 1204224
    buffer_load_dwordx4 v1, s[32:35], s59 offen lds
    s_add_u32 m0, s58, 22528
    s_mov_b32 s59, 1261568
    buffer_load_dwordx4 v1, s[32:35], s59 offen lds
    s_add_u32 m0, s58, 23552
    s_mov_b32 s59, 1318912
    buffer_load_dwordx4 v1, s[32:35], s59 offen lds
    s_add_u32 m0, s58, 24576
    s_mov_b32 s59, 1376256
    buffer_load_dwordx4 v1, s[32:35], s59 offen lds
    s_add_u32 m0, s58, 25600
    s_mov_b32 s59, 1433600
    buffer_load_dwordx4 v1, s[32:35], s59 offen lds
    s_add_u32 m0, s58, 26624
    s_mov_b32 s59, 1490944
    buffer_load_dwordx4 v1, s[32:35], s59 offen lds
    s_add_u32 m0, s58, 27648
    s_mov_b32 s59, 1548288
    buffer_load_dwordx4 v1, s[32:35], s59 offen lds
    s_add_u32 m0, s58, 28672
    s_mov_b32 s59, 1605632
    buffer_load_dwordx4 v1, s[32:35], s59 offen lds
    s_add_u32 m0, s58, 29696
    s_mov_b32 s59, 1662976
    buffer_load_dwordx4 v1, s[32:35], s59 offen lds
    s_add_u32 m0, s58, 30720
    s_mov_b32 s59, 1720320
    buffer_load_dwordx4 v1, s[32:35], s59 offen lds
    s_add_u32 m0, s58, 31744
    s_mov_b32 s59, 1777664
    buffer_load_dwordx4 v1, s[32:35], s59 offen lds
    s_waitcnt vmcnt(28)
    ds_read_b64_tr_b16 a[0:1], v4 offset:0
    ds_read_b64_tr_b16 a[2:3], v4 offset:256
    ds_read_b64_tr_b16 a[4:5], v4 offset:2048
    ds_read_b64_tr_b16 a[6:7], v4 offset:2304
    ds_read_b64_tr_b16 a[64:65], v5 offset:0
    ds_read_b64_tr_b16 a[66:67], v5 offset:256
    ds_read_b64_tr_b16 a[68:69], v5 offset:2048
    ds_read_b64_tr_b16 a[70:71], v5 offset:2304
    s_waitcnt lgkmcnt(0)
    s_add_u32 m0, s58, 0
    s_mov_b32 s59, 0
    buffer_load_dwordx4 v1, s[36:39], s59 offen lds
    s_add_u32 m0, s58, 1024
    s_mov_b32 s59, 57344
    buffer_load_dwordx4 v1, s[36:39], s59 offen lds
    s_add_u32 m0, s58, 2048
    s_mov_b32 s59, 114688
    buffer_load_dwordx4 v1, s[36:39], s59 offen lds
    s_add_u32 m0, s58, 3072
    s_mov_b32 s59, 172032
    buffer_load_dwordx4 v1, s[36:39], s59 offen lds
    s_waitcnt vmcnt(28)
    ds_read_b64_tr_b16 a[8:9], v4 offset:4096
    ds_read_b64_tr_b16 a[10:11], v4 offset:4352
    ds_read_b64_tr_b16 a[12:13], v4 offset:6144
    ds_read_b64_tr_b16 a[14:15], v4 offset:6400
    ds_read_b64_tr_b16 a[72:73], v5 offset:4096
    ds_read_b64_tr_b16 a[74:75], v5 offset:4352
    ds_read_b64_tr_b16 a[76:77], v5 offset:6144
    ds_read_b64_tr_b16 a[78:79], v5 offset:6400
    s_waitcnt lgkmcnt(0)
    s_add_u32 m0, s58, 4096
    s_mov_b32 s59, 229376
    buffer_load_dwordx4 v1, s[36:39], s59 offen lds
    s_add_u32 m0, s58, 5120
    s_mov_b32 s59, 286720
    buffer_load_dwordx4 v1, s[36:39], s59 offen lds
    s_add_u32 m0, s58, 6144
    s_mov_b32 s59, 344064
    buffer_load_dwordx4 v1, s[36:39], s59 offen lds
    s_add_u32 m0, s58, 7168
    s_mov_b32 s59, 401408
    buffer_load_dwordx4 v1, s[36:39], s59 offen lds
    s_waitcnt vmcnt(28)
    ds_read_b64_tr_b16 a[16:17], v4 offset:8192
    ds_read_b64_tr_b16 a[18:19], v4 offset:8448
    ds_read_b64_tr_b16 a[20:21], v4 offset:10240
    ds_read_b64_tr_b16 a[22:23], v4 offset:10496
    ds_read_b64_tr_b16 a[80:81], v5 offset:8192
    ds_read_b64_tr_b16 a[82:83], v5 offset:8448
    ds_read_b64_tr_b16 a[84:85], v5 offset:10240
    ds_read_b64_tr_b16 a[86:87], v5 offset:10496
    s_waitcnt lgkmcnt(0)
    s_add_u32 m0, s58, 8192
    s_mov_b32 s59, 458752
    buffer_load_dwordx4 v1, s[36:39], s59 offen lds
    s_add_u32 m0, s58, 9216
    s_mov_b32 s59, 516096
    buffer_load_dwordx4 v1, s[36:39], s59 offen lds
    s_add_u32 m0, s58, 10240
    s_mov_b32 s59, 573440
    buffer_load_dwordx4 v1, s[36:39], s59 offen lds
    s_add_u32 m0, s58, 11264
    s_mov_b32 s59, 630784
    buffer_load_dwordx4 v1, s[36:39], s59 offen lds
    s_waitcnt vmcnt(28)
    ds_read_b64_tr_b16 a[24:25], v4 offset:12288
    ds_read_b64_tr_b16 a[26:27], v4 offset:12544
    ds_read_b64_tr_b16 a[28:29], v4 offset:14336
    ds_read_b64_tr_b16 a[30:31], v4 offset:14592
    ds_read_b64_tr_b16 a[88:89], v5 offset:12288
    ds_read_b64_tr_b16 a[90:91], v5 offset:12544
    ds_read_b64_tr_b16 a[92:93], v5 offset:14336
    ds_read_b64_tr_b16 a[94:95], v5 offset:14592
    s_waitcnt lgkmcnt(0)
    s_add_u32 m0, s58, 12288
    s_mov_b32 s59, 688128
    buffer_load_dwordx4 v1, s[36:39], s59 offen lds
    s_add_u32 m0, s58, 13312
    s_mov_b32 s59, 745472
    buffer_load_dwordx4 v1, s[36:39], s59 offen lds
    s_add_u32 m0, s58, 14336
    s_mov_b32 s59, 802816
    buffer_load_dwordx4 v1, s[36:39], s59 offen lds
    s_add_u32 m0, s58, 15360
    s_mov_b32 s59, 860160
    buffer_load_dwordx4 v1, s[36:39], s59 offen lds
    s_waitcnt vmcnt(28)
    ds_read_b64_tr_b16 a[32:33], v4 offset:16384
    ds_read_b64_tr_b16 a[34:35], v4 offset:16640
    ds_read_b64_tr_b16 a[36:37], v4 offset:18432
    ds_read_b64_tr_b16 a[38:39], v4 offset:18688
    ds_read_b64_tr_b16 a[96:97], v5 offset:16384
    ds_read_b64_tr_b16 a[98:99], v5 offset:16640
    ds_read_b64_tr_b16 a[100:101], v5 offset:18432
    ds_read_b64_tr_b16 a[102:103], v5 offset:18688
    s_waitcnt lgkmcnt(0)
    s_add_u32 m0, s58, 16384
    s_mov_b32 s59, 917504
    buffer_load_dwordx4 v1, s[36:39], s59 offen lds
    s_add_u32 m0, s58, 17408
    s_mov_b32 s59, 974848
    buffer_load_dwordx4 v1, s[36:39], s59 offen lds
    s_add_u32 m0, s58, 18432
    s_mov_b32 s59, 1032192
    buffer_load_dwordx4 v1, s[36:39], s59 offen lds
    s_add_u32 m0, s58, 19456
    s_mov_b32 s59, 1089536
    buffer_load_dwordx4 v1, s[36:39], s59 offen lds
    s_waitcnt vmcnt(28)
    ds_read_b64_tr_b16 a[40:41], v4 offset:20480
    ds_read_b64_tr_b16 a[42:43], v4 offset:20736
    ds_read_b64_tr_b16 a[44:45], v4 offset:22528
    ds_read_b64_tr_b16 a[46:47], v4 offset:22784
    ds_read_b64_tr_b16 a[104:105], v5 offset:20480
    ds_read_b64_tr_b16 a[106:107], v5 offset:20736
    ds_read_b64_tr_b16 a[108:109], v5 offset:22528
    ds_read_b64_tr_b16 a[110:111], v5 offset:22784
    s_waitcnt lgkmcnt(0)
    s_add_u32 m0, s58, 20480
    s_mov_b32 s59, 1146880
    buffer_load_dwordx4 v1, s[36:39], s59 offen lds
    s_add_u32 m0, s58, 21504
    s_mov_b32 s59, 1204224
    buffer_load_dwordx4 v1, s[36:39], s59 offen lds
    s_add_u32 m0, s58, 22528
    s_mov_b32 s59, 1261568
    buffer_load_dwordx4 v1, s[36:39], s59 offen lds
    s_add_u32 m0, s58, 23552
    s_mov_b32 s59, 1318912
    buffer_load_dwordx4 v1, s[36:39], s59 offen lds
    s_waitcnt vmcnt(28)
    ds_read_b64_tr_b16 a[48:49], v4 offset:24576
    ds_read_b64_tr_b16 a[50:51], v4 offset:24832
    ds_read_b64_tr_b16 a[52:53], v4 offset:26624
    ds_read_b64_tr_b16 a[54:55], v4 offset:26880
    ds_read_b64_tr_b16 a[112:113], v5 offset:24576
    ds_read_b64_tr_b16 a[114:115], v5 offset:24832
    ds_read_b64_tr_b16 a[116:117], v5 offset:26624
    ds_read_b64_tr_b16 a[118:119], v5 offset:26880
    s_waitcnt lgkmcnt(0)
    s_add_u32 m0, s58, 24576
    s_mov_b32 s59, 1376256
    buffer_load_dwordx4 v1, s[36:39], s59 offen lds
    s_add_u32 m0, s58, 25600
    s_mov_b32 s59, 1433600
    buffer_load_dwordx4 v1, s[36:39], s59 offen lds
    s_add_u32 m0, s58, 26624
    s_mov_b32 s59, 1490944
    buffer_load_dwordx4 v1, s[36:39], s59 offen lds
    s_add_u32 m0, s58, 27648
    s_mov_b32 s59, 1548288
    buffer_load_dwordx4 v1, s[36:39], s59 offen lds
    s_waitcnt vmcnt(28)
    ds_read_b64_tr_b16 a[56:57], v4 offset:28672
    ds_read_b64_tr_b16 a[58:59], v4 offset:28928
    ds_read_b64_tr_b16 a[60:61], v4 offset:30720
    ds_read_b64_tr_b16 a[62:63], v4 offset:30976
    ds_read_b64_tr_b16 a[120:121], v5 offset:28672
    ds_read_b64_tr_b16 a[122:123], v5 offset:28928
    ds_read_b64_tr_b16 a[124:125], v5 offset:30720
    ds_read_b64_tr_b16 a[126:127], v5 offset:30976
    s_waitcnt lgkmcnt(0)
    s_add_u32 m0, s58, 28672
    s_mov_b32 s59, 1605632
    buffer_load_dwordx4 v1, s[36:39], s59 offen lds
    s_add_u32 m0, s58, 29696
    s_mov_b32 s59, 1662976
    buffer_load_dwordx4 v1, s[36:39], s59 offen lds
    s_add_u32 m0, s58, 30720
    s_mov_b32 s59, 1720320
    buffer_load_dwordx4 v1, s[36:39], s59 offen lds
    s_add_u32 m0, s58, 31744
    s_mov_b32 s59, 1777664
    buffer_load_dwordx4 v1, s[36:39], s59 offen lds
    s_waitcnt vmcnt(28)
    ds_read_b64_tr_b16 a[128:129], v4 offset:0
    ds_read_b64_tr_b16 a[130:131], v4 offset:256
    ds_read_b64_tr_b16 a[132:133], v4 offset:2048
    ds_read_b64_tr_b16 a[134:135], v4 offset:2304
    ds_read_b64_tr_b16 a[192:193], v5 offset:0
    ds_read_b64_tr_b16 a[194:195], v5 offset:256
    ds_read_b64_tr_b16 a[196:197], v5 offset:2048
    ds_read_b64_tr_b16 a[198:199], v5 offset:2304
    s_waitcnt lgkmcnt(0)
    s_waitcnt vmcnt(24)
    ds_read_b64_tr_b16 a[136:137], v4 offset:4096
    ds_read_b64_tr_b16 a[138:139], v4 offset:4352
    ds_read_b64_tr_b16 a[140:141], v4 offset:6144
    ds_read_b64_tr_b16 a[142:143], v4 offset:6400
    ds_read_b64_tr_b16 a[200:201], v5 offset:4096
    ds_read_b64_tr_b16 a[202:203], v5 offset:4352
    ds_read_b64_tr_b16 a[204:205], v5 offset:6144
    ds_read_b64_tr_b16 a[206:207], v5 offset:6400
    s_waitcnt lgkmcnt(0)
    s_waitcnt vmcnt(20)
    ds_read_b64_tr_b16 a[144:145], v4 offset:8192
    ds_read_b64_tr_b16 a[146:147], v4 offset:8448
    ds_read_b64_tr_b16 a[148:149], v4 offset:10240
    ds_read_b64_tr_b16 a[150:151], v4 offset:10496
    ds_read_b64_tr_b16 a[208:209], v5 offset:8192
    ds_read_b64_tr_b16 a[210:211], v5 offset:8448
    ds_read_b64_tr_b16 a[212:213], v5 offset:10240
    ds_read_b64_tr_b16 a[214:215], v5 offset:10496
    s_waitcnt lgkmcnt(0)
    s_waitcnt vmcnt(16)
    ds_read_b64_tr_b16 a[152:153], v4 offset:12288
    ds_read_b64_tr_b16 a[154:155], v4 offset:12544
    ds_read_b64_tr_b16 a[156:157], v4 offset:14336
    ds_read_b64_tr_b16 a[158:159], v4 offset:14592
    ds_read_b64_tr_b16 a[216:217], v5 offset:12288
    ds_read_b64_tr_b16 a[218:219], v5 offset:12544
    ds_read_b64_tr_b16 a[220:221], v5 offset:14336
    ds_read_b64_tr_b16 a[222:223], v5 offset:14592
    s_waitcnt lgkmcnt(0)
    s_waitcnt vmcnt(12)
    ds_read_b64_tr_b16 a[160:161], v4 offset:16384
    ds_read_b64_tr_b16 a[162:163], v4 offset:16640
    ds_read_b64_tr_b16 a[164:165], v4 offset:18432
    ds_read_b64_tr_b16 a[166:167], v4 offset:18688
    ds_read_b64_tr_b16 a[224:225], v5 offset:16384
    ds_read_b64_tr_b16 a[226:227], v5 offset:16640
    ds_read_b64_tr_b16 a[228:229], v5 offset:18432
    ds_read_b64_tr_b16 a[230:231], v5 offset:18688
    s_waitcnt lgkmcnt(0)
    s_waitcnt vmcnt(8)
    ds_read_b64_tr_b16 a[168:169], v4 offset:20480
    ds_read_b64_tr_b16 a[170:171], v4 offset:20736
    ds_read_b64_tr_b16 a[172:173], v4 offset:22528
    ds_read_b64_tr_b16 a[174:175], v4 offset:22784
    ds_read_b64_tr_b16 a[232:233], v5 offset:20480
    ds_read_b64_tr_b16 a[234:235], v5 offset:20736
    ds_read_b64_tr_b16 a[236:237], v5 offset:22528
    ds_read_b64_tr_b16 a[238:239], v5 offset:22784
    s_waitcnt lgkmcnt(0)
    s_waitcnt vmcnt(4)
    ds_read_b64_tr_b16 a[176:177], v4 offset:24576
    ds_read_b64_tr_b16 a[178:179], v4 offset:24832
    ds_read_b64_tr_b16 a[180:181], v4 offset:26624
    ds_read_b64_tr_b16 a[182:183], v4 offset:26880
    ds_read_b64_tr_b16 a[240:241], v5 offset:24576
    ds_read_b64_tr_b16 a[242:243], v5 offset:24832
    ds_read_b64_tr_b16 a[244:245], v5 offset:26624
    ds_read_b64_tr_b16 a[246:247], v5 offset:26880
    s_waitcnt lgkmcnt(0)
    s_waitcnt vmcnt(0)
    ds_read_b64_tr_b16 a[184:185], v4 offset:28672
    ds_read_b64_tr_b16 a[186:187], v4 offset:28928
    ds_read_b64_tr_b16 a[188:189], v4 offset:30720
    ds_read_b64_tr_b16 a[190:191], v4 offset:30976
    ds_read_b64_tr_b16 a[248:249], v5 offset:28672
    ds_read_b64_tr_b16 a[250:251], v5 offset:28928
    ds_read_b64_tr_b16 a[252:253], v5 offset:30720
    ds_read_b64_tr_b16 a[254:255], v5 offset:30976
    s_waitcnt lgkmcnt(0)
    s_cmp_lg_u32 s54, 0
    s_cbranch_scc1 uprd_ok
uprd_w:
    buffer_load_dword v127, off, s[24:27], s3 offset:8 sc1
    s_add_u32 s52, s52, 1
    s_waitcnt vmcnt(0)
    v_readfirstlane_b32 s59, v127
    s_nop 0
    s_cmp_ge_u32 s59, 3
    s_cbranch_scc1 uprd_ok
    s_cmp_gt_u32 s52, 4194304
    s_cbranch_scc1 uprd_ok
    s_sleep 1
    s_branch uprd_w
uprd_ok:
    s_barrier
    v_and_b32 v1, 15, v0
    v_lshrrev_b32 v2, 4, v0
    v_lshlrev_b32_e64 v4, 10, v1
    v_lshl_add_u32 v4, v2, 4, v4
    s_lshl_b32 s59, s54, 8
    v_add_u32 v4, s59, v4
    v_lshlrev_b32 v5, 5, v2
    s_lshl_b32 s59, s54, 9
    v_add_u32 v5, s59, v5
    v_lshlrev_b32 v8, 2, v1
    v_add_u32 v8, 162816, v8
    s_lshl_b32 s59, s54, 6
    v_add_u32 v9, s59, v8
    v_lshlrev_b32_e64 v3, 4, v0
    s_mov_b32 s59, 73728
    s_mov_b32 s60, 71680
    buffer_load_dwordx4 v[64:67], v5, s[24:27], s59 offen offset:0 sc1
    buffer_load_dwordx4 v[96:99], v5, s[24:27], s60 offen offset:0 sc1
    buffer_load_dwordx4 v[68:71], v5, s[24:27], s59 offen offset:16 sc1
    buffer_load_dwordx4 v[100:103], v5, s[24:27], s60 offen offset:16 sc1
    buffer_load_dwordx4 v[72:75], v5, s[24:27], s59 offen offset:128 sc1
    buffer_load_dwordx4 v[104:107], v5, s[24:27], s60 offen offset:128 sc1
    buffer_load_dwordx4 v[76:79], v5, s[24:27], s59 offen offset:144 sc1
    buffer_load_dwordx4 v[108:111], v5, s[24:27], s60 offen offset:144 sc1
    buffer_load_dwordx4 v[80:83], v5, s[24:27], s59 offen offset:256 sc1
    buffer_load_dwordx4 v[112:115], v5, s[24:27], s60 offen offset:256 sc1
    buffer_load_dwordx4 v[84:87], v5, s[24:27], s59 offen offset:272 sc1
    buffer_load_dwordx4 v[116:119], v5, s[24:27], s60 offen offset:272 sc1
    buffer_load_dwordx4 v[88:91], v5, s[24:27], s59 offen offset:384 sc1
    buffer_load_dwordx4 v[120:123], v5, s[24:27], s60 offen offset:384 sc1
    buffer_load_dwordx4 v[92:95], v5, s[24:27], s59 offen offset:400 sc1
    buffer_load_dwordx4 v[124:127], v5, s[24:27], s60 offen offset:400 sc1
    v_and_b32 v15, 7, v0
    s_lshl_b32 s59, s54, 3
    v_add_u32 v15, s59, v15
    v_lshlrev_b32_e64 v15, 7, v15
    s_lshl_b32 s67, s65, 13
    s_add_u32 s68, s67, 7536640
    s_add_u32 s67, s67, 7471104
    s_lshl_b32 s59, s64, 9
    s_add_u32 s68, s68, s59
    s_lshl_b32 s59, s54, 7
    s_add_u32 s68, s68, s59
    s_lshl_b32 s59, s54, 12
    v_add_u32 v2, s59, v3
    s_waitcnt vmcnt(0)
    v_mov_b32 v224, v127
up_loop:
    s_add_u32 s66, s65, 1
    s_lshl_b32 s61, s65, 14
    s_add_u32 s61, s61, 3145728
up_pw:
    buffer_load_dword v127, v15, s[24:27], s67 offen sc1
    s_add_u32 s52, s52, 1
    s_cmp_gt_u32 s52, 4194304
    s_waitcnt vmcnt(0)
    v_cmp_gt_u32_e64 vcc, s66, v127
    s_cbranch_scc1 up_pk
    s_cbranch_vccz up_pk
    s_sleep 1
    s_branch up_pw
up_pk:
    buffer_load_dwordx4 v[16:19], v2, s[24:27], s61 offen offset:0 sc1
    buffer_load_dwordx4 v[20:23], v2, s[24:27], s61 offen offset:1024 sc1
    buffer_load_dwordx4 v[24:27], v2, s[24:27], s61 offen offset:2048 sc1
    buffer_load_dwordx4 v[28:31], v2, s[24:27], s61 offen offset:3072 sc1
    v_mov_b32 v127, v224
    s_waitcnt vmcnt(0)
    v_lshlrev_b32_e64 v32, 16, v16
    v_and_b32 v33, 0xffff0000, v16
    v_lshlrev_b32_e64 v34, 16, v17
    v_and_b32 v35, 0xffff0000, v17
    v_lshlrev_b32_e64 v36, 16, v18
    v_and_b32 v37, 0xffff0000, v18
    v_lshlrev_b32_e64 v38, 16, v19
    v_and_b32 v39, 0xffff0000, v19
    v_lshlrev_b32_e64 v40, 16, v20
    v_and_b32 v41, 0xffff0000, v20
    v_lshlrev_b32_e64 v42, 16, v21
    v_and_b32 v43, 0xffff0000, v21
    v_lshlrev_b32_e64 v44, 16, v22
    v_and_b32 v45, 0xffff0000, v22
    v_lshlrev_b32_e64 v46, 16, v23
    v_and_b32 v47, 0xffff0000, v23
    v_lshlrev_b32_e64 v48, 16, v24
    v_and_b32 v49, 0xffff0000, v24
    v_lshlrev_b32_e64 v50, 16, v25
    v_and_b32 v51, 0xffff0000, v25
    v_lshlrev_b32_e64 v52, 16, v26
    v_and_b32 v53, 0xffff0000, v26
    v_lshlrev_b32_e64 v54, 16, v27
    v_and_b32 v55, 0xffff0000, v27
    v_lshlrev_b32_e64 v56, 16, v28
    v_and_b32 v57, 0xffff0000, v28
    v_lshlrev_b32_e64 v58, 16, v29
    v_and_b32 v59, 0xffff0000, v29
    v_lshlrev_b32_e64 v60, 16, v30
    v_and_b32 v61, 0xffff0000, v30
    v_lshlrev_b32_e64 v62, 16, v31
    v_and_b32 v63, 0xffff0000, v31
    v_pk_add_f32 v[6:7], v[32:33], v[34:35]
    v_pk_add_f32 v[10:11], v[36:37], v[38:39]
    v_pk_add_f32 v[6:7], v[6:7], v[40:41]
    v_pk_add_f32 v[10:11], v[10:11], v[42:43]
    v_pk_add_f32 v[6:7], v[6:7], v[44:45]
    v_pk_add_f32 v[10:11], v[10:11], v[46:47]
    v_pk_add_f32 v[6:7], v[6:7], v[48:49]
    v_pk_add_f32 v[10:11], v[10:11], v[50:51]
    v_pk_add_f32 v[6:7], v[6:7], v[52:53]
    v_pk_add_f32 v[10:11], v[10:11], v[54:55]
    v_pk_add_f32 v[6:7], v[6:7], v[56:57]
    v_pk_add_f32 v[10:11], v[10:11], v[58:59]
    v_pk_add_f32 v[6:7], v[6:7], v[60:61]
    v_pk_add_f32 v[10:11], v[10:11], v[62:63]
    v_pk_add_f32 v[6:7], v[6:7], v[10:11]
    v_add_f32 v6, v6, v7
    v_mov_b32 v7, v6
    s_nop 1
    v_permlane16_swap_b32 v7, v6
    v_add_f32 v6, v7, v6
    v_mov_b32 v7, v6
    s_nop 1
    v_permlane32_swap_b32 v7, v6
    v_add_f32_e64 v6, v7, v6
    v_mul_f32 v6, 0x3c000000, v6
    v_pk_add_f32 v[12:13], v[32:33], v[6:7] op_sel_hi:[1,0] neg_lo:[0,1] neg_hi:[0,1]
    v_pk_mul_f32 v[10:11], v[12:13], v[12:13]
    v_pk_add_f32 v[12:13], v[34:35], v[6:7] op_sel_hi:[1,0] neg_lo:[0,1] neg_hi:[0,1]
    v_pk_fma_f32 v[10:11], v[12:13], v[12:13], v[10:11]
    v_pk_add_f32 v[12:13], v[36:37], v[6:7] op_sel_hi:[1,0] neg_lo:[0,1] neg_hi:[0,1]
    v_pk_fma_f32 v[10:11], v[12:13], v[12:13], v[10:11]
    v_pk_add_f32 v[12:13], v[38:39], v[6:7] op_sel_hi:[1,0] neg_lo:[0,1] neg_hi:[0,1]
    v_pk_fma_f32 v[10:11], v[12:13], v[12:13], v[10:11]
    v_pk_add_f32 v[12:13], v[40:41], v[6:7] op_sel_hi:[1,0] neg_lo:[0,1] neg_hi:[0,1]
    v_pk_fma_f32 v[10:11], v[12:13], v[12:13], v[10:11]
    v_pk_add_f32 v[12:13], v[42:43], v[6:7] op_sel_hi:[1,0] neg_lo:[0,1] neg_hi:[0,1]
    v_pk_fma_f32 v[10:11], v[12:13], v[12:13], v[10:11]
    v_pk_add_f32 v[12:13], v[44:45], v[6:7] op_sel_hi:[1,0] neg_lo:[0,1] neg_hi:[0,1]
    v_pk_fma_f32 v[10:11], v[12:13], v[12:13], v[10:11]
    v_pk_add_f32 v[12:13], v[46:47], v[6:7] op_sel_hi:[1,0] neg_lo:[0,1] neg_hi:[0,1]
    v_pk_fma_f32 v[10:11], v[12:13], v[12:13], v[10:11]
    v_pk_add_f32 v[12:13], v[48:49], v[6:7] op_sel_hi:[1,0] neg_lo:[0,1] neg_hi:[0,1]
    v_pk_fma_f32 v[10:11], v[12:13], v[12:13], v[10:11]
    v_pk_add_f32 v[12:13], v[50:51], v[6:7] op_sel_hi:[1,0] neg_lo:[0,1] neg_hi:[0,1]
    v_pk_fma_f32 v[10:11], v[12:13], v[12:13], v[10:11]
    v_pk_add_f32 v[12:13], v[52:53], v[6:7] op_sel_hi:[1,0] neg_lo:[0,1] neg_hi:[0,1]
    v_pk_fma_f32 v[10:11], v[12:13], v[12:13], v[10:11]
    v_pk_add_f32 v[12:13], v[54:55], v[6:7] op_sel_hi:[1,0] neg_lo:[0,1] neg_hi:[0,1]
    v_pk_fma_f32 v[10:11], v[12:13], v[12:13], v[10:11]
    v_pk_add_f32 v[12:13], v[56:57], v[6:7] op_sel_hi:[1,0] neg_lo:[0,1] neg_hi:[0,1]
    v_pk_fma_f32 v[10:11], v[12:13], v[12:13], v[10:11]
    v_pk_add_f32 v[12:13], v[58:59], v[6:7] op_sel_hi:[1,0] neg_lo:[0,1] neg_hi:[0,1]
    v_pk_fma_f32 v[10:11], v[12:13], v[12:13], v[10:11]
    v_pk_add_f32 v[12:13], v[60:61], v[6:7] op_sel_hi:[1,0] neg_lo:[0,1] neg_hi:[0,1]
    v_pk_fma_f32 v[10:11], v[12:13], v[12:13], v[10:11]
    v_pk_add_f32 v[12:13], v[62:63], v[6:7] op_sel_hi:[1,0] neg_lo:[0,1] neg_hi:[0,1]
    v_pk_fma_f32 v[10:11], v[12:13], v[12:13], v[10:11]
    v_add_f32 v7, v10, v11
    v_mov_b32 v10, v7
    s_nop 1
    v_permlane16_swap_b32 v10, v7
    v_add_f32 v7, v10, v7
    v_mov_b32 v10, v7
    s_nop 1
    v_permlane32_swap_b32 v10, v7
    v_add_f32_e64 v7, v10, v7
    ds_write2_b32 v9, v6, v7 offset0:0 offset1:64
    s_waitcnt lgkmcnt(0)
    s_barrier
    ds_read2_b32 v[16:17], v8 offset0:0 offset1:16
    ds_read2_b32 v[18:19], v8 offset0:32 offset1:48
    ds_read2_b32 v[20:21], v8 offset0:64 offset1:80
    ds_read2_b32 v[22:23], v8 offset0:96 offset1:112
    s_waitcnt lgkmcnt(0)
    v_add_f32 v10, v16, v17
    v_add_f32 v11, v18, v19
    v_add_f32 v10, v10, v11
    v_mul_f32 v10, 0x3e800000, v10
    v_add_f32 v11, v20, v21
    v_add_f32 v12, v22, v23
    v_add_f32_e64 v11, v11, v12
    v_mul_f32 v11, 0x3c000000, v11
    v_sub_f32 v12, v16, v10
    v_fmac_f32 v11, v12, v12
    v_sub_f32 v12, v17, v10
    v_fmac_f32 v11, v12, v12
    v_sub_f32 v12, v18, v10
    v_fmac_f32 v11, v12, v12
    v_sub_f32 v12, v19, v10
    v_fmac_f32 v11, v12, v12
    v_mul_f32 v11, 0x3e800000, v11
    v_cvt_pk_bf16_f32 v12, v10, v11
    v_lshlrev_b32_e64 v10, 16, v12
    v_and_b32 v11, 0xffff0000, v12
    v_add_f32 v11, 0x3727c5ac, v11
    v_cvt_pk_bf16_f32 v12, v11, v11
    v_lshlrev_b32 v11, 16, v12
    v_sqrt_f32_e64 v11, v11
    s_nop 0
    v_cvt_pk_bf16_f32 v12, v11, v11
    v_lshlrev_b32 v11, 16, v12
    v_rcp_f32 v12, v11
    s_nop 0
    v_mul_f32 v10, v10, v12
    v_pk_fma_f32 v[32:33], v[32:33], v[12:13], v[10:11] op_sel_hi:[1,0,0] neg_lo:[0,0,1] neg_hi:[0,0,1]
    v_pk_fma_f32 v[34:35], v[34:35], v[12:13], v[10:11] op_sel_hi:[1,0,0] neg_lo:[0,0,1] neg_hi:[0,0,1]
    v_pk_fma_f32 v[36:37], v[36:37], v[12:13], v[10:11] op_sel_hi:[1,0,0] neg_lo:[0,0,1] neg_hi:[0,0,1]
    v_pk_fma_f32 v[38:39], v[38:39], v[12:13], v[10:11] op_sel_hi:[1,0,0] neg_lo:[0,0,1] neg_hi:[0,0,1]
    v_pk_fma_f32 v[32:33], v[32:33], v[64:65], v[96:97]
    v_pk_fma_f32 v[34:35], v[34:35], v[66:67], v[98:99]
    v_pk_fma_f32 v[36:37], v[36:37], v[68:69], v[100:101]
    v_pk_fma_f32 v[38:39], v[38:39], v[70:71], v[102:103]
    v_cvt_pk_bf16_f32 v16, v32, v33
    v_cvt_pk_bf16_f32 v18, v34, v35
    v_cvt_pk_bf16_f32 v17, v36, v37
    v_cvt_pk_bf16_f32 v19, v38, v39
    v_pk_fma_f32 v[40:41], v[40:41], v[12:13], v[10:11] op_sel_hi:[1,0,0] neg_lo:[0,0,1] neg_hi:[0,0,1]
    v_pk_fma_f32 v[42:43], v[42:43], v[12:13], v[10:11] op_sel_hi:[1,0,0] neg_lo:[0,0,1] neg_hi:[0,0,1]
    v_pk_fma_f32 v[44:45], v[44:45], v[12:13], v[10:11] op_sel_hi:[1,0,0] neg_lo:[0,0,1] neg_hi:[0,0,1]
    v_pk_fma_f32 v[46:47], v[46:47], v[12:13], v[10:11] op_sel_hi:[1,0,0] neg_lo:[0,0,1] neg_hi:[0,0,1]
    v_pk_fma_f32 v[40:41], v[40:41], v[72:73], v[104:105]
    v_pk_fma_f32 v[42:43], v[42:43], v[74:75], v[106:107]
    v_pk_fma_f32 v[44:45], v[44:45], v[76:77], v[108:109]
    v_pk_fma_f32 v[46:47], v[46:47], v[78:79], v[110:111]
    v_cvt_pk_bf16_f32 v20, v40, v41
    v_cvt_pk_bf16_f32 v22, v42, v43
    v_cvt_pk_bf16_f32 v21, v44, v45
    v_cvt_pk_bf16_f32 v23, v46, v47
    v_pk_fma_f32 v[48:49], v[48:49], v[12:13], v[10:11] op_sel_hi:[1,0,0] neg_lo:[0,0,1] neg_hi:[0,0,1]
    v_pk_fma_f32 v[50:51], v[50:51], v[12:13], v[10:11] op_sel_hi:[1,0,0] neg_lo:[0,0,1] neg_hi:[0,0,1]
    v_pk_fma_f32 v[52:53], v[52:53], v[12:13], v[10:11] op_sel_hi:[1,0,0] neg_lo:[0,0,1] neg_hi:[0,0,1]
    v_pk_fma_f32 v[54:55], v[54:55], v[12:13], v[10:11] op_sel_hi:[1,0,0] neg_lo:[0,0,1] neg_hi:[0,0,1]
    v_pk_fma_f32 v[48:49], v[48:49], v[80:81], v[112:113]
    v_pk_fma_f32 v[50:51], v[50:51], v[82:83], v[114:115]
    v_pk_fma_f32 v[52:53], v[52:53], v[84:85], v[116:117]
    v_pk_fma_f32 v[54:55], v[54:55], v[86:87], v[118:119]
    v_cvt_pk_bf16_f32 v24, v48, v49
    v_cvt_pk_bf16_f32 v26, v50, v51
    v_cvt_pk_bf16_f32 v25, v52, v53
    v_cvt_pk_bf16_f32 v27, v54, v55
    v_pk_fma_f32 v[56:57], v[56:57], v[12:13], v[10:11] op_sel_hi:[1,0,0] neg_lo:[0,0,1] neg_hi:[0,0,1]
    v_pk_fma_f32 v[58:59], v[58:59], v[12:13], v[10:11] op_sel_hi:[1,0,0] neg_lo:[0,0,1] neg_hi:[0,0,1]
    v_pk_fma_f32 v[60:61], v[60:61], v[12:13], v[10:11] op_sel_hi:[1,0,0] neg_lo:[0,0,1] neg_hi:[0,0,1]
    v_pk_fma_f32 v[62:63], v[62:63], v[12:13], v[10:11] op_sel_hi:[1,0,0] neg_lo:[0,0,1] neg_hi:[0,0,1]
    v_pk_fma_f32 v[56:57], v[56:57], v[88:89], v[120:121]
    v_pk_fma_f32 v[58:59], v[58:59], v[90:91], v[122:123]
    v_pk_fma_f32 v[60:61], v[60:61], v[92:93], v[124:125]
    v_pk_fma_f32 v[62:63], v[62:63], v[94:95], v[126:127]
    v_cvt_pk_bf16_f32 v28, v56, v57
    v_cvt_pk_bf16_f32 v30, v58, v59
    v_cvt_pk_bf16_f32 v29, v60, v61
    v_cvt_pk_bf16_f32 v31, v62, v63
    v_permlane16_swap_b32 v16, v17
    v_permlane16_swap_b32 v18, v19
    v_permlane16_swap_b32 v20, v21
    v_permlane16_swap_b32 v22, v23
    v_permlane16_swap_b32 v24, v25
    v_permlane16_swap_b32 v26, v27
    v_permlane16_swap_b32 v28, v29
    v_permlane16_swap_b32 v30, v31
    ds_write_b128 v2, v[16:19] offset:0
    ds_write_b128 v2, v[20:23] offset:1024
    ds_write_b128 v2, v[24:27] offset:2048
    ds_write_b128 v2, v[28:31] offset:3072
    s_waitcnt lgkmcnt(0)
    s_barrier
    ds_read_b128 v[128:131], v3 offset:0
    ds_read_b128 v[132:135], v3 offset:1024
    ds_read_b128 v[136:139], v3 offset:2048
    ds_read_b128 v[140:143], v3 offset:3072
    ds_read_b128 v[144:147], v3 offset:4096
    ds_read_b128 v[148:151], v3 offset:5120
    ds_read_b128 v[152:155], v3 offset:6144
    ds_read_b128 v[156:159], v3 offset:7168
    ds_read_b128 v[160:163], v3 offset:8192
    ds_read_b128 v[164:167], v3 offset:9216
    ds_read_b128 v[168:171], v3 offset:10240
    ds_read_b128 v[172:175], v3 offset:11264
    s_waitcnt lgkmcnt(11)
    v_mfma_f32_16x16x32_bf16 v[192:195], a[0:3], v[128:131], 0
    v_mfma_f32_16x16x32_bf16 v[196:199], a[64:67], v[128:131], 0
    v_mfma_f32_16x16x32_bf16 v[200:203], a[128:131], v[128:131], 0
    v_mfma_f32_16x16x32_bf16 v[204:207], a[192:195], v[128:131], 0
    ds_read_b128 v[176:179], v3 offset:12288
    s_waitcnt lgkmcnt(11)
    v_mfma_f32_16x16x32_bf16 v[192:195], a[4:7], v[132:135], v[192:195]
    v_mfma_f32_16x16x32_bf16 v[196:199], a[68:71], v[132:135], v[196:199]
    v_mfma_f32_16x16x32_bf16 v[200:203], a[132:135], v[132:135], v[200:203]
    v_mfma_f32_16x16x32_bf16 v[204:207], a[196:199], v[132:135], v[204:207]
    ds_read_b128 v[180:183], v3 offset:13312
    s_waitcnt lgkmcnt(11)
    v_mfma_f32_16x16x32_bf16 v[192:195], a[8:11], v[136:139], v[192:195]
    v_mfma_f32_16x16x32_bf16 v[196:199], a[72:75], v[136:139], v[196:199]
    v_mfma_f32_16x16x32_bf16 v[200:203], a[136:139], v[136:139], v[200:203]
    v_mfma_f32_16x16x32_bf16 v[204:207], a[200:203], v[136:139], v[204:207]
    ds_read_b128 v[184:187], v3 offset:14336
    s_waitcnt lgkmcnt(11)
    v_mfma_f32_16x16x32_bf16 v[192:195], a[12:15], v[140:143], v[192:195]
    v_mfma_f32_16x16x32_bf16 v[196:199], a[76:79], v[140:143], v[196:199]
    v_mfma_f32_16x16x32_bf16 v[200:203], a[140:143], v[140:143], v[200:203]
    v_mfma_f32_16x16x32_bf16 v[204:207], a[204:207], v[140:143], v[204:207]
    ds_read_b128 v[188:191], v3 offset:15360
    s_waitcnt lgkmcnt(11)
    v_mfma_f32_16x16x32_bf16 v[192:195], a[16:19], v[144:147], v[192:195]
    v_mfma_f32_16x16x32_bf16 v[196:199], a[80:83], v[144:147], v[196:199]
    v_mfma_f32_16x16x32_bf16 v[200:203], a[144:147], v[144:147], v[200:203]
    v_mfma_f32_16x16x32_bf16 v[204:207], a[208:211], v[144:147], v[204:207]
    s_waitcnt lgkmcnt(10)
    v_mfma_f32_16x16x32_bf16 v[192:195], a[20:23], v[148:151], v[192:195]
    v_mfma_f32_16x16x32_bf16 v[196:199], a[84:87], v[148:151], v[196:199]
    v_mfma_f32_16x16x32_bf16 v[200:203], a[148:151], v[148:151], v[200:203]
    v_mfma_f32_16x16x32_bf16 v[204:207], a[212:215], v[148:151], v[204:207]
    s_waitcnt lgkmcnt(9)
    v_mfma_f32_16x16x32_bf16 v[192:195], a[24:27], v[152:155], v[192:195]
    v_mfma_f32_16x16x32_bf16 v[196:199], a[88:91], v[152:155], v[196:199]
    v_mfma_f32_16x16x32_bf16 v[200:203], a[152:155], v[152:155], v[200:203]
    v_mfma_f32_16x16x32_bf16 v[204:207], a[216:219], v[152:155], v[204:207]
    s_waitcnt lgkmcnt(8)
    v_mfma_f32_16x16x32_bf16 v[192:195], a[28:31], v[156:159], v[192:195]
    v_mfma_f32_16x16x32_bf16 v[196:199], a[92:95], v[156:159], v[196:199]
    v_mfma_f32_16x16x32_bf16 v[200:203], a[156:159], v[156:159], v[200:203]
    v_mfma_f32_16x16x32_bf16 v[204:207], a[220:223], v[156:159], v[204:207]
    s_waitcnt lgkmcnt(7)
    v_mfma_f32_16x16x32_bf16 v[192:195], a[32:35], v[160:163], v[192:195]
    v_mfma_f32_16x16x32_bf16 v[196:199], a[96:99], v[160:163], v[196:199]
    v_mfma_f32_16x16x32_bf16 v[200:203], a[160:163], v[160:163], v[200:203]
    v_mfma_f32_16x16x32_bf16 v[204:207], a[224:227], v[160:163], v[204:207]
    s_waitcnt lgkmcnt(6)
    v_mfma_f32_16x16x32_bf16 v[192:195], a[36:39], v[164:167], v[192:195]
    v_mfma_f32_16x16x32_bf16 v[196:199], a[100:103], v[164:167], v[196:199]
    v_mfma_f32_16x16x32_bf16 v[200:203], a[164:167], v[164:167], v[200:203]
    v_mfma_f32_16x16x32_bf16 v[204:207], a[228:231], v[164:167], v[204:207]
    s_waitcnt lgkmcnt(5)
    v_mfma_f32_16x16x32_bf16 v[192:195], a[40:43], v[168:171], v[192:195]
    v_mfma_f32_16x16x32_bf16 v[196:199], a[104:107], v[168:171], v[196:199]
    v_mfma_f32_16x16x32_bf16 v[200:203], a[168:171], v[168:171], v[200:203]
    v_mfma_f32_16x16x32_bf16 v[204:207], a[232:235], v[168:171], v[204:207]
    s_waitcnt lgkmcnt(4)
    v_mfma_f32_16x16x32_bf16 v[192:195], a[44:47], v[172:175], v[192:195]
    v_mfma_f32_16x16x32_bf16 v[196:199], a[108:111], v[172:175], v[196:199]
    v_mfma_f32_16x16x32_bf16 v[200:203], a[172:175], v[172:175], v[200:203]
    v_mfma_f32_16x16x32_bf16 v[204:207], a[236:239], v[172:175], v[204:207]
    s_waitcnt lgkmcnt(3)
    v_mfma_f32_16x16x32_bf16 v[192:195], a[48:51], v[176:179], v[192:195]
    v_mfma_f32_16x16x32_bf16 v[196:199], a[112:115], v[176:179], v[196:199]
    v_mfma_f32_16x16x32_bf16 v[200:203], a[176:179], v[176:179], v[200:203]
    v_mfma_f32_16x16x32_bf16 v[204:207], a[240:243], v[176:179], v[204:207]
    s_waitcnt lgkmcnt(2)
    v_mfma_f32_16x16x32_bf16 v[192:195], a[52:55], v[180:183], v[192:195]
    v_mfma_f32_16x16x32_bf16 v[196:199], a[116:119], v[180:183], v[196:199]
    v_mfma_f32_16x16x32_bf16 v[200:203], a[180:183], v[180:183], v[200:203]
    v_mfma_f32_16x16x32_bf16 v[204:207], a[244:247], v[180:183], v[204:207]
    s_waitcnt lgkmcnt(1)
    v_mfma_f32_16x16x32_bf16 v[192:195], a[56:59], v[184:187], v[192:195]
    v_mfma_f32_16x16x32_bf16 v[196:199], a[120:123], v[184:187], v[196:199]
    v_mfma_f32_16x16x32_bf16 v[200:203], a[184:187], v[184:187], v[200:203]
    v_mfma_f32_16x16x32_bf16 v[204:207], a[248:251], v[184:187], v[204:207]
    s_waitcnt lgkmcnt(0)
    v_mfma_f32_16x16x32_bf16 v[192:195], a[60:63], v[188:191], v[192:195]
    v_mfma_f32_16x16x32_bf16 v[196:199], a[124:127], v[188:191], v[196:199]
    v_mfma_f32_16x16x32_bf16 v[200:203], a[188:191], v[188:191], v[200:203]
    v_mfma_f32_16x16x32_bf16 v[204:207], a[252:255], v[188:191], v[204:207]
    v_cvt_pk_bf16_f32 v10, v192, v193
    v_lshlrev_b32_e64 v192, 16, v10
    v_and_b32 v193, 0xffff0000, v10
    v_cvt_pk_bf16_f32 v10, v194, v195
    v_lshlrev_b32_e64 v194, 16, v10
    v_and_b32 v195, 0xffff0000, v10
    v_cvt_pk_bf16_f32 v10, v196, v197
    v_lshlrev_b32_e64 v196, 16, v10
    v_and_b32 v197, 0xffff0000, v10
    v_cvt_pk_bf16_f32 v10, v198, v199
    v_lshlrev_b32_e64 v198, 16, v10
    v_and_b32 v199, 0xffff0000, v10
    v_cvt_pk_bf16_f32 v10, v200, v201
    v_lshlrev_b32_e64 v200, 16, v10
    v_and_b32 v201, 0xffff0000, v10
    v_cvt_pk_bf16_f32 v10, v202, v203
    v_lshlrev_b32_e64 v202, 16, v10
    v_and_b32 v203, 0xffff0000, v10
    v_cvt_pk_bf16_f32 v10, v204, v205
    v_lshlrev_b32_e64 v204, 16, v10
    v_and_b32 v205, 0xffff0000, v10
    v_cvt_pk_bf16_f32 v10, v206, v207
    v_lshlrev_b32_e64 v206, 16, v10
    v_and_b32 v207, 0xffff0000, v10
    v_mul_f32 v192, v192, v200
    v_mul_f32 v193, v193, v201
    v_mul_f32 v194, v194, v202
    v_mul_f32 v195, v195, v203
    v_mul_f32 v196, v196, v204
    v_mul_f32 v197, v197, v205
    v_mul_f32 v198, v198, v206
    v_mul_f32 v199, v199, v207
    v_cvt_pk_bf16_f32 v208, v192, v193
    v_cvt_pk_bf16_f32 v209, v194, v195
    v_cvt_pk_bf16_f32 v210, v196, v197
    v_cvt_pk_bf16_f32 v211, v198, v199
    s_mul_i32 s59, s65, 57344
    s_lshl_b32 s60, s64, 12
    s_add_u32 s59, s59, s60
    s_lshl_b32 s60, s54, 10
    s_add_u32 s59, s59, s60
    s_add_u32 s59, s59, 8388608
    buffer_store_dwordx4 v[208:211], v3, s[24:27], s59 offen sc1
    v_mov_b32 v127, s66
    s_barrier
    s_waitcnt vmcnt(0)
    s_mov_b64 exec, 1
    buffer_store_dword v127, off, s[24:27], s68 sc1
    s_mov_b64 exec, -1
    s_add_u32 s65, s65, 4
    s_cmp_lt_u32 s65, 128
    s_cbranch_scc1 up_loop
    s_branch main_done
qkv_start:
    s_sub_u32 s59, s53, 32
    s_lshr_b32 s55, s59, 1
    s_and_b32 s56, s59, 1
    v_lshlrev_b32_e64 v8, 4, v0
    s_lshl_b32 s58, s54, 12
    s_add_u32 s58, s58, 32768
    s_lshl_b32 s13, s55, 8
    v_lshrrev_b32 v16, 4, v0
    v_and_b32 v17, 15, v0
    v_and_b32 v18, 1, v16
    v_lshlrev_b32 v18, 1, v18
    v_xor_b32 v17, v17, v18
    s_lshl_b32 s59, s54, 4
    v_add_u32 v16, s59, v16
    s_mov_b32 s59, 8192
    v_mul_lo_u32 v18, v16, s59
    v_add_u32 v18, s13, v18
    v_xor_b32 v19, 0, v17
    v_lshl_add_u32 v96, v19, 4, v18
    v_xor_b32_e64 v19, 4, v17
    v_lshl_add_u32 v97, v19, 4, v18
    v_add_u32 v97, 32768, v97
    v_xor_b32_e64 v19, 8, v17
    v_lshl_add_u32 v98, v19, 4, v18
    v_add_u32 v98, 65536, v98
    v_xor_b32_e64 v19, 12, v17
    v_lshl_add_u32 v99, v19, 4, v18
    v_add_u32 v99, 98304, v99
    v_bfe_u32 v2, v0, 5, 1
    v_lshlrev_b32_e64 v112, 12, v2
    v_bfe_u32 v2, v0, 3, 1
    v_lshl_add_u32 v112, v2, 11, v112
    v_lshlrev_b32_e64 v3, 3, v2
    v_bfe_u32 v2, v0, 4, 1
    v_lshl_add_u32 v112, v2, 10, v112
    v_lshl_add_u32 v3, v2, 2, v3
    v_bfe_u32 v2, v0, 2, 1
    v_lshl_add_u32 v112, v2, 8, v112
    v_lshl_add_u32 v3, v2, 1, v3
    v_bfe_u32 v2, v0, 1, 1
    s_lshl_b32 s59, s54, 2
    v_add_u32 v2, s59, v2
    v_xor_b32_e64 v2, v2, v3
    v_lshl_add_u32 v112, v2, 4, v112
    v_and_b32_e64 v2, 1, v0
    v_lshl_add_u32 v112, v2, 3, v112
    v_add_u32 v112, 32768, v112
    v_xor_b32_e64 v113, 32, v112
    v_add_u32 v116, 0x10000, v112
    v_add_u32 v117, 0x10000, v113
    s_mov_b32 s59, 0
    s_add_u32 m0, s58, 0
    s_nop 0
    buffer_load_dwordx4 v96, s[32:35], s59 offen lds
    s_add_u32 m0, s58, 1024
    s_nop 0
    buffer_load_dwordx4 v97, s[32:35], s59 offen lds
    s_add_u32 m0, s58, 2048
    s_nop 0
    buffer_load_dwordx4 v98, s[32:35], s59 offen lds
    s_add_u32 m0, s58, 3072
    s_nop 0
    buffer_load_dwordx4 v99, s[32:35], s59 offen lds
    s_mov_b32 s59, 524288
    s_add_u32 m0, s58, 16384
    s_nop 0
    buffer_load_dwordx4 v96, s[32:35], s59 offen lds
    s_add_u32 m0, s58, 17408
    s_nop 0
    buffer_load_dwordx4 v97, s[32:35], s59 offen lds
    s_add_u32 m0, s58, 18432
    s_nop 0
    buffer_load_dwordx4 v98, s[32:35], s59 offen lds
    s_add_u32 m0, s58, 19456
    s_nop 0
    buffer_load_dwordx4 v99, s[32:35], s59 offen lds
    s_mov_b32 s59, 1048576
    s_add_u32 m0, s58, 32768
    s_nop 0
    buffer_load_dwordx4 v96, s[32:35], s59 offen lds
    s_add_u32 m0, s58, 33792
    s_nop 0
    buffer_load_dwordx4 v97, s[32:35], s59 offen lds
    s_add_u32 m0, s58, 34816
    s_nop 0
    buffer_load_dwordx4 v98, s[32:35], s59 offen lds
    s_add_u32 m0, s58, 35840
    s_nop 0
    buffer_load_dwordx4 v99, s[32:35], s59 offen lds
    s_mov_b32 s59, 1572864
    s_add_u32 m0, s58, 49152
    s_nop 0
    buffer_load_dwordx4 v96, s[32:35], s59 offen lds
    s_add_u32 m0, s58, 50176
    s_nop 0
    buffer_load_dwordx4 v97, s[32:35], s59 offen lds
    s_add_u32 m0, s58, 51200
    s_nop 0
    buffer_load_dwordx4 v98, s[32:35], s59 offen lds
    s_add_u32 m0, s58, 52224
    s_nop 0
    buffer_load_dwordx4 v99, s[32:35], s59 offen lds
    s_mov_b32 s59, 2097152
    s_add_u32 m0, s58, 65536
    s_nop 0
    buffer_load_dwordx4 v96, s[32:35], s59 offen lds
    s_add_u32 m0, s58, 66560
    s_nop 0
    buffer_load_dwordx4 v97, s[32:35], s59 offen lds
    s_add_u32 m0, s58, 67584
    s_nop 0
    buffer_load_dwordx4 v98, s[32:35], s59 offen lds
    s_add_u32 m0, s58, 68608
    s_nop 0
    buffer_load_dwordx4 v99, s[32:35], s59 offen lds
    s_mov_b32 s59, 2621440
    s_add_u32 m0, s58, 81920
    s_nop 0
    buffer_load_dwordx4 v96, s[32:35], s59 offen lds
    s_add_u32 m0, s58, 82944
    s_nop 0
    buffer_load_dwordx4 v97, s[32:35], s59 offen lds
    s_add_u32 m0, s58, 83968
    s_nop 0
    buffer_load_dwordx4 v98, s[32:35], s59 offen lds
    s_add_u32 m0, s58, 84992
    s_nop 0
    buffer_load_dwordx4 v99, s[32:35], s59 offen lds
    s_mov_b32 s59, 3145728
    s_add_u32 m0, s58, 98304
    s_nop 0
    buffer_load_dwordx4 v96, s[32:35], s59 offen lds
    s_add_u32 m0, s58, 99328
    s_nop 0
    buffer_load_dwordx4 v97, s[32:35], s59 offen lds
    s_add_u32 m0, s58, 100352
    s_nop 0
    buffer_load_dwordx4 v98, s[32:35], s59 offen lds
    s_add_u32 m0, s58, 101376
    s_nop 0
    buffer_load_dwordx4 v99, s[32:35], s59 offen lds
    s_mov_b32 s59, 3670016
    s_add_u32 m0, s58, 114688
    s_nop 0
    buffer_load_dwordx4 v96, s[32:35], s59 offen lds
    s_add_u32 m0, s58, 115712
    s_nop 0
    buffer_load_dwordx4 v97, s[32:35], s59 offen lds
    s_add_u32 m0, s58, 116736
    s_nop 0
    buffer_load_dwordx4 v98, s[32:35], s59 offen lds
    s_add_u32 m0, s58, 117760
    s_nop 0
    buffer_load_dwordx4 v99, s[32:35], s59 offen lds
    s_waitcnt vmcnt(28)
    s_barrier
    ds_read_b64_tr_b16 a[0:1], v112 offset:0
    ds_read_b64_tr_b16 a[2:3], v112 offset:512
    ds_read_b64_tr_b16 a[4:5], v112 offset:8192
    ds_read_b64_tr_b16 a[6:7], v112 offset:8704
    ds_read_b64_tr_b16 a[64:65], v113 offset:0
    ds_read_b64_tr_b16 a[66:67], v113 offset:512
    ds_read_b64_tr_b16 a[68:69], v113 offset:8192
    ds_read_b64_tr_b16 a[70:71], v113 offset:8704
    s_waitcnt lgkmcnt(0)
    s_waitcnt vmcnt(24)
    s_barrier
    s_mov_b32 s59, 0
    s_add_u32 m0, s58, 0
    s_nop 0
    buffer_load_dwordx4 v96, s[36:39], s59 offen lds
    s_add_u32 m0, s58, 1024
    s_nop 0
    buffer_load_dwordx4 v97, s[36:39], s59 offen lds
    s_add_u32 m0, s58, 2048
    s_nop 0
    buffer_load_dwordx4 v98, s[36:39], s59 offen lds
    s_add_u32 m0, s58, 3072
    s_nop 0
    buffer_load_dwordx4 v99, s[36:39], s59 offen lds
    ds_read_b64_tr_b16 a[8:9], v112 offset:16384
    ds_read_b64_tr_b16 a[10:11], v112 offset:16896
    ds_read_b64_tr_b16 a[12:13], v112 offset:24576
    ds_read_b64_tr_b16 a[14:15], v112 offset:25088
    ds_read_b64_tr_b16 a[72:73], v113 offset:16384
    ds_read_b64_tr_b16 a[74:75], v113 offset:16896
    ds_read_b64_tr_b16 a[76:77], v113 offset:24576
    ds_read_b64_tr_b16 a[78:79], v113 offset:25088
    s_waitcnt lgkmcnt(0)
    s_waitcnt vmcnt(24)
    s_barrier
    s_mov_b32 s59, 524288
    s_add_u32 m0, s58, 16384
    s_nop 0
    buffer_load_dwordx4 v96, s[36:39], s59 offen lds
    s_add_u32 m0, s58, 17408
    s_nop 0
    buffer_load_dwordx4 v97, s[36:39], s59 offen lds
    s_add_u32 m0, s58, 18432
    s_nop 0
    buffer_load_dwordx4 v98, s[36:39], s59 offen lds
    s_add_u32 m0, s58, 19456
    s_nop 0
    buffer_load_dwordx4 v99, s[36:39], s59 offen lds
    ds_read_b64_tr_b16 a[16:17], v112 offset:32768
    ds_read_b64_tr_b16 a[18:19], v112 offset:33280
    ds_read_b64_tr_b16 a[20:21], v112 offset:40960
    ds_read_b64_tr_b16 a[22:23], v112 offset:41472
    ds_read_b64_tr_b16 a[80:81], v113 offset:32768
    ds_read_b64_tr_b16 a[82:83], v113 offset:33280
    ds_read_b64_tr_b16 a[84:85], v113 offset:40960
    ds_read_b64_tr_b16 a[86:87], v113 offset:41472
    s_waitcnt lgkmcnt(0)
    s_waitcnt vmcnt(24)
    s_barrier
    s_mov_b32 s59, 1048576
    s_add_u32 m0, s58, 32768
    s_nop 0
    buffer_load_dwordx4 v96, s[36:39], s59 offen lds
    s_add_u32 m0, s58, 33792
    s_nop 0
    buffer_load_dwordx4 v97, s[36:39], s59 offen lds
    s_add_u32 m0, s58, 34816
    s_nop 0
    buffer_load_dwordx4 v98, s[36:39], s59 offen lds
    s_add_u32 m0, s58, 35840
    s_nop 0
    buffer_load_dwordx4 v99, s[36:39], s59 offen lds
    ds_read_b64_tr_b16 a[24:25], v112 offset:49152
    ds_read_b64_tr_b16 a[26:27], v112 offset:49664
    ds_read_b64_tr_b16 a[28:29], v112 offset:57344
    ds_read_b64_tr_b16 a[30:31], v112 offset:57856
    ds_read_b64_tr_b16 a[88:89], v113 offset:49152
    ds_read_b64_tr_b16 a[90:91], v113 offset:49664
    ds_read_b64_tr_b16 a[92:93], v113 offset:57344
    ds_read_b64_tr_b16 a[94:95], v113 offset:57856
    s_waitcnt lgkmcnt(0)
    s_waitcnt vmcnt(24)
    s_barrier
    s_mov_b32 s59, 1572864
    s_add_u32 m0, s58, 49152
    s_nop 0
    buffer_load_dwordx4 v96, s[36:39], s59 offen lds
    s_add_u32 m0, s58, 50176
    s_nop 0
    buffer_load_dwordx4 v97, s[36:39], s59 offen lds
    s_add_u32 m0, s58, 51200
    s_nop 0
    buffer_load_dwordx4 v98, s[36:39], s59 offen lds
    s_add_u32 m0, s58, 52224
    s_nop 0
    buffer_load_dwordx4 v99, s[36:39], s59 offen lds
    ds_read_b64_tr_b16 a[32:33], v116 offset:0
    ds_read_b64_tr_b16 a[34:35], v116 offset:512
    ds_read_b64_tr_b16 a[36:37], v116 offset:8192
    ds_read_b64_tr_b16 a[38:39], v116 offset:8704
    ds_read_b64_tr_b16 a[96:97], v117 offset:0
    ds_read_b64_tr_b16 a[98:99], v117 offset:512
    ds_read_b64_tr_b16 a[100:101], v117 offset:8192
    ds_read_b64_tr_b16 a[102:103], v117 offset:8704
    s_waitcnt lgkmcnt(0)
    s_waitcnt vmcnt(24)
    s_barrier
    s_mov_b32 s59, 2097152
    s_add_u32 m0, s58, 65536
    s_nop 0
    buffer_load_dwordx4 v96, s[36:39], s59 offen lds
    s_add_u32 m0, s58, 66560
    s_nop 0
    buffer_load_dwordx4 v97, s[36:39], s59 offen lds
    s_add_u32 m0, s58, 67584
    s_nop 0
    buffer_load_dwordx4 v98, s[36:39], s59 offen lds
    s_add_u32 m0, s58, 68608
    s_nop 0
    buffer_load_dwordx4 v99, s[36:39], s59 offen lds
    ds_read_b64_tr_b16 a[40:41], v116 offset:16384
    ds_read_b64_tr_b16 a[42:43], v116 offset:16896
    ds_read_b64_tr_b16 a[44:45], v116 offset:24576
    ds_read_b64_tr_b16 a[46:47], v116 offset:25088
    ds_read_b64_tr_b16 a[104:105], v117 offset:16384
    ds_read_b64_tr_b16 a[106:107], v117 offset:16896
    ds_read_b64_tr_b16 a[108:109], v117 offset:24576
    ds_read_b64_tr_b16 a[110:111], v117 offset:25088
    s_waitcnt lgkmcnt(0)
    s_waitcnt vmcnt(24)
    s_barrier
    s_mov_b32 s59, 2621440
    s_add_u32 m0, s58, 81920
    s_nop 0
    buffer_load_dwordx4 v96, s[36:39], s59 offen lds
    s_add_u32 m0, s58, 82944
    s_nop 0
    buffer_load_dwordx4 v97, s[36:39], s59 offen lds
    s_add_u32 m0, s58, 83968
    s_nop 0
    buffer_load_dwordx4 v98, s[36:39], s59 offen lds
    s_add_u32 m0, s58, 84992
    s_nop 0
    buffer_load_dwordx4 v99, s[36:39], s59 offen lds
    ds_read_b64_tr_b16 a[48:49], v116 offset:32768
    ds_read_b64_tr_b16 a[50:51], v116 offset:33280
    ds_read_b64_tr_b16 a[52:53], v116 offset:40960
    ds_read_b64_tr_b16 a[54:55], v116 offset:41472
    ds_read_b64_tr_b16 a[112:113], v117 offset:32768
    ds_read_b64_tr_b16 a[114:115], v117 offset:33280
    ds_read_b64_tr_b16 a[116:117], v117 offset:40960
    ds_read_b64_tr_b16 a[118:119], v117 offset:41472
    s_waitcnt lgkmcnt(0)
    s_waitcnt vmcnt(24)
    s_barrier
    s_mov_b32 s59, 3145728
    s_add_u32 m0, s58, 98304
    s_nop 0
    buffer_load_dwordx4 v96, s[36:39], s59 offen lds
    s_add_u32 m0, s58, 99328
    s_nop 0
    buffer_load_dwordx4 v97, s[36:39], s59 offen lds
    s_add_u32 m0, s58, 100352
    s_nop 0
    buffer_load_dwordx4 v98, s[36:39], s59 offen lds
    s_add_u32 m0, s58, 101376
    s_nop 0
    buffer_load_dwordx4 v99, s[36:39], s59 offen lds
    ds_read_b64_tr_b16 a[56:57], v116 offset:49152
    ds_read_b64_tr_b16 a[58:59], v116 offset:49664
    ds_read_b64_tr_b16 a[60:61], v116 offset:57344
    ds_read_b64_tr_b16 a[62:63], v116 offset:57856
    ds_read_b64_tr_b16 a[120:121], v117 offset:49152
    ds_read_b64_tr_b16 a[122:123], v117 offset:49664
    ds_read_b64_tr_b16 a[124:125], v117 offset:57344
    ds_read_b64_tr_b16 a[126:127], v117 offset:57856
    s_waitcnt lgkmcnt(0)
    s_waitcnt vmcnt(24)
    s_barrier
    s_mov_b32 s59, 3670016
    s_add_u32 m0, s58, 114688
    s_nop 0
    buffer_load_dwordx4 v96, s[36:39], s59 offen lds
    s_add_u32 m0, s58, 115712
    s_nop 0
    buffer_load_dwordx4 v97, s[36:39], s59 offen lds
    s_add_u32 m0, s58, 116736
    s_nop 0
    buffer_load_dwordx4 v98, s[36:39], s59 offen lds
    s_add_u32 m0, s58, 117760
    s_nop 0
    buffer_load_dwordx4 v99, s[36:39], s59 offen lds
    ds_read_b64_tr_b16 a[128:129], v112 offset:0
    ds_read_b64_tr_b16 a[130:131], v112 offset:512
    ds_read_b64_tr_b16 a[132:133], v112 offset:8192
    ds_read_b64_tr_b16 a[134:135], v112 offset:8704
    ds_read_b64_tr_b16 a[192:193], v113 offset:0
    ds_read_b64_tr_b16 a[194:195], v113 offset:512
    ds_read_b64_tr_b16 a[196:197], v113 offset:8192
    ds_read_b64_tr_b16 a[198:199], v113 offset:8704
    s_waitcnt lgkmcnt(0)
    s_waitcnt vmcnt(24)
    s_barrier
    s_mov_b32 s59, 0
    s_add_u32 m0, s58, 0
    s_nop 0
    buffer_load_dwordx4 v96, s[40:43], s59 offen lds
    s_add_u32 m0, s58, 1024
    s_nop 0
    buffer_load_dwordx4 v97, s[40:43], s59 offen lds
    s_add_u32 m0, s58, 2048
    s_nop 0
    buffer_load_dwordx4 v98, s[40:43], s59 offen lds
    s_add_u32 m0, s58, 3072
    s_nop 0
    buffer_load_dwordx4 v99, s[40:43], s59 offen lds
    ds_read_b64_tr_b16 a[136:137], v112 offset:16384
    ds_read_b64_tr_b16 a[138:139], v112 offset:16896
    ds_read_b64_tr_b16 a[140:141], v112 offset:24576
    ds_read_b64_tr_b16 a[142:143], v112 offset:25088
    ds_read_b64_tr_b16 a[200:201], v113 offset:16384
    ds_read_b64_tr_b16 a[202:203], v113 offset:16896
    ds_read_b64_tr_b16 a[204:205], v113 offset:24576
    ds_read_b64_tr_b16 a[206:207], v113 offset:25088
    s_waitcnt lgkmcnt(0)
    s_waitcnt vmcnt(24)
    s_barrier
    s_mov_b32 s59, 524288
    s_add_u32 m0, s58, 16384
    s_nop 0
    buffer_load_dwordx4 v96, s[40:43], s59 offen lds
    s_add_u32 m0, s58, 17408
    s_nop 0
    buffer_load_dwordx4 v97, s[40:43], s59 offen lds
    s_add_u32 m0, s58, 18432
    s_nop 0
    buffer_load_dwordx4 v98, s[40:43], s59 offen lds
    s_add_u32 m0, s58, 19456
    s_nop 0
    buffer_load_dwordx4 v99, s[40:43], s59 offen lds
    ds_read_b64_tr_b16 a[144:145], v112 offset:32768
    ds_read_b64_tr_b16 a[146:147], v112 offset:33280
    ds_read_b64_tr_b16 a[148:149], v112 offset:40960
    ds_read_b64_tr_b16 a[150:151], v112 offset:41472
    ds_read_b64_tr_b16 a[208:209], v113 offset:32768
    ds_read_b64_tr_b16 a[210:211], v113 offset:33280
    ds_read_b64_tr_b16 a[212:213], v113 offset:40960
    ds_read_b64_tr_b16 a[214:215], v113 offset:41472
    s_waitcnt lgkmcnt(0)
    s_waitcnt vmcnt(24)
    s_barrier
    s_mov_b32 s59, 1048576
    s_add_u32 m0, s58, 32768
    s_nop 0
    buffer_load_dwordx4 v96, s[40:43], s59 offen lds
    s_add_u32 m0, s58, 33792
    s_nop 0
    buffer_load_dwordx4 v97, s[40:43], s59 offen lds
    s_add_u32 m0, s58, 34816
    s_nop 0
    buffer_load_dwordx4 v98, s[40:43], s59 offen lds
    s_add_u32 m0, s58, 35840
    s_nop 0
    buffer_load_dwordx4 v99, s[40:43], s59 offen lds
    ds_read_b64_tr_b16 a[152:153], v112 offset:49152
    ds_read_b64_tr_b16 a[154:155], v112 offset:49664
    ds_read_b64_tr_b16 a[156:157], v112 offset:57344
    ds_read_b64_tr_b16 a[158:159], v112 offset:57856
    ds_read_b64_tr_b16 a[216:217], v113 offset:49152
    ds_read_b64_tr_b16 a[218:219], v113 offset:49664
    ds_read_b64_tr_b16 a[220:221], v113 offset:57344
    ds_read_b64_tr_b16 a[222:223], v113 offset:57856
    s_waitcnt lgkmcnt(0)
    s_waitcnt vmcnt(24)
    s_barrier
    s_mov_b32 s59, 1572864
    s_add_u32 m0, s58, 49152
    s_nop 0
    buffer_load_dwordx4 v96, s[40:43], s59 offen lds
    s_add_u32 m0, s58, 50176
    s_nop 0
    buffer_load_dwordx4 v97, s[40:43], s59 offen lds
    s_add_u32 m0, s58, 51200
    s_nop 0
    buffer_load_dwordx4 v98, s[40:43], s59 offen lds
    s_add_u32 m0, s58, 52224
    s_nop 0
    buffer_load_dwordx4 v99, s[40:43], s59 offen lds
    ds_read_b64_tr_b16 a[160:161], v116 offset:0
    ds_read_b64_tr_b16 a[162:163], v116 offset:512
    ds_read_b64_tr_b16 a[164:165], v116 offset:8192
    ds_read_b64_tr_b16 a[166:167], v116 offset:8704
    ds_read_b64_tr_b16 a[224:225], v117 offset:0
    ds_read_b64_tr_b16 a[226:227], v117 offset:512
    ds_read_b64_tr_b16 a[228:229], v117 offset:8192
    ds_read_b64_tr_b16 a[230:231], v117 offset:8704
    s_waitcnt lgkmcnt(0)
    s_waitcnt vmcnt(24)
    s_barrier
    s_mov_b32 s59, 2097152
    s_add_u32 m0, s58, 65536
    s_nop 0
    buffer_load_dwordx4 v96, s[40:43], s59 offen lds
    s_add_u32 m0, s58, 66560
    s_nop 0
    buffer_load_dwordx4 v97, s[40:43], s59 offen lds
    s_add_u32 m0, s58, 67584
    s_nop 0
    buffer_load_dwordx4 v98, s[40:43], s59 offen lds
    s_add_u32 m0, s58, 68608
    s_nop 0
    buffer_load_dwordx4 v99, s[40:43], s59 offen lds
    ds_read_b64_tr_b16 a[168:169], v116 offset:16384
    ds_read_b64_tr_b16 a[170:171], v116 offset:16896
    ds_read_b64_tr_b16 a[172:173], v116 offset:24576
    ds_read_b64_tr_b16 a[174:175], v116 offset:25088
    ds_read_b64_tr_b16 a[232:233], v117 offset:16384
    ds_read_b64_tr_b16 a[234:235], v117 offset:16896
    ds_read_b64_tr_b16 a[236:237], v117 offset:24576
    ds_read_b64_tr_b16 a[238:239], v117 offset:25088
    s_waitcnt lgkmcnt(0)
    s_waitcnt vmcnt(24)
    s_barrier
    s_mov_b32 s59, 2621440
    s_add_u32 m0, s58, 81920
    s_nop 0
    buffer_load_dwordx4 v96, s[40:43], s59 offen lds
    s_add_u32 m0, s58, 82944
    s_nop 0
    buffer_load_dwordx4 v97, s[40:43], s59 offen lds
    s_add_u32 m0, s58, 83968
    s_nop 0
    buffer_load_dwordx4 v98, s[40:43], s59 offen lds
    s_add_u32 m0, s58, 84992
    s_nop 0
    buffer_load_dwordx4 v99, s[40:43], s59 offen lds
    ds_read_b64_tr_b16 a[176:177], v116 offset:32768
    ds_read_b64_tr_b16 a[178:179], v116 offset:33280
    ds_read_b64_tr_b16 a[180:181], v116 offset:40960
    ds_read_b64_tr_b16 a[182:183], v116 offset:41472
    ds_read_b64_tr_b16 a[240:241], v117 offset:32768
    ds_read_b64_tr_b16 a[242:243], v117 offset:33280
    ds_read_b64_tr_b16 a[244:245], v117 offset:40960
    ds_read_b64_tr_b16 a[246:247], v117 offset:41472
    s_waitcnt lgkmcnt(0)
    s_waitcnt vmcnt(24)
    s_barrier
    s_mov_b32 s59, 3145728
    s_add_u32 m0, s58, 98304
    s_nop 0
    buffer_load_dwordx4 v96, s[40:43], s59 offen lds
    s_add_u32 m0, s58, 99328
    s_nop 0
    buffer_load_dwordx4 v97, s[40:43], s59 offen lds
    s_add_u32 m0, s58, 100352
    s_nop 0
    buffer_load_dwordx4 v98, s[40:43], s59 offen lds
    s_add_u32 m0, s58, 101376
    s_nop 0
    buffer_load_dwordx4 v99, s[40:43], s59 offen lds
    ds_read_b64_tr_b16 a[184:185], v116 offset:49152
    ds_read_b64_tr_b16 a[186:187], v116 offset:49664
    ds_read_b64_tr_b16 a[188:189], v116 offset:57344
    ds_read_b64_tr_b16 a[190:191], v116 offset:57856
    ds_read_b64_tr_b16 a[248:249], v117 offset:49152
    ds_read_b64_tr_b16 a[250:251], v117 offset:49664
    ds_read_b64_tr_b16 a[252:253], v117 offset:57344
    ds_read_b64_tr_b16 a[254:255], v117 offset:57856
    s_waitcnt lgkmcnt(0)
    s_waitcnt vmcnt(24)
    s_barrier
    s_mov_b32 s59, 3670016
    s_add_u32 m0, s58, 114688
    s_nop 0
    buffer_load_dwordx4 v96, s[40:43], s59 offen lds
    s_add_u32 m0, s58, 115712
    s_nop 0
    buffer_load_dwordx4 v97, s[40:43], s59 offen lds
    s_add_u32 m0, s58, 116736
    s_nop 0
    buffer_load_dwordx4 v98, s[40:43], s59 offen lds
    s_add_u32 m0, s58, 117760
    s_nop 0
    buffer_load_dwordx4 v99, s[40:43], s59 offen lds
    ds_read_b64_tr_b16 v[128:129], v112 offset:0
    ds_read_b64_tr_b16 v[130:131], v112 offset:512
    ds_read_b64_tr_b16 v[132:133], v112 offset:8192
    ds_read_b64_tr_b16 v[134:135], v112 offset:8704
    ds_read_b64_tr_b16 v[192:193], v113 offset:0
    ds_read_b64_tr_b16 v[194:195], v113 offset:512
    ds_read_b64_tr_b16 v[196:197], v113 offset:8192
    ds_read_b64_tr_b16 v[198:199], v113 offset:8704
    s_waitcnt lgkmcnt(0)
    s_waitcnt vmcnt(24)
    s_barrier
    ds_read_b64_tr_b16 v[136:137], v112 offset:16384
    ds_read_b64_tr_b16 v[138:139], v112 offset:16896
    ds_read_b64_tr_b16 v[140:141], v112 offset:24576
    ds_read_b64_tr_b16 v[142:143], v112 offset:25088
    ds_read_b64_tr_b16 v[200:201], v113 offset:16384
    ds_read_b64_tr_b16 v[202:203], v113 offset:16896
    ds_read_b64_tr_b16 v[204:205], v113 offset:24576
    ds_read_b64_tr_b16 v[206:207], v113 offset:25088
    s_waitcnt lgkmcnt(0)
    s_waitcnt vmcnt(20)
    s_barrier
    ds_read_b64_tr_b16 v[144:145], v112 offset:32768
    ds_read_b64_tr_b16 v[146:147], v112 offset:33280
    ds_read_b64_tr_b16 v[148:149], v112 offset:40960
    ds_read_b64_tr_b16 v[150:151], v112 offset:41472
    ds_read_b64_tr_b16 v[208:209], v113 offset:32768
    ds_read_b64_tr_b16 v[210:211], v113 offset:33280
    ds_read_b64_tr_b16 v[212:213], v113 offset:40960
    ds_read_b64_tr_b16 v[214:215], v113 offset:41472
    s_waitcnt lgkmcnt(0)
    s_waitcnt vmcnt(16)
    s_barrier
    ds_read_b64_tr_b16 v[152:153], v112 offset:49152
    ds_read_b64_tr_b16 v[154:155], v112 offset:49664
    ds_read_b64_tr_b16 v[156:157], v112 offset:57344
    ds_read_b64_tr_b16 v[158:159], v112 offset:57856
    ds_read_b64_tr_b16 v[216:217], v113 offset:49152
    ds_read_b64_tr_b16 v[218:219], v113 offset:49664
    ds_read_b64_tr_b16 v[220:221], v113 offset:57344
    ds_read_b64_tr_b16 v[222:223], v113 offset:57856
    s_waitcnt lgkmcnt(0)
    s_waitcnt vmcnt(12)
    s_barrier
    ds_read_b64_tr_b16 v[160:161], v116 offset:0
    ds_read_b64_tr_b16 v[162:163], v116 offset:512
    ds_read_b64_tr_b16 v[164:165], v116 offset:8192
    ds_read_b64_tr_b16 v[166:167], v116 offset:8704
    ds_read_b64_tr_b16 v[224:225], v117 offset:0
    ds_read_b64_tr_b16 v[226:227], v117 offset:512
    ds_read_b64_tr_b16 v[228:229], v117 offset:8192
    ds_read_b64_tr_b16 v[230:231], v117 offset:8704
    s_waitcnt lgkmcnt(0)
    s_waitcnt vmcnt(8)
    s_barrier
    ds_read_b64_tr_b16 v[168:169], v116 offset:16384
    ds_read_b64_tr_b16 v[170:171], v116 offset:16896
    ds_read_b64_tr_b16 v[172:173], v116 offset:24576
    ds_read_b64_tr_b16 v[174:175], v116 offset:25088
    ds_read_b64_tr_b16 v[232:233], v117 offset:16384
    ds_read_b64_tr_b16 v[234:235], v117 offset:16896
    ds_read_b64_tr_b16 v[236:237], v117 offset:24576
    ds_read_b64_tr_b16 v[238:239], v117 offset:25088
    s_waitcnt lgkmcnt(0)
    s_waitcnt vmcnt(4)
    s_barrier
    ds_read_b64_tr_b16 v[176:177], v116 offset:32768
    ds_read_b64_tr_b16 v[178:179], v116 offset:33280
    ds_read_b64_tr_b16 v[180:181], v116 offset:40960
    ds_read_b64_tr_b16 v[182:183], v116 offset:41472
    ds_read_b64_tr_b16 v[240:241], v117 offset:32768
    ds_read_b64_tr_b16 v[242:243], v117 offset:33280
    ds_read_b64_tr_b16 v[244:245], v117 offset:40960
    ds_read_b64_tr_b16 v[246:247], v117 offset:41472
    s_waitcnt lgkmcnt(0)
    s_waitcnt vmcnt(0)
    s_barrier
    ds_read_b64_tr_b16 v[184:185], v116 offset:49152
    ds_read_b64_tr_b16 v[186:187], v116 offset:49664
    ds_read_b64_tr_b16 v[188:189], v116 offset:57344
    ds_read_b64_tr_b16 v[190:191], v116 offset:57856
    ds_read_b64_tr_b16 v[248:249], v117 offset:49152
    ds_read_b64_tr_b16 v[250:251], v117 offset:49664
    ds_read_b64_tr_b16 v[252:253], v117 offset:57344
    ds_read_b64_tr_b16 v[254:255], v117 offset:57856
    s_waitcnt lgkmcnt(0)
    s_cmp_lg_u32 s54, 0
    s_cbranch_scc1 qkrd_ok
qkrd_w:
    buffer_load_dword v127, off, s[24:27], s3 offset:4 sc1
    s_add_u32 s52, s52, 1
    s_waitcnt vmcnt(0)
    v_readfirstlane_b32 s59, v127
    s_nop 0
    s_cmp_ge_u32 s59, 2
    s_cbranch_scc1 qkrd_ok
    s_cmp_gt_u32 s52, 4194304
    s_cbranch_scc1 qkrd_ok
    s_sleep 1
    s_branch qkrd_w
qkrd_ok:
    s_barrier
    s_mov_b32 s72, s56
    s_sub_u32 s75, s56, 10
    s_mov_b32 s73, 0
    s_mov_b32 s74, 0x8000
    s_min_u32 s59, s72, 63
    s_lshl_b32 s59, s59, 15
    s_lshl_b32 s60, s54, 13
    s_add_u32 s59, s59, s60
    s_add_u32 s59, s59, 1048576
    s_add_u32 s60, s60, s73
    s_add_u32 m0, s60, 0
    s_nop 0
    buffer_load_dwordx4 v8, s[24:27], s59 offen offset:0 sc1 lds
    buffer_load_dwordx4 v8, s[24:27], s59 offen offset:1024 sc1 lds
    buffer_load_dwordx4 v8, s[24:27], s59 offen offset:2048 sc1 lds
    buffer_load_dwordx4 v8, s[24:27], s59 offen offset:3072 sc1 lds
    s_add_u32 m0, s60, 4096
    s_add_u32 s59, s59, 4096
    buffer_load_dwordx4 v8, s[24:27], s59 offen offset:0 sc1 lds
    buffer_load_dwordx4 v8, s[24:27], s59 offen offset:1024 sc1 lds
    buffer_load_dwordx4 v8, s[24:27], s59 offen offset:2048 sc1 lds
    buffer_load_dwordx4 v8, s[24:27], s59 offen offset:3072 sc1 lds
    s_and_b32 s98, s54, 1
    s_lshr_b32 s99, s54, 1
    s_mov_b32 s80, 0x3e0293ee
    v_and_b32 v1, 15, v0
    v_lshrrev_b32 v2, 4, v0
    v_lshlrev_b32 v3, 2, v2
    v_sub_u32 v3, v3, v1
    s_lshl_b32 s59, s98, 4
    v_subrev_u32 v3, s59, v3
    v_cmp_ge_i32 vcc, 0, v3
    s_nop 0
    s_mov_b64 s[82:83], vcc
    v_cmp_ge_i32 vcc, -1, v3
    s_nop 0
    s_mov_b64 s[84:85], vcc
    v_cmp_ge_i32 vcc, -2, v3
    s_nop 0
    s_mov_b64 s[86:87], vcc
    v_cmp_ge_i32 vcc, -3, v3
    s_nop 0
    s_mov_b64 s[88:89], vcc
    v_cmp_ge_i32_e64 vcc, -16, v3
    s_nop 0
    s_mov_b64 s[90:91], vcc
    v_cmp_ge_i32 vcc, -17, v3
    s_nop 0
    s_mov_b64 s[92:93], vcc
    v_cmp_ge_i32 vcc, -18, v3
    s_nop 0
    s_mov_b64 s[94:95], vcc
    v_cmp_ge_i32 vcc, -19, v3
    s_nop 0
    s_mov_b64 s[96:97], vcc
    v_lshrrev_b32 v3, 2, v1
    v_lshlrev_b32 v10, 8, v3
    v_lshl_add_u32 v10, v2, 6, v10
    v_and_b32_e64 v3, 1, v1
    v_lshl_add_u32 v10, v3, 2, v10
    v_mov_b32 v12, 0x3f803f80
    v_mov_b32 v13, 0x3f803f80
    v_mov_b32 v14, 0x3f803f80
    v_mov_b32 v15, 0x3f803f80
    v_mov_b32 v11, 0xceabdc6e
    s_mov_b32 s78, 0
    s_lshl_b32 s59, s98, 12
    s_add_u32 s59, s59, 65536
    v_add_u32_e64 v4, s59, v8
    v_add_u32 v5, 73728, v8
    s_lshl_b32 s59, s99, 12
    s_add_u32 s59, s59, 81920
    v_add_u32_e64 v6, s59, v8
    s_lshl_b32 s101, s55, 7
    s_add_u32 s101, s101, 7348224
    v_mov_b32 v7, 1
    v_and_b32 v117, 3, v0
    v_lshlrev_b32 v117, 2, v117
    s_lshl_b32 s100, s56, 14
    s_lshl_b32 s59, s98, 13
    s_add_u32 s100, s100, s59
    s_lshl_b32 s59, s55, 8
    s_add_u32 s100, s100, s59
    s_lshl_b32 s59, s99, 7
    s_add_u32 s100, s100, s59
    s_add_u32 s100, s100, 7405568
    s_mov_b32 s79, -1
    s_waitcnt vmcnt(0)
qa_loop:
    s_barrier
    s_mov_b32 s81, 0
    s_cmp_ge_i32 s75, 64
    s_cbranch_scc1 qa_last
    s_max_i32 s61, s75, 0
    s_and_b32 s61, s61, 63
    s_lshl_b32 s76, s61, 18
    s_lshl_b32 s60, s55, 13
    s_add_u32 s76, s76, s60
    s_lshl_b32 s60, s54, 11
    s_add_u32 s61, s76, s60
    s_cmp_ge_u32 s72, 64
    s_cbranch_scc1 qa_noq
    v_add_u32 v9, s73, v8
    ds_read_b128 v[64:67], v9 offset:0
    ds_read_b128 v[68:71], v9 offset:16384
    ds_read_b128 v[72:75], v9 offset:1024
    ds_read_b128 v[76:79], v9 offset:17408
    ds_read_b128 v[80:83], v9 offset:2048
    ds_read_b128 v[84:87], v9 offset:18432
    s_add_u32 s4, s72, 2
    s_min_u32 s4, s4, 63
    s_lshl_b32 s4, s4, 15
    s_lshl_b32 s5, s54, 13
    s_add_u32 s4, s4, s5
    s_add_u32 s4, s4, 1048576
    s_add_u32 s5, s5, s74
    s_waitcnt lgkmcnt(5)
    v_mfma_f32_16x16x32_bf16 v[16:19], a[0:3], v[64:67], 0
    v_mfma_f32_16x16x32_bf16 v[24:27], a[64:67], v[64:67], 0
    ds_read_b128 v[88:91], v9 offset:3072
    v_mfma_f32_16x16x32_bf16 v[32:35], a[128:131], v[64:67], 0
    s_add_u32 m0, s60, 65536
    s_add_u32 s59, s61, 16777216
    buffer_load_dwordx4 v8, s[24:27], s59 offen sc1 lds
    v_mfma_f32_16x16x32_bf16 v[40:43], a[192:195], v[64:67], 0
    v_mfma_f32_16x16x32_bf16 v[48:51], v[64:67], v[128:131], 0
    buffer_load_dwordx4 v8, s[24:27], s59 offen offset:1024 sc1 lds
    v_mfma_f32_16x16x32_bf16 v[56:59], v[64:67], v[192:195], 0
    s_waitcnt lgkmcnt(5)
    v_mfma_f32_16x16x32_bf16 v[20:23], a[0:3], v[68:71], 0
    v_mfma_f32_16x16x32_bf16 v[28:31], a[64:67], v[68:71], 0
    ds_read_b128 v[92:95], v9 offset:19456
    v_mfma_f32_16x16x32_bf16 v[36:39], a[128:131], v[68:71], 0
    s_add_u32 m0, s60, 73728
    s_add_u32 s59, s61, 33554432
    buffer_load_dwordx4 v8, s[24:27], s59 offen sc1 lds
    v_mfma_f32_16x16x32_bf16 v[44:47], a[192:195], v[68:71], 0
    v_mfma_f32_16x16x32_bf16 v[52:55], v[68:71], v[128:131], 0
    buffer_load_dwordx4 v8, s[24:27], s59 offen offset:1024 sc1 lds
    v_mfma_f32_16x16x32_bf16 v[60:63], v[68:71], v[192:195], 0
    s_waitcnt lgkmcnt(5)
    v_mfma_f32_16x16x32_bf16 v[16:19], a[4:7], v[72:75], v[16:19]
    v_mfma_f32_16x16x32_bf16 v[24:27], a[68:71], v[72:75], v[24:27]
    ds_read_b128 v[64:67], v9 offset:4096
    v_mfma_f32_16x16x32_bf16 v[32:35], a[132:135], v[72:75], v[32:35]
    s_add_u32 m0, s60, 81920
    s_add_u32 s59, s61, 50331648
    buffer_load_dwordx4 v8, s[24:27], s59 offen sc1 lds
    v_mfma_f32_16x16x32_bf16 v[40:43], a[196:199], v[72:75], v[40:43]
    v_mfma_f32_16x16x32_bf16 v[48:51], v[72:75], v[132:135], v[48:51]
    buffer_load_dwordx4 v8, s[24:27], s59 offen offset:1024 sc1 lds
    v_mfma_f32_16x16x32_bf16 v[56:59], v[72:75], v[196:199], v[56:59]
    s_waitcnt lgkmcnt(5)
    v_mfma_f32_16x16x32_bf16 v[20:23], a[4:7], v[76:79], v[20:23]
    v_mfma_f32_16x16x32_bf16 v[28:31], a[68:71], v[76:79], v[28:31]
    ds_read_b128 v[68:71], v9 offset:20480
    v_mfma_f32_16x16x32_bf16 v[36:39], a[132:135], v[76:79], v[36:39]
    s_add_u32 m0, s5, 0
    s_nop 0
    buffer_load_dwordx4 v8, s[24:27], s4 offen offset:0 sc1 lds
    v_mfma_f32_16x16x32_bf16 v[44:47], a[196:199], v[76:79], v[44:47]
    v_mfma_f32_16x16x32_bf16 v[52:55], v[76:79], v[132:135], v[52:55]
    buffer_load_dwordx4 v8, s[24:27], s4 offen offset:1024 sc1 lds
    v_mfma_f32_16x16x32_bf16 v[60:63], v[76:79], v[196:199], v[60:63]
    s_cmp_lt_i32 s79, 0
    s_cbranch_scc1 qakf_nf
    s_waitcnt vmcnt(10)
    s_mov_b64 exec, 1
    buffer_store_byte v7, off, s[24:27], s79 sc1
    s_mov_b64 exec, -1
qakf_nf:
    s_waitcnt lgkmcnt(5)
    v_mfma_f32_16x16x32_bf16 v[16:19], a[8:11], v[80:83], v[16:19]
    v_mfma_f32_16x16x32_bf16 v[24:27], a[72:75], v[80:83], v[24:27]
    ds_read_b128 v[72:75], v9 offset:5120
    v_mfma_f32_16x16x32_bf16 v[32:35], a[136:139], v[80:83], v[32:35]
    buffer_load_dwordx4 v8, s[24:27], s4 offen offset:2048 sc1 lds
    v_mfma_f32_16x16x32_bf16 v[40:43], a[200:203], v[80:83], v[40:43]
    v_mfma_f32_16x16x32_bf16 v[48:51], v[80:83], v[136:139], v[48:51]
    buffer_load_dwordx4 v8, s[24:27], s4 offen offset:3072 sc1 lds
    v_mfma_f32_16x16x32_bf16 v[56:59], v[80:83], v[200:203], v[56:59]
    s_waitcnt lgkmcnt(5)
    v_mfma_f32_16x16x32_bf16 v[20:23], a[8:11], v[84:87], v[20:23]
    v_mfma_f32_16x16x32_bf16 v[28:31], a[72:75], v[84:87], v[28:31]
    ds_read_b128 v[76:79], v9 offset:21504
    v_mfma_f32_16x16x32_bf16 v[36:39], a[136:139], v[84:87], v[36:39]
    s_add_u32 m0, s5, 4096
    s_add_u32 s4, s4, 4096
    buffer_load_dwordx4 v8, s[24:27], s4 offen offset:0 sc1 lds
    v_mfma_f32_16x16x32_bf16 v[44:47], a[200:203], v[84:87], v[44:47]
    v_mfma_f32_16x16x32_bf16 v[52:55], v[84:87], v[136:139], v[52:55]
    buffer_load_dwordx4 v8, s[24:27], s4 offen offset:1024 sc1 lds
    v_mfma_f32_16x16x32_bf16 v[60:63], v[84:87], v[200:203], v[60:63]
    s_waitcnt lgkmcnt(5)
    v_mfma_f32_16x16x32_bf16 v[16:19], a[12:15], v[88:91], v[16:19]
    v_mfma_f32_16x16x32_bf16 v[24:27], a[76:79], v[88:91], v[24:27]
    ds_read_b128 v[80:83], v9 offset:6144
    v_mfma_f32_16x16x32_bf16 v[32:35], a[140:143], v[88:91], v[32:35]
    buffer_load_dwordx4 v8, s[24:27], s4 offen offset:2048 sc1 lds
    v_mfma_f32_16x16x32_bf16 v[40:43], a[204:207], v[88:91], v[40:43]
    v_mfma_f32_16x16x32_bf16 v[48:51], v[88:91], v[140:143], v[48:51]
    buffer_load_dwordx4 v8, s[24:27], s4 offen offset:3072 sc1 lds
    v_mfma_f32_16x16x32_bf16 v[56:59], v[88:91], v[204:207], v[56:59]
    s_waitcnt lgkmcnt(5)
    v_mfma_f32_16x16x32_bf16 v[20:23], a[12:15], v[92:95], v[20:23]
    v_mfma_f32_16x16x32_bf16 v[28:31], a[76:79], v[92:95], v[28:31]
    ds_read_b128 v[84:87], v9 offset:22528
    v_mfma_f32_16x16x32_bf16 v[36:39], a[140:143], v[92:95], v[36:39]
    buffer_load_dword v116, v117, s[24:27], s101 offen sc1
    v_mfma_f32_16x16x32_bf16 v[44:47], a[204:207], v[92:95], v[44:47]
    v_mfma_f32_16x16x32_bf16 v[52:55], v[92:95], v[140:143], v[52:55]
    v_mfma_f32_16x16x32_bf16 v[60:63], v[92:95], v[204:207], v[60:63]
    s_waitcnt lgkmcnt(5)
    v_mfma_f32_16x16x32_bf16 v[16:19], a[16:19], v[64:67], v[16:19]
    v_mfma_f32_16x16x32_bf16 v[24:27], a[80:83], v[64:67], v[24:27]
    ds_read_b128 v[88:91], v9 offset:7168
    v_mfma_f32_16x16x32_bf16 v[32:35], a[144:147], v[64:67], v[32:35]
    v_mfma_f32_16x16x32_bf16 v[40:43], a[208:211], v[64:67], v[40:43]
    v_mfma_f32_16x16x32_bf16 v[48:51], v[64:67], v[144:147], v[48:51]
    v_mfma_f32_16x16x32_bf16 v[56:59], v[64:67], v[208:211], v[56:59]
    s_waitcnt lgkmcnt(5)
    v_mfma_f32_16x16x32_bf16 v[20:23], a[16:19], v[68:71], v[20:23]
    v_mfma_f32_16x16x32_bf16 v[28:31], a[80:83], v[68:71], v[28:31]
    ds_read_b128 v[92:95], v9 offset:23552
    v_mfma_f32_16x16x32_bf16 v[36:39], a[144:147], v[68:71], v[36:39]
    v_mfma_f32_16x16x32_bf16 v[44:47], a[208:211], v[68:71], v[44:47]
    v_mfma_f32_16x16x32_bf16 v[52:55], v[68:71], v[144:147], v[52:55]
    v_mfma_f32_16x16x32_bf16 v[60:63], v[68:71], v[208:211], v[60:63]
    s_waitcnt lgkmcnt(5)
    v_mfma_f32_16x16x32_bf16 v[16:19], a[20:23], v[72:75], v[16:19]
    v_mfma_f32_16x16x32_bf16 v[24:27], a[84:87], v[72:75], v[24:27]
    ds_read_b128 v[64:67], v9 offset:8192
    v_mfma_f32_16x16x32_bf16 v[32:35], a[148:151], v[72:75], v[32:35]
    v_mfma_f32_16x16x32_bf16 v[40:43], a[212:215], v[72:75], v[40:43]
    v_mfma_f32_16x16x32_bf16 v[48:51], v[72:75], v[148:151], v[48:51]
    v_mfma_f32_16x16x32_bf16 v[56:59], v[72:75], v[212:215], v[56:59]
    s_cmp_eq_u32 s78, 0
    s_cbranch_scc1 qaof_nf
    s_waitcnt vmcnt(15)
    v_mov_b32_e64 v3, s78
    s_mov_b64 exec, 1
    buffer_store_dword v3, off, s[24:27], s100 sc1
    s_mov_b64 exec, -1
    s_mov_b32 s78, 0
qaof_nf:
    s_waitcnt lgkmcnt(5)
    v_mfma_f32_16x16x32_bf16 v[20:23], a[20:23], v[76:79], v[20:23]
    v_mfma_f32_16x16x32_bf16 v[28:31], a[84:87], v[76:79], v[28:31]
    ds_read_b128 v[68:71], v9 offset:24576
    v_mfma_f32_16x16x32_bf16 v[36:39], a[148:151], v[76:79], v[36:39]
    v_mfma_f32_16x16x32_bf16 v[44:47], a[212:215], v[76:79], v[44:47]
    v_mfma_f32_16x16x32_bf16 v[52:55], v[76:79], v[148:151], v[52:55]
    v_mfma_f32_16x16x32_bf16 v[60:63], v[76:79], v[212:215], v[60:63]
    s_waitcnt lgkmcnt(5)
    v_mfma_f32_16x16x32_bf16 v[16:19], a[24:27], v[80:83], v[16:19]
    v_mfma_f32_16x16x32_bf16 v[24:27], a[88:91], v[80:83], v[24:27]
    ds_read_b128 v[72:75], v9 offset:9216
    v_mfma_f32_16x16x32_bf16 v[32:35], a[152:155], v[80:83], v[32:35]
    v_mfma_f32_16x16x32_bf16 v[40:43], a[216:219], v[80:83], v[40:43]
    v_mfma_f32_16x16x32_bf16 v[48:51], v[80:83], v[152:155], v[48:51]
    v_mfma_f32_16x16x32_bf16 v[56:59], v[80:83], v[216:219], v[56:59]
    s_waitcnt lgkmcnt(5)
    v_mfma_f32_16x16x32_bf16 v[20:23], a[24:27], v[84:87], v[20:23]
    v_mfma_f32_16x16x32_bf16 v[28:31], a[88:91], v[84:87], v[28:31]
    ds_read_b128 v[76:79], v9 offset:25600
    v_mfma_f32_16x16x32_bf16 v[36:39], a[152:155], v[84:87], v[36:39]
    v_mfma_f32_16x16x32_bf16 v[44:47], a[216:219], v[84:87], v[44:47]
    v_mfma_f32_16x16x32_bf16 v[52:55], v[84:87], v[152:155], v[52:55]
    v_mfma_f32_16x16x32_bf16 v[60:63], v[84:87], v[216:219], v[60:63]
    s_waitcnt lgkmcnt(5)
    v_mfma_f32_16x16x32_bf16 v[16:19], a[28:31], v[88:91], v[16:19]
    v_mfma_f32_16x16x32_bf16 v[24:27], a[92:95], v[88:91], v[24:27]
    ds_read_b128 v[80:83], v9 offset:10240
    v_mfma_f32_16x16x32_bf16 v[32:35], a[156:159], v[88:91], v[32:35]
    v_mfma_f32_16x16x32_bf16 v[40:43], a[220:223], v[88:91], v[40:43]
    v_mfma_f32_16x16x32_bf16 v[48:51], v[88:91], v[156:159], v[48:51]
    v_mfma_f32_16x16x32_bf16 v[56:59], v[88:91], v[220:223], v[56:59]
    s_waitcnt lgkmcnt(5)
    v_mfma_f32_16x16x32_bf16 v[20:23], a[28:31], v[92:95], v[20:23]
    v_mfma_f32_16x16x32_bf16 v[28:31], a[92:95], v[92:95], v[28:31]
    ds_read_b128 v[84:87], v9 offset:26624
    v_mfma_f32_16x16x32_bf16 v[36:39], a[156:159], v[92:95], v[36:39]
    v_mfma_f32_16x16x32_bf16 v[44:47], a[220:223], v[92:95], v[44:47]
    v_mfma_f32_16x16x32_bf16 v[52:55], v[92:95], v[156:159], v[52:55]
    v_mfma_f32_16x16x32_bf16 v[60:63], v[92:95], v[220:223], v[60:63]
    s_waitcnt lgkmcnt(5)
    v_mfma_f32_16x16x32_bf16 v[16:19], a[32:35], v[64:67], v[16:19]
    v_mfma_f32_16x16x32_bf16 v[24:27], a[96:99], v[64:67], v[24:27]
    ds_read_b128 v[88:91], v9 offset:11264
    v_mfma_f32_16x16x32_bf16 v[32:35], a[160:163], v[64:67], v[32:35]
    v_mfma_f32_16x16x32_bf16 v[40:43], a[224:227], v[64:67], v[40:43]
    v_mfma_f32_16x16x32_bf16 v[48:51], v[64:67], v[160:163], v[48:51]
    v_mfma_f32_16x16x32_bf16 v[56:59], v[64:67], v[224:227], v[56:59]
    s_waitcnt lgkmcnt(5)
    v_mfma_f32_16x16x32_bf16 v[20:23], a[32:35], v[68:71], v[20:23]
    v_mfma_f32_16x16x32_bf16 v[28:31], a[96:99], v[68:71], v[28:31]
    ds_read_b128 v[92:95], v9 offset:27648
    v_mfma_f32_16x16x32_bf16 v[36:39], a[160:163], v[68:71], v[36:39]
    v_mfma_f32_16x16x32_bf16 v[44:47], a[224:227], v[68:71], v[44:47]
    v_mfma_f32_16x16x32_bf16 v[52:55], v[68:71], v[160:163], v[52:55]
    v_mfma_f32_16x16x32_bf16 v[60:63], v[68:71], v[224:227], v[60:63]
    s_waitcnt lgkmcnt(5)
    v_mfma_f32_16x16x32_bf16 v[16:19], a[36:39], v[72:75], v[16:19]
    v_mfma_f32_16x16x32_bf16 v[24:27], a[100:103], v[72:75], v[24:27]
    ds_read_b128 v[64:67], v9 offset:12288
    v_mfma_f32_16x16x32_bf16 v[32:35], a[164:167], v[72:75], v[32:35]
    v_mfma_f32_16x16x32_bf16 v[40:43], a[228:231], v[72:75], v[40:43]
    v_mfma_f32_16x16x32_bf16 v[48:51], v[72:75], v[164:167], v[48:51]
    v_mfma_f32_16x16x32_bf16 v[56:59], v[72:75], v[228:231], v[56:59]
    s_waitcnt lgkmcnt(5)
    v_mfma_f32_16x16x32_bf16 v[20:23], a[36:39], v[76:79], v[20:23]
    v_mfma_f32_16x16x32_bf16 v[28:31], a[100:103], v[76:79], v[28:31]
    ds_read_b128 v[68:71], v9 offset:28672
    v_mfma_f32_16x16x32_bf16 v[36:39], a[164:167], v[76:79], v[36:39]
    v_mfma_f32_16x16x32_bf16 v[44:47], a[228:231], v[76:79], v[44:47]
    v_mfma_f32_16x16x32_bf16 v[52:55], v[76:79], v[164:167], v[52:55]
    v_mfma_f32_16x16x32_bf16 v[60:63], v[76:79], v[228:231], v[60:63]
    s_waitcnt lgkmcnt(5)
    v_mfma_f32_16x16x32_bf16 v[16:19], a[40:43], v[80:83], v[16:19]
    v_mfma_f32_16x16x32_bf16 v[24:27], a[104:107], v[80:83], v[24:27]
    ds_read_b128 v[72:75], v9 offset:13312
    v_mfma_f32_16x16x32_bf16 v[32:35], a[168:171], v[80:83], v[32:35]
    v_mfma_f32_16x16x32_bf16 v[40:43], a[232:235], v[80:83], v[40:43]
    v_mfma_f32_16x16x32_bf16 v[48:51], v[80:83], v[168:171], v[48:51]
    v_mfma_f32_16x16x32_bf16 v[56:59], v[80:83], v[232:235], v[56:59]
    s_waitcnt vmcnt(1)
    s_cmp_lt_i32 s75, 2
    s_cbranch_scc0 qa_fl
    s_waitcnt vmcnt(0)
qa_fl:
    v_cmp_ge_i32 vcc, s75, v116
    s_lshr_b32 s4, s76, 1
    s_add_u32 s4, s4, 84934656
    s_cmp_eq_u64 vcc, 0
    s_cselect_b32 s81, 1, 0
    s_cselect_b32 s4, s4, 0x40000000
    s_lshl_b32 s5, s99, 11
    s_add_u32 s5, s5, s4
    s_waitcnt lgkmcnt(5)
    v_mfma_f32_16x16x32_bf16 v[20:23], a[40:43], v[84:87], v[20:23]
    v_mfma_f32_16x16x32_bf16 v[28:31], a[104:107], v[84:87], v[28:31]
    ds_read_b128 v[76:79], v9 offset:29696
    v_mfma_f32_16x16x32_bf16 v[36:39], a[168:171], v[84:87], v[36:39]
    buffer_load_dword v96, v10, s[24:27], s4 offen offset:0 sc1
    v_mfma_f32_16x16x32_bf16 v[44:47], a[232:235], v[84:87], v[44:47]
    v_mfma_f32_16x16x32_bf16 v[52:55], v[84:87], v[168:171], v[52:55]
    buffer_load_dword v97, v10, s[24:27], s4 offen offset:16 sc1
    v_mfma_f32_16x16x32_bf16 v[60:63], v[84:87], v[232:235], v[60:63]
    s_waitcnt lgkmcnt(5)
    v_mfma_f32_16x16x32_bf16 v[16:19], a[44:47], v[88:91], v[16:19]
    v_mfma_f32_16x16x32_bf16 v[24:27], a[108:111], v[88:91], v[24:27]
    ds_read_b128 v[80:83], v9 offset:14336
    v_mfma_f32_16x16x32_bf16 v[32:35], a[172:175], v[88:91], v[32:35]
    buffer_load_dword v98, v10, s[24:27], s4 offen offset:32 sc1
    v_mfma_f32_16x16x32_bf16 v[40:43], a[236:239], v[88:91], v[40:43]
    v_mfma_f32_16x16x32_bf16 v[48:51], v[88:91], v[172:175], v[48:51]
    buffer_load_dword v99, v10, s[24:27], s4 offen offset:48 sc1
    v_mfma_f32_16x16x32_bf16 v[56:59], v[88:91], v[236:239], v[56:59]
    s_waitcnt lgkmcnt(5)
    v_mfma_f32_16x16x32_bf16 v[20:23], a[44:47], v[92:95], v[20:23]
    v_mfma_f32_16x16x32_bf16 v[28:31], a[108:111], v[92:95], v[28:31]
    ds_read_b128 v[84:87], v9 offset:30720
    v_mfma_f32_16x16x32_bf16 v[36:39], a[172:175], v[92:95], v[36:39]
    buffer_load_dword v100, v10, s[24:27], s4 offen offset:1024 sc1
    v_mfma_f32_16x16x32_bf16 v[44:47], a[236:239], v[92:95], v[44:47]
    v_mfma_f32_16x16x32_bf16 v[52:55], v[92:95], v[172:175], v[52:55]
    buffer_load_dword v101, v10, s[24:27], s4 offen offset:1040 sc1
    v_mfma_f32_16x16x32_bf16 v[60:63], v[92:95], v[236:239], v[60:63]
    s_waitcnt lgkmcnt(5)
    v_mfma_f32_16x16x32_bf16 v[16:19], a[48:51], v[64:67], v[16:19]
    v_mfma_f32_16x16x32_bf16 v[24:27], a[112:115], v[64:67], v[24:27]
    ds_read_b128 v[88:91], v9 offset:15360
    v_mfma_f32_16x16x32_bf16 v[32:35], a[176:179], v[64:67], v[32:35]
    buffer_load_dword v102, v10, s[24:27], s4 offen offset:1056 sc1
    v_mfma_f32_16x16x32_bf16 v[40:43], a[240:243], v[64:67], v[40:43]
    v_mfma_f32_16x16x32_bf16 v[48:51], v[64:67], v[176:179], v[48:51]
    buffer_load_dword v103, v10, s[24:27], s4 offen offset:1072 sc1
    v_mfma_f32_16x16x32_bf16 v[56:59], v[64:67], v[240:243], v[56:59]
    s_waitcnt lgkmcnt(5)
    v_mfma_f32_16x16x32_bf16 v[20:23], a[48:51], v[68:71], v[20:23]
    v_mfma_f32_16x16x32_bf16 v[28:31], a[112:115], v[68:71], v[28:31]
    ds_read_b128 v[92:95], v9 offset:31744
    v_mfma_f32_16x16x32_bf16 v[36:39], a[176:179], v[68:71], v[36:39]
    buffer_load_dword v104, v10, s[24:27], s4 offen offset:2048 sc1
    v_mfma_f32_16x16x32_bf16 v[44:47], a[240:243], v[68:71], v[44:47]
    v_mfma_f32_16x16x32_bf16 v[52:55], v[68:71], v[176:179], v[52:55]
    buffer_load_dword v105, v10, s[24:27], s4 offen offset:2064 sc1
    v_mfma_f32_16x16x32_bf16 v[60:63], v[68:71], v[240:243], v[60:63]
    s_waitcnt lgkmcnt(5)
    v_mfma_f32_16x16x32_bf16 v[16:19], a[52:55], v[72:75], v[16:19]
    v_mfma_f32_16x16x32_bf16 v[24:27], a[116:119], v[72:75], v[24:27]
    v_mfma_f32_16x16x32_bf16 v[32:35], a[180:183], v[72:75], v[32:35]
    buffer_load_dword v106, v10, s[24:27], s4 offen offset:2080 sc1
    v_mfma_f32_16x16x32_bf16 v[40:43], a[244:247], v[72:75], v[40:43]
    v_mfma_f32_16x16x32_bf16 v[48:51], v[72:75], v[180:183], v[48:51]
    buffer_load_dword v107, v10, s[24:27], s4 offen offset:2096 sc1
    v_mfma_f32_16x16x32_bf16 v[56:59], v[72:75], v[244:247], v[56:59]
    s_waitcnt lgkmcnt(4)
    v_mfma_f32_16x16x32_bf16 v[20:23], a[52:55], v[76:79], v[20:23]
    v_mfma_f32_16x16x32_bf16 v[28:31], a[116:119], v[76:79], v[28:31]
    v_mfma_f32_16x16x32_bf16 v[36:39], a[180:183], v[76:79], v[36:39]
    buffer_load_dword v108, v10, s[24:27], s4 offen offset:3072 sc1
    v_mfma_f32_16x16x32_bf16 v[44:47], a[244:247], v[76:79], v[44:47]
    v_mfma_f32_16x16x32_bf16 v[52:55], v[76:79], v[180:183], v[52:55]
    buffer_load_dword v109, v10, s[24:27], s4 offen offset:3088 sc1
    v_mfma_f32_16x16x32_bf16 v[60:63], v[76:79], v[244:247], v[60:63]
    s_waitcnt lgkmcnt(3)
    v_mfma_f32_16x16x32_bf16 v[16:19], a[56:59], v[80:83], v[16:19]
    v_mfma_f32_16x16x32_bf16 v[24:27], a[120:123], v[80:83], v[24:27]
    v_mfma_f32_16x16x32_bf16 v[32:35], a[184:187], v[80:83], v[32:35]
    buffer_load_dword v110, v10, s[24:27], s4 offen offset:3104 sc1
    v_mfma_f32_16x16x32_bf16 v[40:43], a[248:251], v[80:83], v[40:43]
    v_mfma_f32_16x16x32_bf16 v[48:51], v[80:83], v[184:187], v[48:51]
    buffer_load_dword v111, v10, s[24:27], s4 offen offset:3120 sc1
    v_mfma_f32_16x16x32_bf16 v[56:59], v[80:83], v[248:251], v[56:59]
    s_waitcnt lgkmcnt(2)
    v_mfma_f32_16x16x32_bf16 v[20:23], a[56:59], v[84:87], v[20:23]
    v_mfma_f32_16x16x32_bf16 v[28:31], a[120:123], v[84:87], v[28:31]
    v_mfma_f32_16x16x32_bf16 v[36:39], a[184:187], v[84:87], v[36:39]
    buffer_load_dwordx2 v[112:113], v8, s[24:27], s5 offen offset:8 sc1
    v_mfma_f32_16x16x32_bf16 v[44:47], a[248:251], v[84:87], v[44:47]
    v_mfma_f32_16x16x32_bf16 v[52:55], v[84:87], v[184:187], v[52:55]
    buffer_load_dwordx2 v[114:115], v8, s[24:27], s5 offen offset:1032 sc1
    v_mfma_f32_16x16x32_bf16 v[60:63], v[84:87], v[248:251], v[60:63]
    s_waitcnt lgkmcnt(1)
    v_mfma_f32_16x16x32_bf16 v[16:19], a[60:63], v[88:91], v[16:19]
    v_mfma_f32_16x16x32_bf16 v[24:27], a[124:127], v[88:91], v[24:27]
    v_mfma_f32_16x16x32_bf16 v[32:35], a[188:191], v[88:91], v[32:35]
    v_mfma_f32_16x16x32_bf16 v[40:43], a[252:255], v[88:91], v[40:43]
    v_mfma_f32_16x16x32_bf16 v[48:51], v[88:91], v[188:191], v[48:51]
    v_mfma_f32_16x16x32_bf16 v[56:59], v[88:91], v[252:255], v[56:59]
    s_waitcnt lgkmcnt(0)
    v_mfma_f32_16x16x32_bf16 v[20:23], a[60:63], v[92:95], v[20:23]
    v_mfma_f32_16x16x32_bf16 v[28:31], a[124:127], v[92:95], v[28:31]
    v_mfma_f32_16x16x32_bf16 v[36:39], a[188:191], v[92:95], v[36:39]
    v_mfma_f32_16x16x32_bf16 v[44:47], a[252:255], v[92:95], v[44:47]
    v_mfma_f32_16x16x32_bf16 v[52:55], v[92:95], v[188:191], v[52:55]
    v_mfma_f32_16x16x32_bf16 v[60:63], v[92:95], v[252:255], v[60:63]
    s_and_b32 s59, s72, 63
    s_lshl_b32 s59, s59, 18
    s_lshl_b32 s60, s55, 13
    s_add_u32 s59, s59, s60
    s_lshl_b32 s60, s54, 10
    s_add_u32 s61, s59, s60
    s_add_u32 s62, s61, s60
    s_barrier
    v_cvt_pk_bf16_f32 v32, v32, v40
    v_cvt_pk_bf16_f32 v33, v33, v41
    v_cvt_pk_bf16_f32 v34, v34, v42
    v_cvt_pk_bf16_f32 v35, v35, v43
    s_add_u32 s59, s61, 33554432
    buffer_store_dwordx4 v[32:35], v8, s[24:27], s59 offen sc1
    v_cvt_pk_bf16_f32 v36, v36, v44
    v_cvt_pk_bf16_f32 v37, v37, v45
    v_cvt_pk_bf16_f32 v38, v38, v46
    v_cvt_pk_bf16_f32 v39, v39, v47
    s_add_u32 s59, s61, 33558528
    buffer_store_dwordx4 v[36:39], v8, s[24:27], s59 offen sc1
    v_cvt_pk_bf16_f32 v16, v16, v24
    v_cvt_pk_bf16_f32 v17, v17, v25
    v_cvt_pk_bf16_f32 v18, v18, v26
    v_cvt_pk_bf16_f32 v19, v19, v27
    s_add_u32 s59, s61, 16777216
    buffer_store_dwordx4 v[16:19], v8, s[24:27], s59 offen
    v_cvt_pk_bf16_f32 v20, v20, v28
    v_cvt_pk_bf16_f32 v21, v21, v29
    v_cvt_pk_bf16_f32 v22, v22, v30
    v_cvt_pk_bf16_f32 v23, v23, v31
    s_add_u32 s59, s61, 16781312
    buffer_store_dwordx4 v[20:23], v8, s[24:27], s59 offen
    s_add_u32 s59, s62, 50331648
    v_cvt_pk_bf16_f32 v48, v48, v49
    v_cvt_pk_bf16_f32 v49, v50, v51
    v_cvt_pk_bf16_f32 v50, v52, v53
    v_cvt_pk_bf16_f32 v51, v54, v55
    buffer_store_dwordx4 v[48:51], v8, s[24:27], s59 offen offset:0 sc1
    v_cvt_pk_bf16_f32 v56, v56, v57
    v_cvt_pk_bf16_f32 v57, v58, v59
    v_cvt_pk_bf16_f32 v58, v60, v61
    v_cvt_pk_bf16_f32 v59, v62, v63
    buffer_store_dwordx4 v[56:59], v8, s[24:27], s59 offen offset:1024 sc1
    s_lshl_b32 s79, s55, 8
    s_lshl_b32 s60, s72, 2
    s_add_u32 s79, s79, s60
    s_add_u32 s79, s79, s54
    s_add_u32 s79, s79, 7340032
    s_mov_b32 s59, s73
    s_mov_b32 s73, s74
    s_mov_b32 s74, s59
    s_add_u32 s72, s72, 2
    s_cmp_lt_i32 s75, 0
    s_cbranch_scc0 qa_att2
    s_waitcnt vmcnt(0)
    s_mov_b64 exec, 1
    buffer_store_byte v7, off, s[24:27], s79 sc1
    s_mov_b64 exec, -1
    s_mov_b32 s79, -1
    s_cmp_lg_u32 s54, 0
    s_cbranch_scc1 qkr3_ok
qkr3_w:
    buffer_load_dword v127, off, s[24:27], s3 offset:8 sc1
    s_add_u32 s52, s52, 1
    s_waitcnt vmcnt(0)
    v_readfirstlane_b32 s59, v127
    s_nop 0
    s_cmp_ge_u32 s59, 3
    s_cbranch_scc1 qkr3_ok
    s_cmp_gt_u32 s52, 4194304
    s_cbranch_scc1 qkr3_ok
    s_sleep 1
    s_branch qkr3_w
qkr3_ok:
    s_barrier
    s_add_u32 s75, s75, 2
    s_branch qa_loop
qa_last:
    s_waitcnt vmcnt(0)
    v_mov_b32_e64 v3, s78
    s_mov_b64 exec, 1
    buffer_store_dword v3, off, s[24:27], s100 sc1
    s_mov_b64 exec, -1
    s_branch qa_end
qa_noq:
    s_add_u32 m0, s60, 65536
    s_add_u32 s59, s61, 16777216
    buffer_load_dwordx4 v8, s[24:27], s59 offen sc1 lds
    buffer_load_dwordx4 v8, s[24:27], s59 offen offset:1024 sc1 lds
    s_add_u32 m0, s60, 73728
    s_add_u32 s59, s61, 33554432
    buffer_load_dwordx4 v8, s[24:27], s59 offen sc1 lds
    buffer_load_dwordx4 v8, s[24:27], s59 offen offset:1024 sc1 lds
    s_add_u32 m0, s60, 81920
    s_add_u32 s59, s61, 50331648
    buffer_load_dwordx4 v8, s[24:27], s59 offen sc1 lds
    buffer_load_dwordx4 v8, s[24:27], s59 offen offset:1024 sc1 lds
    s_waitcnt vmcnt(6)
    s_cmp_lt_i32 s79, 0
    s_cbranch_scc1 qakf2_nf
    s_mov_b64 exec, 1
    buffer_store_byte v7, off, s[24:27], s79 sc1
    s_mov_b64 exec, -1
    s_mov_b32 s79, -1
qakf2_nf:
    v_mov_b32 v3, s78
    s_mov_b64 exec, 1
    buffer_store_dword v3, off, s[24:27], s100 sc1
    s_mov_b64 exec, -1
    s_waitcnt vmcnt(1)
    s_barrier
qa_att2:
    ds_read_b128 v[64:67], v4 offset:0
    ds_read_b128 v[68:71], v4 offset:1024
    ds_read_b128 v[72:75], v4 offset:2048
    ds_read_b128 v[76:79], v4 offset:3072
    ds_read_b128 v[16:19], v5 offset:0
    ds_read_b128 v[20:23], v5 offset:1024
    ds_read_b128 v[24:27], v5 offset:2048
    ds_read_b128 v[28:31], v5 offset:3072
    ds_read_b128 v[32:35], v5 offset:4096
    ds_read_b128 v[36:39], v5 offset:5120
    ds_read_b128 v[40:43], v5 offset:6144
    ds_read_b128 v[44:47], v5 offset:7168
    s_waitcnt lgkmcnt(4)
    ds_read_b128 v[80:83], v6 offset:0
    ds_read_b128 v[84:87], v6 offset:1024
    ds_read_b128 v[88:91], v6 offset:2048
    ds_read_b128 v[92:95], v6 offset:3072
    v_mfma_f32_16x16x32_bf16 v[48:51], v[16:19], v[64:67], 0
    v_mfma_f32_16x16x32_bf16 v[48:51], v[20:23], v[68:71], v[48:51]
    v_mfma_f32_16x16x32_bf16 v[48:51], v[24:27], v[72:75], v[48:51]
    v_mfma_f32_16x16x32_bf16 v[48:51], v[28:31], v[76:79], v[48:51]
    s_waitcnt lgkmcnt(4)
    v_mfma_f32_16x16x32_bf16 v[52:55], v[32:35], v[64:67], 0
    v_mfma_f32_16x16x32_bf16 v[52:55], v[36:39], v[68:71], v[52:55]
    v_mfma_f32_16x16x32_bf16 v[52:55], v[40:43], v[72:75], v[52:55]
    v_mfma_f32_16x16x32_bf16 v[52:55], v[44:47], v[76:79], v[52:55]
    v_mul_f32 v48, s80, v48
    v_mul_f32 v49, s80, v49
    v_mul_f32 v50, s80, v50
    v_mul_f32 v51, s80, v51
    s_nop 3
    v_mul_f32 v52, s80, v52
    v_mul_f32 v53, s80, v53
    v_mul_f32 v54, s80, v54
    v_mul_f32 v55, s80, v55
    v_cndmask_b32 v48, v11, v48, s[82:83]
    v_cndmask_b32 v49, v11, v49, s[84:85]
    v_cndmask_b32 v50, v11, v50, s[86:87]
    v_cndmask_b32 v51, v11, v51, s[88:89]
    v_cndmask_b32 v52, v11, v52, s[90:91]
    v_cndmask_b32 v53, v11, v53, s[92:93]
    v_cndmask_b32 v54, v11, v54, s[94:95]
    v_cndmask_b32 v55, v11, v55, s[96:97]
    v_max3_f32 v118, v48, v49, v50
    v_max3_f32 v119, v51, v52, v53
    v_max3_f32 v118, v118, v54, v55
    v_max_f32_e64 v118, v118, v119
    s_cmp_eq_u32 s81, 1
    s_cbranch_scc1 att_rdy
att_poll:
    buffer_load_dword v116, v117, s[24:27], s101 offen sc1
    s_add_u32 s52, s52, 1
    s_waitcnt vmcnt(0)
    v_cmp_ge_i32_e64 vcc, s75, v116
    s_cbranch_vccz att_go
    s_cmp_lt_i32 s79, 0
    s_cbranch_scc1 att_nk
    s_mov_b64 exec, 1
    buffer_store_byte v7, off, s[24:27], s79 sc1
    s_mov_b64 exec, -1
    s_mov_b32 s79, -1
att_nk:
    s_cmp_gt_u32 s52, 4194304
    s_cbranch_scc1 att_go
    s_sleep 1
    s_branch att_poll
att_go:
    s_lshr_b32 s59, s76, 1
    s_add_u32 s59, s59, 84934656
    buffer_load_dword v96, v10, s[24:27], s59 offen offset:0 sc1
    buffer_load_dword v97, v10, s[24:27], s59 offen offset:16 sc1
    buffer_load_dword v98, v10, s[24:27], s59 offen offset:32 sc1
    buffer_load_dword v99, v10, s[24:27], s59 offen offset:48 sc1
    buffer_load_dword v100, v10, s[24:27], s59 offen offset:1024 sc1
    buffer_load_dword v101, v10, s[24:27], s59 offen offset:1040 sc1
    buffer_load_dword v102, v10, s[24:27], s59 offen offset:1056 sc1
    buffer_load_dword v103, v10, s[24:27], s59 offen offset:1072 sc1
    buffer_load_dword v104, v10, s[24:27], s59 offen offset:2048 sc1
    buffer_load_dword v105, v10, s[24:27], s59 offen offset:2064 sc1
    buffer_load_dword v106, v10, s[24:27], s59 offen offset:2080 sc1
    buffer_load_dword v107, v10, s[24:27], s59 offen offset:2096 sc1
    buffer_load_dword v108, v10, s[24:27], s59 offen offset:3072 sc1
    buffer_load_dword v109, v10, s[24:27], s59 offen offset:3088 sc1
    buffer_load_dword v110, v10, s[24:27], s59 offen offset:3104 sc1
    buffer_load_dword v111, v10, s[24:27], s59 offen offset:3120 sc1
    s_lshl_b32 s60, s99, 11
    s_add_u32 s59, s59, s60
    buffer_load_dwordx2 v[112:113], v8, s[24:27], s59 offen offset:8 sc1
    buffer_load_dwordx2 v[114:115], v8, s[24:27], s59 offen offset:1032 sc1
    s_waitcnt vmcnt(0)
    s_branch att_have
att_rdy:
    s_waitcnt vmcnt(6)
att_have:
    v_mfma_f32_16x16x32_bf16 v[56:59], v[96:99], v[64:67], 0
    v_mfma_f32_16x16x32_bf16 v[56:59], v[100:103], v[68:71], v[56:59]
    v_mfma_f32_16x16x32_bf16 v[56:59], v[104:107], v[72:75], v[56:59]
    v_mfma_f32_16x16x32_bf16 v[56:59], v[108:111], v[76:79], v[56:59]
    v_mov_b32 v32, v112
    v_mov_b32 v33, 0
    v_mov_b32 v34, v113
    v_mov_b32 v35, 0
    v_mov_b32 v36, v114
    v_mov_b32 v37, 0
    v_mov_b32 v38, v115
    v_mov_b32 v39, 0
    v_mul_f32 v56, s80, v56
    v_mul_f32_e64 v57, s80, v57
    v_max3_f32 v118, v118, v56, v57
    v_mov_b32 v119, v118
    s_nop 1
    v_permlane16_swap_b32 v119, v118
    v_max_f32 v118, v119, v118
    v_mov_b32 v119, v118
    s_nop 1
    v_permlane32_swap_b32 v119, v118
    v_max_f32 v118, v119, v118
    v_sub_f32 v48, v48, v118
    v_sub_f32 v49, v49, v118
    v_sub_f32 v50, v50, v118
    v_sub_f32 v51, v51, v118
    v_sub_f32 v52, v52, v118
    v_sub_f32 v53, v53, v118
    v_sub_f32 v54, v54, v118
    v_sub_f32 v55, v55, v118
    v_sub_f32 v56, v56, v118
    v_sub_f32 v57, v57, v118
    v_exp_f32 v48, v48
    v_exp_f32 v49, v49
    v_exp_f32 v50, v50
    v_exp_f32 v51, v51
    v_exp_f32 v52, v52
    v_exp_f32 v53, v53
    v_exp_f32 v54, v54
    v_exp_f32 v55, v55
    v_exp_f32 v56, v56
    v_exp_f32 v57, v57
    v_cvt_pk_bf16_f32 v120, v48, v49
    v_cvt_pk_bf16_f32 v121, v50, v51
    v_cvt_pk_bf16_f32 v122, v52, v53
    v_cvt_pk_bf16_f32 v123, v54, v55
    v_cvt_pk_bf16_f32 v124, v56, v57
    v_mov_b32 v125, 0
    s_waitcnt lgkmcnt(0)
    v_mfma_f32_16x16x32_bf16 v[60:63], v[12:15], v[120:123], 0
    v_mfma_f32_16x16x32_bf16 v[16:19], v[80:83], v[120:123], 0
    v_mfma_f32_16x16x32_bf16 v[20:23], v[84:87], v[120:123], 0
    v_mfma_f32_16x16x32_bf16 v[24:27], v[88:91], v[120:123], 0
    v_mfma_f32_16x16x32_bf16 v[28:31], v[92:95], v[120:123], 0
    v_mfma_f32_16x16x16_bf16 v[60:63], v[12:13], v[124:125], v[60:63]
    v_mfma_f32_16x16x16_bf16 v[16:19], v[32:33], v[124:125], v[16:19]
    v_mfma_f32_16x16x16_bf16 v[20:23], v[34:35], v[124:125], v[20:23]
    v_mfma_f32_16x16x16_bf16 v[24:27], v[36:37], v[124:125], v[24:27]
    v_mfma_f32_16x16x16_bf16 v[28:31], v[38:39], v[124:125], v[28:31]
    s_lshl_b32 s59, s75, 18
    s_lshl_b32 s60, s98, 17
    s_add_u32 s59, s59, s60
    s_lshl_b32 s60, s55, 12
    s_add_u32 s59, s59, s60
    s_lshl_b32 s60, s99, 11
    s_add_u32 s59, s59, s60
    s_add_u32 s59, s59, 67108864
    v_rcp_f32 v60, v60
    s_nop 0
    v_mul_f32 v16, v16, v60
    v_mul_f32 v17, v17, v60
    v_mul_f32 v18, v18, v60
    v_mul_f32 v19, v19, v60
    v_mul_f32 v20, v20, v60
    v_mul_f32 v21, v21, v60
    v_mul_f32 v22, v22, v60
    v_mul_f32 v23, v23, v60
    v_mul_f32 v24, v24, v60
    v_mul_f32 v25, v25, v60
    v_mul_f32 v26, v26, v60
    v_mul_f32 v27, v27, v60
    v_mul_f32 v28, v28, v60
    v_mul_f32 v29, v29, v60
    v_mul_f32 v30, v30, v60
    v_mul_f32_e64 v31, v31, v60
    v_cvt_pk_bf16_f32 v40, v16, v17
    v_cvt_pk_bf16_f32 v41, v18, v19
    v_cvt_pk_bf16_f32 v42, v20, v21
    v_cvt_pk_bf16_f32 v43, v22, v23
    v_cvt_pk_bf16_f32 v44, v24, v25
    v_cvt_pk_bf16_f32 v45, v26, v27
    v_cvt_pk_bf16_f32 v46, v28, v29
    v_cvt_pk_bf16_f32 v47, v30, v31
    buffer_store_dwordx4 v[40:43], v8, s[24:27], s59 offen offset:0 sc1
    buffer_store_dwordx4 v[44:47], v8, s[24:27], s59 offen offset:1024 sc1
    s_lshl_b32 s78, s75, 1
    s_add_u32 s78, s78, s98
    s_add_u32 s78, s78, 1
    s_add_u32 s75, s75, 2
    s_branch qa_loop
qa_end:
    s_branch main_done
main_done:
    s_endpgm
code_end:
.section .rodata,"a"
.p2align 6
.amdhsa_kernel adaLN_cond__memory_aug_recurrent_mem_tr__glu_gated_bilinear__prompt_kernel
  .amdhsa_next_free_vgpr 512
  .amdhsa_next_free_sgpr 102
  .amdhsa_accum_offset 256
  .amdhsa_group_segment_fixed_size 0
  .amdhsa_kernarg_size 128
  .amdhsa_user_sgpr_count 2
  .amdhsa_user_sgpr_kernarg_segment_ptr 1
  .amdhsa_system_sgpr_workgroup_id_x 1
  .amdhsa_float_denorm_mode_32 3
.end_amdhsa_kernel
```
